```python
import torch

def _softmax(x, axis=-1):
    return torch.softmax(x, dim=axis)
def _gelu(x):
    return torch.nn.functional.gelu(x, approximate="tanh")
def _silu(x):
    return torch.nn.functional.silu(x)
def _sigmoid(x):
    return torch.sigmoid(x)
def _layernorm(x, axis=-1, eps=1e-5):
    m = x.mean(dim=axis, keepdim=True)
    v = x.var(dim=axis, keepdim=True, unbiased=False)
    return (x - m) / torch.sqrt(v + eps)
def _scatter_add(tgt, idx, src, axis=0):
    return tgt.clone().index_add_(axis, idx, src)
def _segment_sum(src, seg, n):
    out = torch.zeros((n,) + src.shape[1:], dtype=src.dtype)
    return out.index_add_(0, seg, src)
def _pad(x, pw):
    flat = tuple(v for pair in reversed(pw) for v in pair)
    return torch.nn.functional.pad(x, flat)

kernel_name = 'interleave_layers__spectral_gfnet__mixer_channel_mlp__prompt'

def setup_inputs():

    _w = (lambda a: (lambda t: t.to(torch.bfloat16) if t.is_floating_point() else t)(torch.as_tensor(a)))
    def _A_setup():
        B, S, D = 1, 2048, 640
        Df = D // 2 + 1
        return {
            "x": _w((lambda *s: torch.randn(*s, dtype=torch.bfloat16) * 0.05)(B, S, D)),
            "w_r": _w((lambda *s: torch.randn(*s, dtype=torch.bfloat16) * 0.8)(S, Df) * 0.02),
            "w_i": _w((lambda *s: torch.randn(*s, dtype=torch.bfloat16) * 0.8)(S, Df) * 0.02),
        }
    _A_in = _A_setup()

    def _B_setup():
        B, S, D, F = 1, 2048, 640, 1728
        return {
            "x": _w((lambda *s: torch.randn(*s, dtype=torch.bfloat16) * 0.05)(B, S, D)),
            "w1": _w((lambda *s: torch.randn(*s, dtype=torch.bfloat16) * 0.8)(D, F) * (D ** -0.5)),
            "b1": _w((lambda *s: torch.randn(*s, dtype=torch.bfloat16) * 0.4)(F)),
            "w2": _w((lambda *s: torch.randn(*s, dtype=torch.bfloat16) * 0.05)(F, D) * (F ** -0.5)),
            "b2": _w((lambda *s: torch.randn(*s, dtype=torch.bfloat16) * 0.05)(D)),
        }
    _B_in = _B_setup()

    return {
        "A_x": _A_in["x"],
        "A_w_r": _A_in["w_r"],
        "A_w_i": _A_in["w_i"],
        "B_x": _B_in["x"],
        "B_w1": _B_in["w1"],
        "B_b1": _B_in["b1"],
        "B_w2": _B_in["w2"],
        "B_b2": _B_in["b2"],
    }

def reference(A_x, A_w_r, A_w_i, B_x, B_w1, B_b1, B_w2, B_b2):
    def _A_ref(x, w_r, w_i):
        B, S, D = x.shape
        X = (lambda x, axes=(-2,-1): torch.fft.rfft2(x.float(), dim=axes))(x, axes=(-2, -1))
        W = w_r + 1j * w_i
        X = X * W
        y = (lambda x, s, axes=(-2,-1): torch.fft.irfft2(x, s=s, dim=axes).to(torch.bfloat16))(X, (S, D), axes=(-2, -1))
        return y

    def _B_ref(x, w1, b1, w2, b2):
        y = _layernorm(x, axis=-1)
        h = _gelu(torch.einsum("bsd,df->bsf", y, w1) + b1)
        return torch.einsum("bsf,fd->bsd", h, w2) + b2

    x = A_x
    x = x + _A_ref(_layernorm(x, axis=-1), A_w_r, A_w_i)
    x = x + _B_ref(_layernorm(x, axis=-1), B_w1, B_b1, B_w2, B_b2)
    x = x + _A_ref(_layernorm(x, axis=-1), A_w_r, A_w_i)
    x = x + _B_ref(_layernorm(x, axis=-1), B_w1, B_b1, B_w2, B_b2)
    return x
```

```asm
; @launch kernel=main_kernel grid=(256,1,1) block=(256,1,1) lds=160768
.amdgcn_target "amdgcn-amd-amdhsa--gfx950"
.text
.globl main_kernel
.p2align 8
.type main_kernel,@function
main_kernel:
    s_load_dwordx16 s[4:19], s[0:1], 0
    s_load_dwordx4 s[20:23], s[0:1], 64
    s_load_dwordx2 s[24:25], s[0:1], 80
    s_mov_b64 exec, -1
    v_and_b32 v1, 63, v0
    v_lshrrev_b32 v2, 6, v0
    s_nop 0
    v_readfirstlane_b32 s26, v2
    s_cmp_ge_u32 s2, 128
    s_cbranch_scc1 K1_oth
    v_and_b32 v89, 3, v1
    v_lshrrev_b32 v2, 4, v1
    v_mul_u32_u24 v2, 320, v2
    v_bfe_u32 v5, v1, 2, 2
    v_lshl_add_u32 v90, v5, 4, v2
    s_and_b32 s41, s2, 3
    s_lshl_b32 s41, s41, 2
    s_add_u32 s41, s41, s26
    s_lshl_b32 s40, s41, 7
    s_lshr_b32 s41, s2, 2
    s_add_u32 s40, s40, s41
    s_mul_i32 s40, s40, 1280
    v_mul_u32_u24 v86, 40960, v89
    v_add_u32 v86, v86, v90
    s_waitcnt lgkmcnt(0)
    s_mov_b32 s36, s4
    s_and_b32 s37, s5, 0xffff
    s_mov_b32 s38, 0x280000
    s_mov_b32 s39, 0x00020000
    buffer_load_dwordx4 v[216:219], v86, s[36:39], s40 offen offset:0
    buffer_load_dwordx4 v[220:223], v86, s[36:39], s40 offen offset:64
    buffer_load_dwordx4 v[224:227], v86, s[36:39], s40 offen offset:128
    buffer_load_dwordx4 v[228:231], v86, s[36:39], s40 offen offset:192
    buffer_load_dwordx4 v[232:235], v86, s[36:39], s40 offen offset:256
    s_mov_b32 s32, s24
    s_and_b32 s33, s25, 0xffff
    s_mov_b32 s34, 0x134f000
    s_mov_b32 s35, 0x00020000
    s_mov_b32 s27, 0
    s_mov_b32 s28, s2
    s_mov_b32 s45, 0
    s_and_b32 s56, s2, 30
    s_lshl_b32 s56, s56, 2
    s_and_b32 s3, s2, 1
SC_e16:
PAD_0:
    s_cbranch_execz SC_ret
    s_or_b32 s56, s56, s3
    s_lshr_b32 s3, s2, 5
    s_lshl_b32 s3, s3, 1
    s_or_b32 s56, s56, s3
    s_bitcmp0_b32 s26, 0
    s_cselect_b32 s36, s6, s8
    s_cselect_b32 s37, s7, s9
    s_and_b32 s37, s37, 0xffff
    s_mov_b32 s38, 1314816
    s_mov_b32 s39, 0x00020000
    s_lshr_b32 s40, s56, 3
    s_lshl_b32 s40, s40, 7
    s_lshr_b32 s49, s26, 1
    s_lshl_b32 s49, s49, 6
    s_add_u32 s40, s40, s49
    s_and_b32 s49, s56, 1
    s_lshl_b32 s49, s49, 5
    s_add_u32 s40, s40, s49
    s_bfe_u32 s49, s56, 0x20001
    s_add_u32 s40, s40, s49
    s_mul_i32 s40, s40, 642
    s_and_b32 s54, s40, 2
    s_and_b32 s40, s40, -4
    v_sub_u32 v2, 40, v1
    v_and_b32 v2, 0x40000000, v2
    v_lshl_add_u32 v2, v1, 4, v2
    buffer_load_dwordx4 a[0:3], v2, s[36:39], s40 offen offset:0
    buffer_load_dwordx4 a[4:7], v2, s[36:39], s40 offen offset:2568
    s_add_u32 s40, s40, 5136
    buffer_load_dwordx4 a[8:11], v2, s[36:39], s40 offen offset:0
    buffer_load_dwordx4 a[12:15], v2, s[36:39], s40 offen offset:2568
    s_add_u32 s40, s40, 5136
    buffer_load_dwordx4 a[16:19], v2, s[36:39], s40 offen offset:0
    buffer_load_dwordx4 a[20:23], v2, s[36:39], s40 offen offset:2568
    s_add_u32 s40, s40, 5136
    buffer_load_dwordx4 a[24:27], v2, s[36:39], s40 offen offset:0
    buffer_load_dwordx4 a[28:31], v2, s[36:39], s40 offen offset:2568
    v_mov_b32 v252, -2
    v_mov_b32 v253, -2
    v_mov_b32 v254, -2
    v_mov_b32 v255, -2
    s_lshr_b32 s59, s2, 2
    s_lshl_b32 s59, s59, 5
    s_and_b32 s3, s2, 3
    s_add_u32 s59, s59, s3
    s_lshl_b32 s59, s59, 2
SC_e32:
PAD_1:
    s_cbranch_execz SC_ret
    s_add_u32 s59, s59, 0xb7f000
    s_branch K1_con
K1_oth:
    s_cmp_ge_u32 s2, 256
    s_cbranch_scc1 main_kernel_exit
    s_lshl_b32 s58, s2, 2
    s_add_u32 s58, s58, s26
    s_cmp_eq_u32 s58, 512
    s_cbranch_scc1 SC_ret
    s_bfe_u32 s40, s2, 0x40003
    s_mov_b64 exec, 0
    s_cmp_eq_u32 s26, 1
    s_cbranch_scc1 SC_c1
    s_cmp_eq_u32 s26, 2
    s_cbranch_scc1 SC_c2
    s_cmp_eq_u32 s26, 3
    s_cbranch_scc1 SC_c3
SC_c0:
    s_sub_u32 s40, s40, 1
    s_cbranch_scc1 SC_e0
    s_sub_u32 s40, s40, 1
    s_cbranch_scc1 SC_e1
    s_sub_u32 s40, s40, 1
    s_cbranch_scc1 SC_e2
    s_sub_u32 s40, s40, 1
    s_cbranch_scc1 SC_e3
    s_sub_u32 s40, s40, 1
    s_cbranch_scc1 SC_e4
    s_sub_u32 s40, s40, 1
    s_cbranch_scc1 SC_e5
    s_sub_u32 s40, s40, 1
    s_cbranch_scc1 SC_e6
    s_sub_u32 s40, s40, 1
    s_cbranch_scc1 SC_e7
    s_sub_u32 s40, s40, 1
    s_cbranch_scc1 SC_e8
    s_sub_u32 s40, s40, 1
    s_cbranch_scc1 SC_e9
    s_sub_u32 s40, s40, 1
    s_cbranch_scc1 SC_e10
    s_sub_u32 s40, s40, 1
    s_cbranch_scc1 SC_e11
    s_sub_u32 s40, s40, 1
    s_cbranch_scc1 SC_e12
    s_sub_u32 s40, s40, 1
    s_cbranch_scc1 SC_e13
    s_sub_u32 s40, s40, 1
    s_cbranch_scc1 SC_e14
    s_branch SC_e15
SC_c1:
    s_sub_u32 s40, s40, 1
    s_cbranch_scc1 SC_e16
    s_sub_u32 s40, s40, 1
    s_cbranch_scc1 SC_e17
    s_sub_u32 s40, s40, 1
    s_cbranch_scc1 SC_e18
    s_sub_u32 s40, s40, 1
    s_cbranch_scc1 SC_e19
    s_sub_u32 s40, s40, 1
    s_cbranch_scc1 SC_e20
    s_sub_u32 s40, s40, 1
    s_cbranch_scc1 SC_e21
    s_sub_u32 s40, s40, 1
    s_cbranch_scc1 SC_e22
    s_sub_u32 s40, s40, 1
    s_cbranch_scc1 SC_e23
    s_sub_u32 s40, s40, 1
    s_cbranch_scc1 SC_e24
    s_sub_u32 s40, s40, 1
    s_cbranch_scc1 SC_e25
    s_sub_u32 s40, s40, 1
    s_cbranch_scc1 SC_e26
    s_sub_u32 s40, s40, 1
    s_cbranch_scc1 SC_e27
    s_sub_u32 s40, s40, 1
    s_cbranch_scc1 SC_e28
    s_sub_u32 s40, s40, 1
    s_cbranch_scc1 SC_e29
    s_sub_u32 s40, s40, 1
    s_cbranch_scc1 SC_e30
    s_branch SC_e31
SC_c2:
    s_sub_u32 s40, s40, 1
    s_cbranch_scc1 SC_e32
    s_sub_u32 s40, s40, 1
    s_cbranch_scc1 SC_e33
    s_sub_u32 s40, s40, 1
    s_cbranch_scc1 SC_e34
    s_sub_u32 s40, s40, 1
    s_cbranch_scc1 SC_e35
    s_sub_u32 s40, s40, 1
    s_cbranch_scc1 SC_e36
    s_sub_u32 s40, s40, 1
    s_cbranch_scc1 SC_e37
    s_sub_u32 s40, s40, 1
    s_cbranch_scc1 SC_e38
    s_sub_u32 s40, s40, 1
    s_cbranch_scc1 SC_e39
    s_sub_u32 s40, s40, 1
    s_cbranch_scc1 SC_e40
    s_sub_u32 s40, s40, 1
    s_cbranch_scc1 SC_e41
    s_sub_u32 s40, s40, 1
    s_cbranch_scc1 SC_e42
    s_sub_u32 s40, s40, 1
    s_cbranch_scc1 SC_e43
    s_sub_u32 s40, s40, 1
    s_cbranch_scc1 SC_e44
    s_sub_u32 s40, s40, 1
    s_cbranch_scc1 SC_e45
    s_sub_u32 s40, s40, 1
    s_cbranch_scc1 SC_e46
    s_branch SC_e47
SC_c3:
    s_sub_u32 s40, s40, 1
    s_cbranch_scc1 SC_e48
    s_sub_u32 s40, s40, 1
    s_cbranch_scc1 SC_e49
    s_sub_u32 s40, s40, 1
    s_cbranch_scc1 SC_e50
    s_sub_u32 s40, s40, 1
    s_cbranch_scc1 SC_e51
    s_sub_u32 s40, s40, 1
    s_cbranch_scc1 SC_e52
    s_sub_u32 s40, s40, 1
    s_cbranch_scc1 SC_e53
    s_sub_u32 s40, s40, 1
    s_cbranch_scc1 SC_e54
    s_sub_u32 s40, s40, 1
    s_cbranch_scc1 SC_e55
    s_sub_u32 s40, s40, 1
    s_cbranch_scc1 SC_e56
    s_sub_u32 s40, s40, 1
    s_cbranch_scc1 SC_e57
    s_sub_u32 s40, s40, 1
    s_cbranch_scc1 SC_e58
    s_sub_u32 s40, s40, 1
    s_cbranch_scc1 SC_e59
    s_sub_u32 s40, s40, 1
    s_cbranch_scc1 SC_e60
    s_sub_u32 s40, s40, 1
    s_cbranch_scc1 SC_e61
    s_sub_u32 s40, s40, 1
    s_cbranch_scc1 SC_e62
    s_branch SC_e63
SC_e0:
SC_ret:
    s_mov_b64 exec, -1
SC_e48:
PAD_2:
    s_cbranch_execz PAD_3
    s_waitcnt lgkmcnt(0)
    s_mov_b32 s32, s24
    s_and_b32 s33, s25, 0xffff
    s_mov_b32 s34, 0x134f000
    s_mov_b32 s35, 0x00020000
    s_cmp_lg_u32 s58, 512
    s_cbranch_scc1 skip_1
    v_mov_b32 v252, -2
    v_mov_b32 v253, -2
    v_mov_b32 v254, -2
    v_mov_b32 v255, -2
    v_lshlrev_b32 v2, 7, v1
    s_mov_b32 s3, 0xb7f000
    buffer_store_dwordx4 v[252:255], v2, s[32:35], s3 offen sc1
    s_mov_b32 s3, 0xb81000
    buffer_store_dwordx4 v[252:255], v2, s[32:35], s3 offen sc1
    s_mov_b32 s60, s22
    s_and_b32 s61, s23, 0xffff
    s_mov_b32 s62, 0x100
    s_mov_b32 s63, 0x00020000
    v_mov_b32 v3, 1
    v_sub_u32 v2, 0, v1
    v_and_b32 v2, 0x40000000, v2
    s_waitcnt vmcnt(0)
    buffer_store_dword v3, v2, s[60:63], 0 offen sc1
skip_1:
    s_and_b32 s28, s2, 7
    s_lshl_b32 s28, s28, 2
    s_bfe_u32 s40, s2, 0x20003
    s_add_u32 s28, s28, s40
    s_and_b32 s40, s2, 0x60
    s_add_u32 s28, s28, s40
PAD_3:
    s_cbranch_execz SC_ret
    s_sub_u32 s28, 127, s28
    s_lshr_b32 s59, s28, 2
    s_lshl_b32 s59, s59, 5
    s_and_b32 s3, s28, 3
    s_add_u32 s59, s59, s3
    s_lshl_b32 s59, s59, 2
    s_add_u32 s59, s59, 0xb80000
    s_mov_b32 s45, 0
    s_cmp_ge_u32 s28, 108
    s_cbranch_scc1 K1_dw2
    s_mov_b32 s27, 1
    s_mov_b32 s36, s12
    s_and_b32 s37, s13, 0xffff
    s_mov_b32 s38, 0x21c000
    s_mov_b32 s39, 0x00020000
    v_lshrrev_b32 v2, 1, v0
    v_mul_u32_u24 v86, 3456, v2
    v_and_b32 v2, 1, v0
    v_lshl_add_u32 v86, v2, 4, v86
    s_lshl_b32 s40, s28, 5
    s_mov_b32 s48, 442368
    s_branch K1_oj
K1_dw2:
    s_sub_u32 s28, s28, 12
    s_mov_b32 s27, 2
    s_cmp_gt_u32 s28, 108
    s_cselect_b32 s45, 0x40000000, 0
    s_cselect_b32 s28, 0, s28
    v_and_b32 v89, 3, v1
    v_lshrrev_b32 v2, 4, v1
    v_mul_u32_u24 v2, 320, v2
    v_bfe_u32 v5, v1, 2, 2
    v_lshl_add_u32 v90, v5, 4, v2
    s_mov_b32 s36, s16
    s_and_b32 s37, s17, 0xffff
    s_mov_b32 s38, 0x21c000
    s_mov_b32 s39, 0x00020000
    s_lshl_b32 s40, s28, 2
    s_add_u32 s40, s40, s26
    s_mul_i32 s40, s40, 5120
    s_mov_b32 s48, 64
    v_mul_u32_u24 v86, 1280, v89
    v_add_u32 v86, v86, v90
    v_or_b32 v86, s45, v86
    s_cmp_lg_u32 s28, 108
SC_e1:
PAD_4:
    s_cbranch_execz SC_ret
    s_cbranch_scc1 K1_oj
    s_mov_b32 s27, 3
    s_mov_b32 s36, s18
    s_and_b32 s37, s19, 0xffff
    s_mov_b32 s38, 0x500
    s_mov_b32 s39, 0x00020000
    s_mov_b32 s40, 0
K1_oj:
    buffer_load_dwordx4 v[216:219], v86, s[36:39], s40 offen
    s_add_u32 s40, s40, s48
    buffer_load_dwordx4 v[220:223], v86, s[36:39], s40 offen
    s_add_u32 s40, s40, s48
    buffer_load_dwordx4 v[224:227], v86, s[36:39], s40 offen
    s_add_u32 s40, s40, s48
    buffer_load_dwordx4 v[228:231], v86, s[36:39], s40 offen
    s_add_u32 s40, s40, s48
    buffer_load_dwordx4 v[232:235], v86, s[36:39], s40 offen
K1_con:
    v_sub_u32 v93, 63, v0
    v_and_b32 v93, 0x40000000, v93
    v_lshl_add_u32 v93, v0, 2, v93
    s_lshl_b32 s3, s2, 8
    s_add_u32 s3, s3, 0xc7b000
    v_add_u32 v93, s3, v93
    v_mov_b32 v92, -1
    v_and_b32 v2, 15, v1
    v_cvt_f32_ubyte0 v6, v2
    v_lshrrev_b32 v2, 4, v1
    v_cvt_f32_ubyte0 v7, v2
    v_mul_f32 v2, v6, v7
    v_mul_f32 v3, 0x3e800000, v2
    v_fmamk_f32 v4, v6, 0x00000000, v3
    v_cos_f32 v152, v4
    v_sin_f32 v160, v4
    v_fmamk_f32 v4, v6, 0x3d4ccccd, v3
    v_cos_f32 v153, v4
    v_sin_f32 v161, v4
    v_fmamk_f32 v4, v6, 0x3dcccccd, v3
    v_cos_f32 v154, v4
    v_sin_f32 v162, v4
    v_fmamk_f32 v4, v6, 0x3e19999a, v3
    v_cos_f32 v155, v4
    v_sin_f32 v163, v4
    v_fmamk_f32 v4, v6, 0x3e4ccccd, v3
    v_cos_f32 v156, v4
    v_sin_f32 v164, v4
    v_cvt_pk_bf16_f32 v96, v152, v153
    v_cvt_pk_bf16_f32 v97, v154, v155
SC_e17:
PAD_5:
    s_cbranch_execz SC_ret
    v_cvt_pk_bf16_f32 v98, v156, 0
    v_mov_b32 v99, 0
    v_cvt_pk_bf16_f32 v100, -v160, -v161
    v_cvt_pk_bf16_f32 v101, -v162, -v163
    v_cvt_pk_bf16_f32 v102, -v164, 0
    v_mov_b32 v103, 0
    v_mul_f32 v3, 0x3c4ccccd, v2
    v_fmamk_f32 v4, v6, 0x00000000, v3
    v_cos_f32 v152, v4
    v_sin_f32 v160, v4
    v_fmamk_f32 v4, v6, 0x3acccccd, v3
    v_cos_f32 v153, v4
    v_sin_f32 v161, v4
    v_fmamk_f32 v4, v6, 0x3b4ccccd, v3
    v_cos_f32 v154, v4
    v_sin_f32 v162, v4
    v_fmamk_f32 v4, v6, 0x3b99999a, v3
    v_cos_f32 v155, v4
    v_sin_f32 v163, v4
    v_fmamk_f32 v4, v6, 0x3bcccccd, v3
    v_cos_f32 v156, v4
    v_sin_f32 v164, v4
    v_fmamk_f32 v4, v6, 0x3c000000, v3
    v_cos_f32 v157, v4
    v_sin_f32 v165, v4
    v_fmamk_f32 v4, v6, 0x3c19999a, v3
    v_cos_f32 v158, v4
    v_sin_f32 v166, v4
    v_fmamk_f32 v4, v6, 0x3c333333, v3
    v_cos_f32 v159, v4
    v_sin_f32 v167, v4
    v_mul_f32 v104, 0x3d64f92e, v152
    v_mul_f32 v105, 0xbd64f92e, v160
    v_mul_f32 v106, 0x3d64f92e, v153
    v_mul_f32 v107, 0xbd64f92e, v161
    v_mul_f32 v108, 0x3d64f92e, v154
    v_mul_f32 v109, 0xbd64f92e, v162
    v_mul_f32 v110, 0x3d64f92e, v155
    v_mul_f32 v111, 0xbd64f92e, v163
    v_mul_f32 v112, 0x3d64f92e, v156
SC_e33:
PAD_6:
    s_cbranch_execz SC_ret
    v_mul_f32 v113, 0xbd64f92e, v164
    v_mul_f32 v114, 0x3d64f92e, v157
    v_mul_f32 v115, 0xbd64f92e, v165
    v_mul_f32 v116, 0x3d64f92e, v158
    v_mul_f32 v117, 0xbd64f92e, v166
    v_mul_f32 v118, 0x3d64f92e, v159
    v_mul_f32 v119, 0xbd64f92e, v167
    v_bfe_u32 v2, v1, 1, 3
    v_cvt_f32_ubyte0 v5, v2
    v_and_b32 v2, 1, v1
    v_cvt_f32_ubyte0 v2, v2
    v_fma_f32 v2, v5, v7, v2
    v_mul_f32 v3, 0x3e800000, v2
    v_fmamk_f32 v4, v5, 0x00000000, v3
    v_cos_f32 v152, v4
    v_sin_f32 v160, v4
    v_fmamk_f32 v4, v5, 0x3d000000, v3
    v_cos_f32 v153, v4
    v_sin_f32 v161, v4
    v_fmamk_f32 v4, v5, 0x3d800000, v3
    v_cos_f32 v154, v4
    v_sin_f32 v162, v4
    v_fmamk_f32 v4, v5, 0x3dc00000, v3
    v_cos_f32 v155, v4
    v_sin_f32 v163, v4
    v_fmamk_f32 v4, v5, 0x3e000000, v3
    v_cos_f32 v156, v4
    v_sin_f32 v164, v4
    v_fmamk_f32 v4, v5, 0x3e200000, v3
    v_cos_f32 v157, v4
    v_sin_f32 v165, v4
    v_fmamk_f32 v4, v5, 0x3e400000, v3
    v_cos_f32 v158, v4
    v_sin_f32 v166, v4
    v_fmamk_f32 v4, v5, 0x3e600000, v3
    v_cos_f32 v159, v4
    v_sin_f32 v167, v4
    v_cvt_pk_bf16_f32 v120, v152, v153
    v_cvt_pk_bf16_f32 v121, v154, v155
    v_cvt_pk_bf16_f32 v122, v156, v157
    v_cvt_pk_bf16_f32 v123, v158, v159
SC_e49:
PAD_7:
    s_cbranch_execz SC_ret
    v_cvt_pk_bf16_f32 v124, v160, v161
    v_cvt_pk_bf16_f32 v125, v162, v163
    v_cvt_pk_bf16_f32 v126, v164, v165
    v_cvt_pk_bf16_f32 v127, v166, v167
    v_cvt_pk_bf16_f32 v128, v152, -v161
    v_cvt_pk_bf16_f32 v129, -v154, v163
    v_cvt_pk_bf16_f32 v130, v156, -v165
    v_cvt_pk_bf16_f32 v131, -v158, v167
    v_cvt_pk_bf16_f32 v132, v160, v153
    v_cvt_pk_bf16_f32 v133, -v162, -v155
    v_cvt_pk_bf16_f32 v134, v164, v157
    v_cvt_pk_bf16_f32 v135, -v166, -v159
    v_cvt_pk_bf16_f32 v136, v152, -v153
    v_cvt_pk_bf16_f32 v137, v154, -v155
    v_cvt_pk_bf16_f32 v138, v156, -v157
    v_cvt_pk_bf16_f32 v139, v158, -v159
    v_cvt_pk_bf16_f32 v140, v160, -v161
    v_cvt_pk_bf16_f32 v141, v162, -v163
    v_cvt_pk_bf16_f32 v142, v164, -v165
    v_cvt_pk_bf16_f32 v143, v166, -v167
    v_cvt_pk_bf16_f32 v144, v152, v161
    v_cvt_pk_bf16_f32 v145, -v154, -v163
    v_cvt_pk_bf16_f32 v146, v156, v165
    v_cvt_pk_bf16_f32 v147, -v158, -v167
    v_cvt_pk_bf16_f32 v148, v160, -v153
    v_cvt_pk_bf16_f32 v149, -v162, v155
    v_cvt_pk_bf16_f32 v150, v164, -v157
    v_cvt_pk_bf16_f32 v151, -v166, v159
    s_mov_b32 s60, s22
    s_and_b32 s61, s23, 0xffff
    s_mov_b32 s62, 0x100
    s_mov_b32 s63, 0x00020000
SC_e2:
PAD_8:
    s_cbranch_execz PAD_9
    s_mov_b32 s29, 0
    s_mov_b32 s55, 0x10000
    v_sub_u32 v94, 0, v0
    v_and_b32 v94, 0x40000000, v94
    v_sub_u32 v249, 0, v0
    v_and_b32 v249, 0x40000000, v249
    s_and_b32 s101, s2, 0
    s_mul_i32 s101, s101, 8192
    v_mov_b32 v88, 0x40000000
    v_mov_b32 v95, 0x40000000
    v_mov_b32 v251, 0x40000000
    v_lshrrev_b32 v184, 3, v0
    v_and_b32 v185, 7, v0
    v_lshlrev_b32 v185, 4, v185
    v_lshl_add_u32 v80, v184, 9, v185
    v_lshrrev_b32 v85, 1, v80
    s_mul_i32 s48, s2, 16640
    v_add_u32 v80, s48, v80
    s_cmp_ge_u32 s2, 160
    s_cbranch_scc1 K1_nc
    s_waitcnt vmcnt(0)
    s_cmp_ge_u32 s2, 128
    s_cbranch_scc1 skip_2
    v_and_b32 v5, 7, v0
    v_lshrrev_b32 v3, 3, v0
    v_mul_u32_u24 v88, 16640, v3
    v_lshl_add_u32 v88, v5, 4, v88
    s_lshl_b32 s40, s56, 7
    s_add_u32 s40, s40, 0x28a000
    v_mul_u32_u24 v87, 656, v5
    s_add_u32 s54, s54, 42560
    v_add_u32 v87, s54, v87
    v_bfe_u32 v4, v0, 3, 1
    v_mul_u32_u24 v4, 160, v4
    v_bfe_u32 v5, v0, 4, 2
    v_mad_u32_u24 v4, v5, 40, v4
    v_add_u32 v4, s26, v4
    s_mul_i32 s48, s26, 5248
    s_add_u32 s48, s48, 42560
    v_lshl_add_u32 v2, v1, 4, s48
    s_mov_b32 exec_hi, 0x1ff
    ds_write_b128 v2, a[0:3] offset:0
    ds_write_b128 v2, a[4:7] offset:656
PAD_9:
    s_cbranch_execz SC_ret
    ds_write_b128 v2, a[8:11] offset:1312
    ds_write_b128 v2, a[12:15] offset:1968
    ds_write_b128 v2, a[16:19] offset:2624
    ds_write_b128 v2, a[20:23] offset:3280
    ds_write_b128 v2, a[24:27] offset:3936
    ds_write_b128 v2, a[28:31] offset:4592
    s_mov_b32 exec_hi, -1
    s_waitcnt lgkmcnt(0)
    s_barrier
    v_add_u32 v2, 0, v4
    v_lshl_add_u32 v89, v2, 1, v87
    v_add_u32 v90, 40, v89
    v_cmp_gt_u32 vcc, 8, v0
    v_add_u32 v2, 640, v87
    s_nop 0
    v_cndmask_b32 v89, v89, v2, vcc
    ds_read_u16 v152, v89 offset:0
    ds_read_u16 v156, v89 offset:5248
    ds_read_u16 v153, v90 offset:0
    ds_read_u16 v157, v90 offset:5248
    ds_read_u16 v154, v89 offset:10496
    ds_read_u16 v158, v89 offset:15744
    ds_read_u16 v155, v90 offset:10496
    ds_read_u16 v159, v90 offset:15744
    v_add_u32 v2, 4, v4
    v_lshl_add_u32 v89, v2, 1, v87
    v_add_u32 v90, 40, v89
    ds_read_u16 v160, v89 offset:0
    ds_read_u16 v164, v89 offset:5248
    ds_read_u16 v161, v90 offset:0
    ds_read_u16 v165, v90 offset:5248
    ds_read_u16 v162, v89 offset:10496
    ds_read_u16 v166, v89 offset:15744
    ds_read_u16 v163, v90 offset:10496
    ds_read_u16 v167, v90 offset:15744
    v_sub_u32 v2, 322, v4
SC_e18:
PAD_10:
    s_cbranch_execz SC_ret
    v_lshl_add_u32 v89, v2, 1, v87
    v_add_u32 v90, -40, v89
    s_cmp_eq_u32 s26, 3
    s_cbranch_scc1 K1_wt_hi
    v_add_u32 v2, 8, v4
    v_lshl_add_u32 v89, v2, 1, v87
    v_add_u32 v90, 40, v89
K1_wt_hi:
    ds_read_u16 v168, v89 offset:0
    ds_read_u16 v172, v89 offset:5248
    ds_read_u16 v169, v90 offset:0
    ds_read_u16 v173, v90 offset:5248
    ds_read_u16 v170, v89 offset:10496
    ds_read_u16 v174, v89 offset:15744
    ds_read_u16 v171, v90 offset:10496
    ds_read_u16 v175, v90 offset:15744
    v_sub_u32 v2, 318, v4
    v_lshl_add_u32 v89, v2, 1, v87
    v_add_u32 v90, -40, v89
    ds_read_u16 v176, v89 offset:0
    ds_read_u16 v180, v89 offset:5248
    ds_read_u16 v177, v90 offset:0
    ds_read_u16 v181, v90 offset:5248
    ds_read_u16 v178, v89 offset:10496
    ds_read_u16 v182, v89 offset:15744
    ds_read_u16 v179, v90 offset:10496
    ds_read_u16 v183, v90 offset:15744
    v_sub_u32 v2, 314, v4
    v_lshl_add_u32 v89, v2, 1, v87
    v_add_u32 v90, -40, v89
    ds_read_u16 v184, v89 offset:0
    ds_read_u16 v188, v89 offset:5248
    ds_read_u16 v185, v90 offset:0
    ds_read_u16 v189, v90 offset:5248
    ds_read_u16 v186, v89 offset:10496
SC_e34:
PAD_11:
    s_cbranch_execz SC_ret
    ds_read_u16 v190, v89 offset:15744
    ds_read_u16 v187, v90 offset:10496
    ds_read_u16 v191, v90 offset:15744
    s_waitcnt lgkmcnt(15)
    v_lshl_or_b32 v152, v156, 16, v152
    v_lshl_or_b32 v153, v157, 16, v153
    v_lshl_or_b32 v154, v158, 16, v154
    v_lshl_or_b32 v155, v159, 16, v155
    s_add_u32 s42, s40, 0
    buffer_store_dwordx4 v[152:155], v88, s[32:35], s42 offen sc1
    v_lshl_or_b32 v160, v164, 16, v160
    v_lshl_or_b32 v161, v165, 16, v161
    v_lshl_or_b32 v162, v166, 16, v162
    v_lshl_or_b32 v163, v167, 16, v163
    s_add_u32 s42, s40, 532480
    buffer_store_dwordx4 v[160:163], v88, s[32:35], s42 offen sc1
    v_lshl_or_b32 v168, v172, 16, v168
    v_lshl_or_b32 v169, v173, 16, v169
    v_lshl_or_b32 v170, v174, 16, v170
    v_lshl_or_b32 v171, v175, 16, v171
    s_add_u32 s42, s40, 1064960
    buffer_store_dwordx4 v[168:171], v88, s[32:35], s42 offen sc1
    s_waitcnt lgkmcnt(14)
    v_lshl_or_b32 v176, v180, 16, v176
    s_waitcnt lgkmcnt(12)
    v_lshl_or_b32 v177, v181, 16, v177
    s_waitcnt lgkmcnt(10)
    v_lshl_or_b32 v178, v182, 16, v178
    s_waitcnt lgkmcnt(8)
    v_lshl_or_b32 v179, v183, 16, v179
    s_add_u32 s42, s40, 1597440
    buffer_store_dwordx4 v[176:179], v88, s[32:35], s42 offen sc1
    s_waitcnt lgkmcnt(6)
    v_lshl_or_b32 v184, v188, 16, v184
    s_waitcnt lgkmcnt(4)
SC_e50:
PAD_12:
    s_cbranch_execz SC_ret
    v_lshl_or_b32 v185, v189, 16, v185
    s_waitcnt lgkmcnt(2)
    v_lshl_or_b32 v186, v190, 16, v186
    s_waitcnt lgkmcnt(0)
    v_lshl_or_b32 v187, v191, 16, v187
    s_add_u32 s42, s40, 2129920
    buffer_store_dwordx4 v[184:187], v88, s[32:35], s42 offen sc1
    s_lshl_b32 s42, s2, 7
    s_mul_i32 s48, s26, 665600
    s_add_u32 s42, s42, s48
    v_and_b32 v5, 7, v1
    v_lshrrev_b32 v4, 3, v1
    v_lshl_add_u32 v5, v5, 4, s42
    v_mul_u32_u24 v4, 16640, v4
    v_add_u32 v5, v4, v5
    s_mov_b32 s42, 0x0
    buffer_store_dwordx4 v[252:255], v5, s[32:35], s42 offen sc1
    s_mov_b32 s42, 0x20800
    buffer_store_dwordx4 v[252:255], v5, s[32:35], s42 offen sc1
    s_mov_b32 s42, 0x41000
    buffer_store_dwordx4 v[252:255], v5, s[32:35], s42 offen sc1
    s_mov_b32 s42, 0x61800
    buffer_store_dwordx4 v[252:255], v5, s[32:35], s42 offen sc1
    s_mov_b32 s42, 0x82000
    buffer_store_dwordx4 v[252:255], v5, s[32:35], s42 offen sc1
    s_lshl_b32 s43, s2, 2
    s_add_u32 s43, s43, s26
    s_lshl_b32 s43, s43, 4
    s_add_u32 s43, s43, 0xb7c000
    v_sub_u32 v2, 3, v1
    v_and_b32 v2, 0x40000000, v2
    v_lshl_add_u32 v2, v1, 2, v2
    v_add_u32 v93, s43, v2
    buffer_store_dword v252, v93, s[32:35], 0 offen sc1
    v_mov_b32 v95, v94
    v_mov_b32 v88, 0x40000000
skip_2:
K1_go:
    v_and_b32 v2, 15, v1
    v_lshrrev_b32 v3, 4, v1
    v_lshl_add_u32 v6, v2, 2, v3
    v_mul_u32_u24 v7, 1040, v2
    v_cmp_eq_u32 vcc, 0, v1
SC_e3:
PAD_13:
    s_cbranch_execz SC_ret
    v_mov_b32 v2, 0x3f3504f3
    s_cmp_eq_u32 s27, 1
    s_cbranch_scc1 K1_w1
    v_cndmask_b32 v91, 1.0, v2, vcc
    s_mov_b32 s48, 0x05040100
    s_mov_b32 s49, 0x07060302
    v_perm_b32 v184, v220, v216, s48
    v_perm_b32 v185, v228, v224, s48
    v_and_b32 v186, 0xffff, v232
    v_mov_b32 v187, 0
    v_perm_b32 v188, v220, v216, s49
    v_perm_b32 v189, v228, v224, s49
    v_lshrrev_b32 v190, 16, v232
    v_mov_b32 v191, 0
    v_perm_b32 v192, v221, v217, s48
    v_perm_b32 v193, v229, v225, s48
    v_and_b32 v194, 0xffff, v233
    v_mov_b32 v195, 0
    v_perm_b32 v196, v221, v217, s49
    v_perm_b32 v197, v229, v225, s49
    v_lshrrev_b32 v198, 16, v233
    v_mov_b32 v199, 0
    v_perm_b32 v200, v222, v218, s48
    v_perm_b32 v201, v230, v226, s48
    v_and_b32 v202, 0xffff, v234
    v_mov_b32 v203, 0
    v_perm_b32 v204, v222, v218, s49
    v_perm_b32 v205, v230, v226, s49
    v_lshrrev_b32 v206, 16, v234
    v_mov_b32 v207, 0
    v_perm_b32 v208, v223, v219, s48
    v_perm_b32 v209, v231, v227, s48
    v_and_b32 v210, 0xffff, v235
    v_mov_b32 v211, 0
    v_perm_b32 v212, v223, v219, s49
    v_perm_b32 v213, v231, v227, s49
    v_lshrrev_b32 v214, 16, v235
    v_mov_b32 v215, 0
    s_cmp_eq_u32 s27, 0
    s_cbranch_scc0 K1_ow2
SC_e19:
PAD_14:
    s_cbranch_execz PAD_15
    s_mov_b32 s48, 0x3f803f80
    v_mov_b32 v2, 0
    v_mov_b32 v3, 0
    v_dot2_f32_bf16 v2, v216, v216, v2
    v_dot2_f32_bf16 v3, v216, s48, v3
    v_dot2_f32_bf16 v2, v217, v217, v2
    v_dot2_f32_bf16 v3, v217, s48, v3
    v_dot2_f32_bf16 v2, v218, v218, v2
    v_dot2_f32_bf16 v3, v218, s48, v3
    v_dot2_f32_bf16 v2, v219, v219, v2
    v_dot2_f32_bf16 v3, v219, s48, v3
    v_dot2_f32_bf16 v2, v220, v220, v2
    v_dot2_f32_bf16 v3, v220, s48, v3
    v_dot2_f32_bf16 v2, v221, v221, v2
    v_dot2_f32_bf16 v3, v221, s48, v3
    v_dot2_f32_bf16 v2, v222, v222, v2
    v_dot2_f32_bf16 v3, v222, s48, v3
    v_dot2_f32_bf16 v2, v223, v223, v2
    v_dot2_f32_bf16 v3, v223, s48, v3
    v_dot2_f32_bf16 v2, v224, v224, v2
    v_dot2_f32_bf16 v3, v224, s48, v3
    v_dot2_f32_bf16 v2, v225, v225, v2
    v_dot2_f32_bf16 v3, v225, s48, v3
    v_dot2_f32_bf16 v2, v226, v226, v2
    v_dot2_f32_bf16 v3, v226, s48, v3
    v_dot2_f32_bf16 v2, v227, v227, v2
    v_dot2_f32_bf16 v3, v227, s48, v3
    v_dot2_f32_bf16 v2, v228, v228, v2
    v_dot2_f32_bf16 v3, v228, s48, v3
    v_dot2_f32_bf16 v2, v229, v229, v2
    v_dot2_f32_bf16 v3, v229, s48, v3
    v_dot2_f32_bf16 v2, v230, v230, v2
    v_dot2_f32_bf16 v3, v230, s48, v3
PAD_15:
    s_cbranch_execz SC_ret
    v_dot2_f32_bf16 v2, v231, v231, v2
    v_dot2_f32_bf16 v3, v231, s48, v3
    v_dot2_f32_bf16 v2, v232, v232, v2
    v_dot2_f32_bf16 v3, v232, s48, v3
    v_dot2_f32_bf16 v2, v233, v233, v2
    v_dot2_f32_bf16 v3, v233, s48, v3
    v_dot2_f32_bf16 v2, v234, v234, v2
    v_dot2_f32_bf16 v3, v234, s48, v3
    v_dot2_f32_bf16 v2, v235, v235, v2
    v_dot2_f32_bf16 v3, v235, s48, v3
    s_nop 1
    v_add_f32_dpp v2, v2, v2 row_ror:4 row_mask:0xf bank_mask:0xf
    v_add_f32_dpp v3, v3, v3 row_ror:4 row_mask:0xf bank_mask:0xf
    s_nop 0
    v_add_f32_dpp v2, v2, v2 row_ror:8 row_mask:0xf bank_mask:0xf
    v_add_f32_dpp v3, v3, v3 row_ror:8 row_mask:0xf bank_mask:0xf
    v_mov_b32 v4, v2
    v_mov_b32 v5, v3
    s_nop 0
    v_permlane16_swap_b32 v2, v4
    v_permlane16_swap_b32 v3, v5
    v_add_f32 v2, v2, v4
    v_add_f32 v3, v3, v5
    v_mov_b32 v4, v2
    v_mov_b32 v5, v3
    s_nop 0
    v_permlane32_swap_b32 v2, v4
    v_permlane32_swap_b32 v3, v5
    v_add_f32 v2, v2, v4
    v_add_f32 v3, v3, v5
    v_mul_f32 v4, 0xbacccccd, v3
    v_fma_f32 v2, v4, v3, v2
    v_max_f32 v92, 0, v2
    s_lshl_b32 s40, s28, 7
    s_mul_i32 s48, s26, 665600
    s_add_u32 s40, s40, s48
    s_add_u32 s40, s40, 0x0
    s_add_u32 s41, s40, 133120
    s_add_u32 s42, s41, 133120
    s_add_u32 s43, s42, 133120
    s_add_u32 s44, s43, 133120
SC_e35:
PAD_16:
    s_cbranch_execz SC_ret
    s_lshl_b32 s48, s26, 5
    v_lshrrev_b32 v4, 4, v1
    v_lshl_add_u32 v87, v4, 8, v7
    v_add_u32 v87, s48, v87
    v_and_b32 v5, 7, v1
    v_lshlrev_b32 v5, 4, v5
    v_lshrrev_b32 v4, 3, v1
    v_mul_u32_u24 v89, 16640, v4
    v_add_u32 v89, v89, v5
    v_mov_b32 v90, v89
K1_core:
    buffer_load_dword v248, v249, s[60:63], 0 offen sc1
    s_waitcnt lgkmcnt(14)
    v_mfma_f32_16x16x32_bf16 v[216:219], v[184:187], v[96:99], 0
    v_mfma_f32_16x16x32_bf16 v[220:223], v[184:187], v[100:103], 0
    s_waitcnt lgkmcnt(12)
    v_mfma_f32_16x16x32_bf16 v[224:227], v[188:191], v[96:99], 0
    v_mfma_f32_16x16x32_bf16 v[228:231], v[188:191], v[100:103], 0
    s_waitcnt lgkmcnt(10)
    v_mfma_f32_16x16x32_bf16 v[232:235], v[192:195], v[96:99], 0
    v_mfma_f32_16x16x32_bf16 v[236:239], v[192:195], v[100:103], 0
    s_waitcnt lgkmcnt(8)
    v_mfma_f32_16x16x32_bf16 v[240:243], v[196:199], v[96:99], 0
    v_mfma_f32_16x16x32_bf16 v[244:247], v[196:199], v[100:103], 0
    v_mul_f32 v2, v216, v104
    v_mul_f32 v4, v216, v105
    v_fma_f32 v2, -v220, v105, v2
    v_fma_f32 v4, v220, v104, v4
    v_mul_f32 v3, v224, v106
    v_mul_f32 v5, v224, v107
    v_fma_f32 v3, -v228, v107, v3
    v_fma_f32 v5, v228, v106, v5
    v_cvt_pk_bf16_f32 v152, v2, v3
    v_cvt_pk_bf16_f32 v156, v4, v5
    v_mul_f32 v2, v217, v104
    v_mul_f32 v4, v217, v105
    v_fma_f32 v2, -v221, v105, v2
    v_fma_f32 v4, v221, v104, v4
    v_mul_f32 v3, v225, v106
    v_mul_f32 v5, v225, v107
    v_fma_f32 v3, -v229, v107, v3
    v_fma_f32 v5, v229, v106, v5
    v_cvt_pk_bf16_f32 v160, v2, v3
SC_e51:
PAD_17:
    s_cbranch_execz SC_ret
    v_cvt_pk_bf16_f32 v164, v4, v5
    v_mul_f32 v2, v218, v104
    v_mul_f32 v4, v218, v105
    v_fma_f32 v2, -v222, v105, v2
    v_fma_f32 v4, v222, v104, v4
    v_mul_f32 v3, v226, v106
    v_mul_f32 v5, v226, v107
    v_fma_f32 v3, -v230, v107, v3
    v_fma_f32 v5, v230, v106, v5
    v_cvt_pk_bf16_f32 v168, v2, v3
    v_cvt_pk_bf16_f32 v172, v4, v5
    v_mul_f32 v2, v219, v104
    v_mul_f32 v4, v219, v105
    v_fma_f32 v2, -v223, v105, v2
    v_fma_f32 v4, v223, v104, v4
    v_mul_f32 v3, v227, v106
    v_mul_f32 v5, v227, v107
    v_fma_f32 v3, -v231, v107, v3
    v_fma_f32 v5, v231, v106, v5
    v_cvt_pk_bf16_f32 v176, v2, v3
    v_cvt_pk_bf16_f32 v180, v4, v5
    s_waitcnt lgkmcnt(6)
    v_mfma_f32_16x16x32_bf16 v[216:219], v[200:203], v[96:99], 0
    v_mfma_f32_16x16x32_bf16 v[220:223], v[200:203], v[100:103], 0
    s_waitcnt lgkmcnt(4)
    v_mfma_f32_16x16x32_bf16 v[224:227], v[204:207], v[96:99], 0
    v_mfma_f32_16x16x32_bf16 v[228:231], v[204:207], v[100:103], 0
    v_mul_f32 v2, v232, v108
    v_mul_f32 v4, v232, v109
    v_fma_f32 v2, -v236, v109, v2
    v_fma_f32 v4, v236, v108, v4
    v_mul_f32 v3, v240, v110
    v_mul_f32 v5, v240, v111
    v_fma_f32 v3, -v244, v111, v3
    v_fma_f32 v5, v244, v110, v5
    v_cvt_pk_bf16_f32 v153, v2, v3
    v_cvt_pk_bf16_f32 v157, v4, v5
    v_mul_f32 v2, v233, v108
    v_mul_f32 v4, v233, v109
SC_e4:
PAD_18:
    s_cbranch_execz SC_ret
    v_fma_f32 v2, -v237, v109, v2
    v_fma_f32 v4, v237, v108, v4
    v_mul_f32 v3, v241, v110
    v_mul_f32 v5, v241, v111
    v_fma_f32 v3, -v245, v111, v3
    v_fma_f32 v5, v245, v110, v5
    v_cvt_pk_bf16_f32 v161, v2, v3
    v_cvt_pk_bf16_f32 v165, v4, v5
    v_mul_f32 v2, v234, v108
    v_mul_f32 v4, v234, v109
    v_fma_f32 v2, -v238, v109, v2
    v_fma_f32 v4, v238, v108, v4
    v_mul_f32 v3, v242, v110
    v_mul_f32 v5, v242, v111
    v_fma_f32 v3, -v246, v111, v3
    v_fma_f32 v5, v246, v110, v5
    v_cvt_pk_bf16_f32 v169, v2, v3
    v_cvt_pk_bf16_f32 v173, v4, v5
    v_mul_f32 v2, v235, v108
    v_mul_f32 v4, v235, v109
    v_fma_f32 v2, -v239, v109, v2
    v_fma_f32 v4, v239, v108, v4
    v_mul_f32 v3, v243, v110
    v_mul_f32 v5, v243, v111
    v_fma_f32 v3, -v247, v111, v3
    v_fma_f32 v5, v247, v110, v5
    v_cvt_pk_bf16_f32 v177, v2, v3
    v_cvt_pk_bf16_f32 v181, v4, v5
    s_waitcnt lgkmcnt(2)
    v_mfma_f32_16x16x32_bf16 v[232:235], v[208:211], v[96:99], 0
    v_mfma_f32_16x16x32_bf16 v[236:239], v[208:211], v[100:103], 0
    s_waitcnt lgkmcnt(0)
    v_mfma_f32_16x16x32_bf16 v[240:243], v[212:215], v[96:99], 0
    v_mfma_f32_16x16x32_bf16 v[244:247], v[212:215], v[100:103], 0
    v_mul_f32 v2, v216, v112
    v_mul_f32 v4, v216, v113
    v_fma_f32 v2, -v220, v113, v2
    v_fma_f32 v4, v220, v112, v4
    v_mul_f32 v3, v224, v114
SC_e20:
PAD_19:
    s_cbranch_execz PAD_20
    v_mul_f32 v5, v224, v115
    v_fma_f32 v3, -v228, v115, v3
    v_fma_f32 v5, v228, v114, v5
    v_cvt_pk_bf16_f32 v154, v2, v3
    v_cvt_pk_bf16_f32 v158, v4, v5
    v_mul_f32 v2, v217, v112
    v_mul_f32 v4, v217, v113
    v_fma_f32 v2, -v221, v113, v2
    v_fma_f32 v4, v221, v112, v4
    v_mul_f32 v3, v225, v114
    v_mul_f32 v5, v225, v115
    v_fma_f32 v3, -v229, v115, v3
    v_fma_f32 v5, v229, v114, v5
    v_cvt_pk_bf16_f32 v162, v2, v3
    v_cvt_pk_bf16_f32 v166, v4, v5
    v_mul_f32 v2, v218, v112
    v_mul_f32 v4, v218, v113
    v_fma_f32 v2, -v222, v113, v2
    v_fma_f32 v4, v222, v112, v4
    v_mul_f32 v3, v226, v114
    v_mul_f32 v5, v226, v115
    v_fma_f32 v3, -v230, v115, v3
    v_fma_f32 v5, v230, v114, v5
    v_cvt_pk_bf16_f32 v170, v2, v3
    v_cvt_pk_bf16_f32 v174, v4, v5
    v_mul_f32 v2, v219, v112
    v_mul_f32 v4, v219, v113
    v_fma_f32 v2, -v223, v113, v2
    v_fma_f32 v4, v223, v112, v4
    v_mul_f32 v3, v227, v114
    v_mul_f32 v5, v227, v115
    v_fma_f32 v3, -v231, v115, v3
    v_fma_f32 v5, v231, v114, v5
    v_cvt_pk_bf16_f32 v178, v2, v3
    v_cvt_pk_bf16_f32 v182, v4, v5
    v_mul_f32 v2, v232, v116
    v_mul_f32 v4, v232, v117
    v_fma_f32 v2, -v236, v117, v2
    v_fma_f32 v4, v236, v116, v4
PAD_20:
    s_cbranch_execz SC_ret
    v_mul_f32 v3, v240, v118
    v_mul_f32 v5, v240, v119
    v_fma_f32 v3, -v244, v119, v3
    v_fma_f32 v5, v244, v118, v5
    v_cvt_pk_bf16_f32 v155, v2, v3
    v_cvt_pk_bf16_f32 v159, v4, v5
    v_mul_f32 v2, v233, v116
    v_mul_f32 v4, v233, v117
    v_fma_f32 v2, -v237, v117, v2
    v_fma_f32 v4, v237, v116, v4
    v_mul_f32 v3, v241, v118
    v_mul_f32 v5, v241, v119
    v_fma_f32 v3, -v245, v119, v3
    v_fma_f32 v5, v245, v118, v5
    v_cvt_pk_bf16_f32 v163, v2, v3
    v_cvt_pk_bf16_f32 v167, v4, v5
    v_mul_f32 v2, v234, v116
    v_mul_f32 v4, v234, v117
    v_fma_f32 v2, -v238, v117, v2
    v_fma_f32 v4, v238, v116, v4
    v_mul_f32 v3, v242, v118
    v_mul_f32 v5, v242, v119
    v_fma_f32 v3, -v246, v119, v3
    v_fma_f32 v5, v246, v118, v5
    v_cvt_pk_bf16_f32 v171, v2, v3
    v_cvt_pk_bf16_f32 v175, v4, v5
    v_mul_f32 v2, v235, v116
    v_mul_f32 v4, v235, v117
    v_fma_f32 v2, -v239, v117, v2
    v_fma_f32 v4, v239, v116, v4
    v_mul_f32 v3, v243, v118
    v_mul_f32 v5, v243, v119
    v_fma_f32 v3, -v247, v119, v3
    v_fma_f32 v5, v247, v118, v5
    v_cvt_pk_bf16_f32 v179, v2, v3
    v_cvt_pk_bf16_f32 v183, v4, v5
    v_mfma_f32_16x16x32_bf16 v[184:187], v[120:123], v[152:155], 0
    v_mfma_f32_16x16x32_bf16 v[188:191], v[128:131], v[152:155], 0
    v_mfma_f32_16x16x32_bf16 v[192:195], v[136:139], v[152:155], 0
SC_e36:
PAD_21:
    s_cbranch_execz SC_ret
    v_mfma_f32_16x16x32_bf16 v[196:199], v[144:147], v[152:155], 0
    v_mfma_f32_16x16x32_bf16 v[184:187], v[124:127], v[156:159], v[184:187]
    v_mfma_f32_16x16x32_bf16 v[188:191], v[132:135], v[156:159], v[188:191]
    v_mfma_f32_16x16x32_bf16 v[192:195], v[140:143], v[156:159], v[192:195]
    v_mfma_f32_16x16x32_bf16 v[196:199], v[148:151], v[156:159], v[196:199]
    v_mfma_f32_16x16x32_bf16 v[200:203], v[120:123], v[160:163], 0
    v_mfma_f32_16x16x32_bf16 v[204:207], v[128:131], v[160:163], 0
    v_mfma_f32_16x16x32_bf16 v[208:211], v[136:139], v[160:163], 0
    v_mfma_f32_16x16x32_bf16 v[212:215], v[144:147], v[160:163], 0
    v_mfma_f32_16x16x32_bf16 v[200:203], v[124:127], v[164:167], v[200:203]
    v_mfma_f32_16x16x32_bf16 v[204:207], v[132:135], v[164:167], v[204:207]
    v_mfma_f32_16x16x32_bf16 v[208:211], v[140:143], v[164:167], v[208:211]
    v_mfma_f32_16x16x32_bf16 v[212:215], v[148:151], v[164:167], v[212:215]
    v_mfma_f32_16x16x32_bf16 v[216:219], v[120:123], v[168:171], 0
    v_mfma_f32_16x16x32_bf16 v[220:223], v[128:131], v[168:171], 0
    v_mfma_f32_16x16x32_bf16 v[224:227], v[136:139], v[168:171], 0
    v_mfma_f32_16x16x32_bf16 v[228:231], v[144:147], v[168:171], 0
    v_mfma_f32_16x16x32_bf16 v[216:219], v[124:127], v[172:175], v[216:219]
    v_mfma_f32_16x16x32_bf16 v[220:223], v[132:135], v[172:175], v[220:223]
    v_mfma_f32_16x16x32_bf16 v[224:227], v[140:143], v[172:175], v[224:227]
    v_mfma_f32_16x16x32_bf16 v[228:231], v[148:151], v[172:175], v[228:231]
    v_mfma_f32_16x16x32_bf16 v[232:235], v[120:123], v[176:179], 0
    v_mfma_f32_16x16x32_bf16 v[236:239], v[128:131], v[176:179], 0
    v_mfma_f32_16x16x32_bf16 v[240:243], v[136:139], v[176:179], 0
    v_mfma_f32_16x16x32_bf16 v[244:247], v[144:147], v[176:179], 0
    v_mfma_f32_16x16x32_bf16 v[232:235], v[124:127], v[180:183], v[232:235]
    v_mfma_f32_16x16x32_bf16 v[236:239], v[132:135], v[180:183], v[236:239]
    v_mfma_f32_16x16x32_bf16 v[240:243], v[140:143], v[180:183], v[240:243]
    v_mfma_f32_16x16x32_bf16 v[244:247], v[148:151], v[180:183], v[244:247]
    v_mul_f32 v184, v184, v91
    v_mul_f32 v2, 0x3f3504f3, v192
    v_cndmask_b32 v185, v185, v2, vcc
SC_e52:
PAD_22:
    s_cbranch_execz SC_ret
    v_mul_f32 v200, v200, v91
    v_mul_f32 v2, 0x3f3504f3, v208
    v_cndmask_b32 v201, v201, v2, vcc
    v_mul_f32 v216, v216, v91
    v_mul_f32 v2, 0x3f3504f3, v224
    v_cndmask_b32 v217, v217, v2, vcc
    v_mul_f32 v232, v232, v91
    v_mul_f32 v2, 0x3f3504f3, v240
    v_cndmask_b32 v233, v233, v2, vcc
    s_cmp_eq_u32 s27, 1
    s_cbranch_scc1 K1_st1
    s_cmp_lg_u32 s27, 0
    s_cbranch_scc1 K1_st2
    s_mov_b32 exec_lo, 0x7ff07ff
    s_mov_b32 exec_hi, 0x7ff07ff
    v_add_u32 v184, 0x10000, v184
    v_and_b32 v184, 0xfffe0000, v184
    v_add_u32 v185, 0x10000, v185
    v_and_b32 v185, 0xfffe0000, v185
    v_cvt_pk_bf16_f32 v152, v184, v185
    v_cvt_pk_bf16_f32 v153, v186, v187
    v_cvt_pk_bf16_f32 v154, v200, v201
    v_cvt_pk_bf16_f32 v155, v202, v203
    v_add_u32 v216, 0x10000, v216
    v_and_b32 v216, 0xfffe0000, v216
    v_add_u32 v217, 0x10000, v217
    v_and_b32 v217, 0xfffe0000, v217
    v_cvt_pk_bf16_f32 v156, v216, v217
    v_cvt_pk_bf16_f32 v157, v218, v219
    v_cvt_pk_bf16_f32 v158, v232, v233
    v_cvt_pk_bf16_f32 v159, v234, v235
    ds_write_b128 v87, v[152:155] offset:21760
    ds_write_b128 v87, v[156:159] offset:21776
    v_add_u32 v188, 0x10000, v188
    v_and_b32 v188, 0xfffe0000, v188
    v_add_u32 v189, 0x10000, v189
    v_and_b32 v189, 0xfffe0000, v189
SC_e5:
PAD_23:
    s_cbranch_execz SC_ret
    v_cvt_pk_bf16_f32 v160, v188, v189
    v_cvt_pk_bf16_f32 v161, v190, v191
    v_cvt_pk_bf16_f32 v162, v204, v205
    v_cvt_pk_bf16_f32 v163, v206, v207
    v_add_u32 v220, 0x10000, v220
    v_and_b32 v220, 0xfffe0000, v220
    v_add_u32 v221, 0x10000, v221
    v_and_b32 v221, 0xfffe0000, v221
    v_cvt_pk_bf16_f32 v164, v220, v221
    v_cvt_pk_bf16_f32 v165, v222, v223
    v_cvt_pk_bf16_f32 v166, v236, v237
    v_cvt_pk_bf16_f32 v167, v238, v239
    ds_write_b128 v87, v[160:163] offset:21888
    ds_write_b128 v87, v[164:167] offset:21904
    s_mov_b32 exec_lo, 0x3fe03fe
    s_mov_b32 exec_hi, 0x3fe03fe
    v_add_u32 v192, 0x10000, v192
    v_and_b32 v192, 0xfffe0000, v192
    v_add_u32 v193, 0x10000, v193
    v_and_b32 v193, 0xfffe0000, v193
    v_cvt_pk_bf16_f32 v168, v192, -v193
    v_cvt_pk_bf16_f32 v169, v194, -v195
    v_cvt_pk_bf16_f32 v170, v208, -v209
    v_cvt_pk_bf16_f32 v171, v210, -v211
    v_add_u32 v224, 0x10000, v224
    v_and_b32 v224, 0xfffe0000, v224
    v_add_u32 v225, 0x10000, v225
    v_and_b32 v225, 0xfffe0000, v225
    v_cvt_pk_bf16_f32 v172, v224, -v225
    v_cvt_pk_bf16_f32 v173, v226, -v227
    v_cvt_pk_bf16_f32 v174, v240, -v241
SC_e21:
PAD_24:
    s_cbranch_execz SC_ret
    v_cvt_pk_bf16_f32 v175, v242, -v243
    ds_write_b128 v87, v[168:171] offset:32160
    ds_write_b128 v87, v[172:175] offset:32176
    v_add_u32 v196, 0x10000, v196
    v_and_b32 v196, 0xfffe0000, v196
    v_add_u32 v197, 0x10000, v197
    v_and_b32 v197, 0xfffe0000, v197
    v_cvt_pk_bf16_f32 v176, v196, -v197
    v_cvt_pk_bf16_f32 v177, v198, -v199
    v_cvt_pk_bf16_f32 v178, v212, -v213
    v_cvt_pk_bf16_f32 v179, v214, -v215
    v_add_u32 v228, 0x10000, v228
    v_and_b32 v228, 0xfffe0000, v228
    v_add_u32 v229, 0x10000, v229
    v_and_b32 v229, 0xfffe0000, v229
    v_cvt_pk_bf16_f32 v180, v228, -v229
    v_cvt_pk_bf16_f32 v181, v230, -v231
    v_cvt_pk_bf16_f32 v182, v244, -v245
    v_cvt_pk_bf16_f32 v183, v246, -v247
    ds_write_b128 v87, v[176:179] offset:32288
    ds_write_b128 v87, v[180:183] offset:32304
K1_out:
    s_mov_b64 exec, -1
    s_mul_i32 s48, s26, 5200
    v_lshlrev_b32 v2, 4, v1
    v_add_u32 v2, s48, v2
    v_mov_b32 v7, 8
    s_cmp_ge_u32 s2, 128
    s_cbranch_scc1 skip_3
    s_waitcnt vmcnt(0)
    v_readfirstlane_b32 s57, v248
    s_nop 3
    s_or_b32 s57, s57, s26
    s_cmp_eq_u32 s57, 0
    s_cbranch_scc1 flg_retry_5
flg_4:
skip_3:
    s_waitcnt lgkmcnt(0)
    s_barrier
    ds_read_b128 v[184:187], v2 offset:21760
    ds_read_b128 v[188:191], v2 offset:22800
SC_e37:
PAD_25:
    s_cbranch_execz PAD_26
    ds_read_b128 v[192:195], v2 offset:23840
    ds_read_b128 v[196:199], v2 offset:24880
    ds_read_b128 v[200:203], v2 offset:25920
    buffer_store_dword v7, v95, s[32:35], s59 offen sc1
    buffer_load_dwordx4 v[252:255], v251, s[32:35], s101 offen sc1
    buffer_store_dword v92, v93, s[32:35], 0 offen sc1
    s_waitcnt lgkmcnt(4)
    buffer_store_dwordx4 v[184:187], v89, s[32:35], s40 offen sc1
    s_waitcnt lgkmcnt(3)
    buffer_store_dwordx4 v[188:191], v89, s[32:35], s41 offen sc1
    s_waitcnt lgkmcnt(2)
    buffer_store_dwordx4 v[192:195], v90, s[32:35], s42 offen sc1
    s_waitcnt lgkmcnt(1)
    buffer_store_dwordx4 v[196:199], v89, s[32:35], s43 offen sc1
    s_waitcnt lgkmcnt(0)
    buffer_store_dwordx4 v[200:203], v89, s[32:35], s44 offen sc1
    s_cmp_ge_u32 s2, 160
    s_cbranch_scc1 K1_more
    s_cmp_lt_u32 s2, 128
    s_cbranch_scc1 skip_8
    v_mov_b32 v7, 8
    s_waitcnt vmcnt(0)
    v_readfirstlane_b32 s57, v248
    s_nop 3
    s_or_b32 s57, s57, s26
    s_cmp_eq_u32 s57, 0
    s_cbranch_scc1 flg_retry_10
flg_9:
    s_barrier
    buffer_store_dword v7, v94, s[32:35], s59 offen sc1
skip_8:
K1_done:
    v_lshlrev_b32 v2, 4, v1
    s_bfe_u32 s27, s2, 0x20001
    s_lshl_b32 s27, s27, 3
    s_bfe_u32 s28, s2, 0x30003
    s_add_u32 s27, s27, s28
    s_lshr_b32 s28, s2, 6
    s_lshl_b32 s28, s28, 1
    s_and_b32 s48, s2, 1
    s_add_u32 s28, s28, s48
    s_mov_b32 s36, s14
    s_and_b32 s37, s15, 0xffff
    s_mov_b32 s38, 0xd80
    s_mov_b32 s39, 0x00020000
    s_mov_b32 s40, s20
    s_and_b32 s41, s21, 0xffff
PAD_26:
    s_cbranch_execz SC_ret
    s_mov_b32 s42, 0x280000
    s_mov_b32 s43, 0x00020000
    s_mov_b32 s44, s18
    s_and_b32 s45, s19, 0xffff
    s_mov_b32 s46, 0x500
    s_mov_b32 s47, 0x00020000
    s_mov_b32 s18, s59
    v_mov_b32 v3, 0xfffe0000
    s_lshr_b32 s48, s28, 1
    s_mul_i32 s48, s48, 14
    s_add_u32 s48, s48, s26
    s_and_b32 s49, s28, 1
    s_lshl_b32 s29, s49, 2
    s_add_u32 s29, s29, s48
    s_cmp_lt_u32 s28, 6
    s_cselect_b32 s30, 3, 2
    s_mul_i32 s49, s49, s30
    s_add_u32 s31, s48, s49
    s_add_u32 s31, s31, 8
    s_cmp_lt_u32 s26, s30
    s_cselect_b32 s30, 1, 0
    s_cmp_eq_u32 s2, 0
    s_cselect_b32 s54, 0x0c0c0c0c, 0
    s_cselect_b32 s54, s54, 0x01000c0c
    s_cselect_b32 s56, 0, 1.0
    s_mov_b32 s57, 1.0
    s_mov_b32 s63, 0
    s_mov_b32 s60, 0x1
    s_mov_b32 s15, 0x10000
    s_mov_b32 s16, 0x0
    s_mov_b32 s17, 0x4
    s_mul_i32 s53, s27, 221184
    s_add_u32 s53, s53, 0xc8b000
    s_mul_i32 s14, s28, 276480
    s_mul_i32 s48, s26, 71680
    s_add_u32 s14, s14, s48
    s_add_u32 s14, s14, 0x514000
L_layer:
    v_lshrrev_b32 v5, 3, v1
    v_and_b32 v4, 0x70, v2
    v_lshl_or_b32 v5, v5, 8, v4
    s_mul_i32 s48, s29, 40960
    v_add_u32 v4, s48, v5
    s_mul_i32 s48, s31, 40960
    s_cmp_eq_u32 s30, 0
SC_e53:
PAD_27:
    s_cbranch_execz SC_ret
    s_cselect_b32 s48, 0x40000000, s48
    v_add_u32 v5, s48, v5
    s_cmp_ge_u32 s2, 160
    s_cbranch_scc1 L_nocol
    s_mov_b32 s61, 0x3bd1b717
    s_cmp_lg_u32 s63, 0
    s_cbranch_scc1 col_chk_11_first
    v_sub_u32 v251, 7, v1
    v_and_b32 v251, 0x40000000, v251
    v_lshl_add_u32 v251, v1, 7, v251
    v_add_u32 v251, 0xb7f000, v251
    s_lshl_b32 s48, s26, 10
    v_add_u32 v251, s48, v251
    v_and_b32 v184, 15, v1
    v_lshlrev_b32 v185, 2, v184
    v_add_u32 v185, s26, v185
    v_cvt_f32_ubyte0 v188, v185
    v_lshrrev_b32 v185, 4, v1
    v_cvt_f32_ubyte0 v189, v185
    v_mul_f32 v186, v188, v189
    v_mul_f32 v187, 0x3d800000, v186
    v_fmamk_f32 v184, v188, 0x00000000, v187
    v_cos_f32 v120, v184
    v_sin_f32 v128, v184
    v_fmamk_f32 v184, v188, 0x3c800000, v187
    v_cos_f32 v121, v184
    v_sin_f32 v129, v184
    v_fmamk_f32 v184, v188, 0x3d000000, v187
    v_cos_f32 v122, v184
    v_sin_f32 v130, v184
    v_fmamk_f32 v184, v188, 0x3d400000, v187
    v_cos_f32 v123, v184
    v_sin_f32 v131, v184
    v_cvt_pk_bf16_f32 v8, v120, v128
    v_cvt_pk_bf16_f32 v12, -v128, v120
    v_cvt_pk_bf16_f32 v9, v121, v129
    v_cvt_pk_bf16_f32 v13, -v129, v121
    v_cvt_pk_bf16_f32 v10, v122, v130
    v_cvt_pk_bf16_f32 v14, -v130, v122
    v_cvt_pk_bf16_f32 v11, v123, v131
    v_cvt_pk_bf16_f32 v15, -v131, v123
    v_mul_f32 v187, 0xbb800000, v186
    v_fmamk_f32 v184, v188, 0x00000000, v187
    v_cos_f32 v16, v184
SC_e6:
PAD_28:
    s_cbranch_execz SC_ret
    v_sin_f32 v24, v184
    v_fmamk_f32 v184, v188, 0xba000000, v187
    v_cos_f32 v17, v184
    v_sin_f32 v25, v184
    v_fmamk_f32 v184, v188, 0xba800000, v187
    v_cos_f32 v18, v184
    v_sin_f32 v26, v184
    v_fmamk_f32 v184, v188, 0xbac00000, v187
    v_cos_f32 v19, v184
    v_sin_f32 v27, v184
    v_fmamk_f32 v184, v188, 0xbb000000, v187
    v_cos_f32 v20, v184
    v_sin_f32 v28, v184
    v_fmamk_f32 v184, v188, 0xbb200000, v187
    v_cos_f32 v21, v184
    v_sin_f32 v29, v184
    v_fmamk_f32 v184, v188, 0xbb400000, v187
    v_cos_f32 v22, v184
    v_sin_f32 v30, v184
    v_fmamk_f32 v184, v188, 0xbb600000, v187
    v_cos_f32 v23, v184
    v_sin_f32 v31, v184
    v_and_b32 v184, 15, v1
    v_and_b32 v185, 12, v1
    v_add_u32 v184, v184, v185
    v_cvt_f32_ubyte0 v190, v184
    v_mul_f32 v186, v190, v189
    v_mul_f32 v187, 0x3e800000, v186
    v_fmamk_f32 v184, v190, 0x00000000, v187
    v_cos_f32 v120, v184
    v_sin_f32 v128, v184
    v_fmamk_f32 v184, v190, 0x3d000000, v187
    v_cos_f32 v121, v184
    v_sin_f32 v129, v184
    v_fmamk_f32 v184, v190, 0x3d800000, v187
    v_cos_f32 v122, v184
    v_sin_f32 v130, v184
    v_fmamk_f32 v184, v190, 0x3dc00000, v187
    v_cos_f32 v123, v184
    v_sin_f32 v131, v184
    v_fmamk_f32 v184, v190, 0x3e000000, v187
    v_cos_f32 v124, v184
    v_sin_f32 v132, v184
    v_fmamk_f32 v184, v190, 0x3e200000, v187
    v_cos_f32 v125, v184
    v_sin_f32 v133, v184
    v_fmamk_f32 v184, v190, 0x3e400000, v187
    v_cos_f32 v126, v184
SC_e22:
PAD_29:
    s_cbranch_execz SC_ret
    v_sin_f32 v134, v184
    v_fmamk_f32 v184, v190, 0x3e600000, v187
    v_cos_f32 v127, v184
    v_sin_f32 v135, v184
    v_cvt_pk_bf16_f32 v32, v120, v121
    v_cvt_pk_bf16_f32 v40, v128, v129
    v_cvt_pk_bf16_f32 v48, -v128, -v129
    v_cvt_pk_bf16_f32 v33, v122, v123
    v_cvt_pk_bf16_f32 v41, v130, v131
    v_cvt_pk_bf16_f32 v49, -v130, -v131
    v_cvt_pk_bf16_f32 v34, v124, v125
    v_cvt_pk_bf16_f32 v42, v132, v133
    v_cvt_pk_bf16_f32 v50, -v132, -v133
    v_cvt_pk_bf16_f32 v35, v126, v127
    v_cvt_pk_bf16_f32 v43, v134, v135
    v_cvt_pk_bf16_f32 v51, -v134, -v135
    v_add_f32 v191, 4.0, v190
    v_mul_f32 v186, v191, v189
    v_mul_f32 v187, 0x3e800000, v186
    v_fmamk_f32 v184, v191, 0x00000000, v187
    v_cos_f32 v120, v184
    v_sin_f32 v128, v184
    v_fmamk_f32 v184, v191, 0x3d000000, v187
    v_cos_f32 v121, v184
    v_sin_f32 v129, v184
    v_fmamk_f32 v184, v191, 0x3d800000, v187
    v_cos_f32 v122, v184
    v_sin_f32 v130, v184
    v_fmamk_f32 v184, v191, 0x3dc00000, v187
    v_cos_f32 v123, v184
    v_sin_f32 v131, v184
    v_fmamk_f32 v184, v191, 0x3e000000, v187
    v_cos_f32 v124, v184
    v_sin_f32 v132, v184
    v_fmamk_f32 v184, v191, 0x3e200000, v187
    v_cos_f32 v125, v184
    v_sin_f32 v133, v184
    v_fmamk_f32 v184, v191, 0x3e400000, v187
    v_cos_f32 v126, v184
    v_sin_f32 v134, v184
    v_fmamk_f32 v184, v191, 0x3e600000, v187
SC_e38:
PAD_30:
    s_cbranch_execz SC_ret
    v_cos_f32 v127, v184
    v_sin_f32 v135, v184
    v_cvt_pk_bf16_f32 v36, v120, v121
    v_cvt_pk_bf16_f32 v44, v128, v129
    v_cvt_pk_bf16_f32 v52, -v128, -v129
    v_cvt_pk_bf16_f32 v37, v122, v123
    v_cvt_pk_bf16_f32 v45, v130, v131
    v_cvt_pk_bf16_f32 v53, -v130, -v131
    v_cvt_pk_bf16_f32 v38, v124, v125
    v_cvt_pk_bf16_f32 v46, v132, v133
    v_cvt_pk_bf16_f32 v54, -v132, -v133
    v_cvt_pk_bf16_f32 v39, v126, v127
    v_cvt_pk_bf16_f32 v47, v134, v135
    v_cvt_pk_bf16_f32 v55, -v134, -v135
    buffer_load_dwordx4 v[252:255], v251, s[32:35], s101 offen sc1
    v_cvt_f32_ubyte0 v184, s26
    v_fmamk_f32 v188, v189, 0x41800000, v184
    v_mul_f32 v186, v190, v188
    v_mul_f32 v187, 0x3a000000, v186
    v_fmamk_f32 v184, v190, 0x00000000, v187
    v_cos_f32 v56, v184
    v_sin_f32 v64, v184
    v_fmamk_f32 v184, v190, 0x3b000000, v187
    v_cos_f32 v57, v184
    v_sin_f32 v65, v184
    v_fmamk_f32 v184, v190, 0x3b800000, v187
    v_cos_f32 v58, v184
    v_sin_f32 v66, v184
    v_fmamk_f32 v184, v190, 0x3bc00000, v187
    v_cos_f32 v59, v184
    v_sin_f32 v67, v184
    v_mul_f32 v186, v191, v188
    v_mul_f32 v187, 0x3a000000, v186
    v_fmamk_f32 v184, v191, 0x00000000, v187
    v_cos_f32 v60, v184
    v_sin_f32 v68, v184
    v_fmamk_f32 v184, v191, 0x3b000000, v187
    v_cos_f32 v61, v184
    v_sin_f32 v69, v184
    v_fmamk_f32 v184, v191, 0x3b800000, v187
SC_e54:
PAD_31:
    s_cbranch_execz PAD_32
    v_cos_f32 v62, v184
    v_sin_f32 v70, v184
    v_fmamk_f32 v184, v191, 0x3bc00000, v187
    v_cos_f32 v63, v184
    v_sin_f32 v71, v184
    v_bfe_u32 v184, v1, 1, 3
    v_cvt_f32_ubyte0 v190, v184
    v_and_b32 v184, 1, v1
    v_cvt_f32_ubyte0 v185, v184
    v_mul_f32 v185, 0xbe800000, v185
    v_mul_f32 v186, v190, v188
    v_fmamk_f32 v187, v186, 0x3c800000, v185
    v_fmamk_f32 v184, v190, 0x00000000, v187
    v_cos_f32 v120, v184
    v_sin_f32 v128, v184
    v_fmamk_f32 v184, v190, 0x3d800000, v187
    v_cos_f32 v121, v184
    v_sin_f32 v129, v184
    v_fmamk_f32 v184, v190, 0x3e000000, v187
    v_cos_f32 v122, v184
    v_sin_f32 v130, v184
    v_fmamk_f32 v184, v190, 0x3e400000, v187
    v_cos_f32 v123, v184
    v_sin_f32 v131, v184
    v_cvt_pk_bf16_f32 v72, v120, -v128
    v_cvt_pk_bf16_f32 v73, v121, -v129
    v_cvt_pk_bf16_f32 v74, v122, -v130
    v_cvt_pk_bf16_f32 v75, v123, -v131
    v_add_f32 v190, 0x41000000, v190
    v_mul_f32 v186, v190, v188
    v_fmamk_f32 v187, v186, 0x3c800000, v185
    v_fmamk_f32 v184, v190, 0x00000000, v187
    v_cos_f32 v120, v184
    v_sin_f32 v128, v184
    v_fmamk_f32 v184, v190, 0x3d800000, v187
    v_cos_f32 v121, v184
    v_sin_f32 v129, v184
    v_fmamk_f32 v184, v190, 0x3e000000, v187
    v_cos_f32 v122, v184
    v_sin_f32 v130, v184
    v_fmamk_f32 v184, v190, 0x3e400000, v187
    v_cos_f32 v123, v184
    v_sin_f32 v131, v184
    v_cvt_pk_bf16_f32 v76, v120, -v128
PAD_32:
    s_cbranch_execz SC_ret
    v_cvt_pk_bf16_f32 v77, v121, -v129
    v_cvt_pk_bf16_f32 v78, v122, -v130
    v_cvt_pk_bf16_f32 v79, v123, -v131
    s_mul_i32 s48, s26, 3072
    v_add_u32 v184, 144384, v2
    v_add_u32 v185, s48, v184
    ds_write_b128 v184, v[32:35] offset:0
    ds_write_b128 v184, v[36:39] offset:1024
    ds_write_b128 v184, v[40:43] offset:2048
    ds_write_b128 v184, v[44:47] offset:3072
    ds_write_b128 v185, v[8:11] offset:4096
    ds_write_b128 v185, v[72:75] offset:5120
    ds_write_b128 v185, v[76:79] offset:6144
    v_bfe_u32 v184, v0, 1, 2
    v_bfe_u32 v185, v0, 3, 2
    s_lshl_b32 s48, s26, 2
    v_or_b32 v185, s48, v185
    v_lshlrev_b32 v186, 1, v184
    v_xor_b32 v185, v185, v186
    v_lshlrev_b32 v185, 4, v185
    v_lshl_add_u32 v185, v184, 8, v185
    v_bfe_u32 v184, v0, 5, 1
    v_lshl_add_u32 v185, v184, 10, v185
    v_and_b32 v184, 1, v0
    v_lshl_add_u32 v81, v184, 3, v185
    v_lshrrev_b32 v184, 4, v1
    v_lshlrev_b32 v185, 1, v184
    v_xor_b32 v185, v185, v1
    v_lshlrev_b32 v185, 4, v185
    s_lshl_b32 s48, s26, 12
    v_add_u32 v82, s48, v185
    v_and_b32 v185, 7, v1
    v_xor_b32 v185, v185, v184
    v_lshlrev_b32 v185, 4, v185
    v_and_b32 v184, 15, v1
    v_and_b32 v186, 12, v1
    v_add_u32 v184, v184, v186
    v_lshl_add_u32 v185, v184, 7, v185
    s_lshl_b32 s48, s26, 13
    v_add_u32 v83, s48, v185
    v_bfe_u32 v184, v0, 3, 2
    v_bfe_u32 v185, v0, 6, 1
SC_e7:
PAD_33:
    s_cbranch_execz SC_ret
    v_lshl_add_u32 v184, v185, 2, v184
    v_xor_b32 v184, v0, v184
    v_lshlrev_b32 v84, 4, v184
    s_waitcnt vmcnt(0)
    v_or3_b32 v184, v252, v253, v254
    v_bitop3_b32 v184, v184, v255, 2 bitop3:0xa8
    v_cmp_ne_u32 vcc, 0, v184
    s_nop 3
    s_cmp_lg_u64 vcc, 0
    s_cbranch_scc1 flg_retry_14
flg_13:
    buffer_load_dwordx4 v[88:91], v80, s[32:35], 0 offen offset:0 sc1
    buffer_load_dwordx4 v[92:95], v80, s[32:35], 0 offen offset:128 sc1
    buffer_load_dwordx4 v[96:99], v80, s[32:35], 0 offen offset:256 sc1
    buffer_load_dwordx4 v[100:103], v80, s[32:35], 0 offen offset:384 sc1
    s_mov_b32 s50, 0xb7c000
    buffer_load_dwordx2 v[152:153], v85, s[32:35], s50 offen offset:0 sc1
    buffer_load_dwordx2 v[154:155], v85, s[32:35], s50 offen offset:64 sc1
    buffer_load_dwordx2 v[156:157], v85, s[32:35], s50 offen offset:128 sc1
    buffer_load_dwordx2 v[158:159], v85, s[32:35], s50 offen offset:192 sc1
    v_lshrrev_b32 v184, 4, v1
    v_and_b32 v185, 15, v1
    v_lshlrev_b32 v185, 4, v185
    v_lshl_add_u32 v186, v184, 12, v185
    s_mul_i32 s48, s2, 16640
    s_lshl_b32 s49, s26, 8
    s_add_u32 s48, s48, s49
    s_add_u32 s48, s48, 0x28a000
    buffer_load_dwordx4 v[104:107], v186, s[32:35], s48 offen offset:0 sc1
    buffer_load_dwordx4 v[108:111], v186, s[32:35], s48 offen offset:1024 sc1
    buffer_load_dwordx4 v[112:115], v186, s[32:35], s48 offen offset:2048 sc1
    buffer_load_dwordx4 v[116:119], v186, s[32:35], s48 offen offset:3072 sc1
col_chk_110:
    s_waitcnt vmcnt(9)
    v_or3_b32 v184, v88, v92, v96
    s_waitcnt vmcnt(8)
    v_bitop3_b32 v184, v184, v100, s15 bitop3:0xa8
    v_cmp_ne_u32 s[48:49], 0, v184
    s_waitcnt vmcnt(6)
    v_or3_b32 v184, v152, v153, v154
    s_waitcnt vmcnt(5)
    v_or3_b32 v185, v155, v156, v157
SC_e23:
PAD_34:
    s_cbranch_execz SC_ret
    s_waitcnt vmcnt(4)
    v_or3_b32 v184, v184, v158, v159
    v_or_b32 v184, v184, v185
    v_cmp_gt_i32 vcc, 0, v184
    s_nop 3
    s_or_b64 s[4:5], vcc, s[48:49]
    s_cbranch_scc1 col_retry_120
col_chk_110_ok:
    s_lshr_b32 s48, s29, 1
    s_lshr_b32 s49, s31, 1
    s_sub_u32 s49, s49, s48
    s_lshl_b32 s48, s48, 7
    s_lshl_b32 s49, s49, 7
    s_add_u32 s48, s48, 0xb80000
    v_sub_u32 v251, 1, v1
    v_and_b32 v251, 0x40000000, v251
    v_mad_u32_u24 v251, v1, s49, v251
    v_add_u32 v251, s48, v251
    buffer_load_dwordx4 v[252:255], v251, s[32:35], s101 offen sc1
    v_add_f32 v184, s61, v152
    v_add_f32 v185, s61, v153
    v_add_f32 v186, s61, v154
    v_add_f32 v187, s61, v155
    v_add_f32 v188, s61, v156
    v_add_f32 v189, s61, v157
    v_add_f32 v190, s61, v158
    v_add_f32 v191, s61, v159
    s_branch col_chk_11_sum
K1_nc:
    s_waitcnt vmcnt(0)
    s_sub_u32 s11, s2, 160
    v_and_b32 v89, 3, v1
    v_lshrrev_b32 v2, 4, v1
    v_mul_u32_u24 v2, 320, v2
    v_bfe_u32 v5, v1, 2, 2
    v_lshl_add_u32 v90, v5, 4, v2
    s_mov_b32 s36, s16
    s_and_b32 s37, s17, 0xffff
    s_mov_b32 s38, 0x21c000
    s_mov_b32 s39, 0x00020000
    s_lshl_b32 s40, s11, 2
    s_add_u32 s40, s40, s26
    s_mul_i32 s40, s40, 5120
    s_mov_b32 s48, 64
    v_mul_u32_u24 v86, 1280, v89
    v_add_u32 v86, v86, v90
    buffer_load_dwordx4 a[96:99], v86, s[36:39], s40 offen
    s_add_u32 s40, s40, s48
    buffer_load_dwordx4 a[100:103], v86, s[36:39], s40 offen
SC_e39:
PAD_35:
    s_cbranch_execz SC_ret
    s_add_u32 s40, s40, s48
    buffer_load_dwordx4 a[104:107], v86, s[36:39], s40 offen
    s_add_u32 s40, s40, s48
    buffer_load_dwordx4 a[108:111], v86, s[36:39], s40 offen
    s_add_u32 s40, s40, s48
    buffer_load_dwordx4 a[112:115], v86, s[36:39], s40 offen
    s_branch K1_go
K1_w1:
    v_cndmask_b32 v91, 1.0, 0, vcc
    v_lshrrev_b32 v2, 4, v0
    v_add_lshl_u32 v2, v2, v0, 4
    ds_write_b128 v2, v[216:219] offset:0
    ds_write_b128 v2, v[220:223] offset:4352
    ds_write_b128 v2, v[224:227] offset:8704
    ds_write_b128 v2, v[228:231] offset:13056
    ds_write_b128 v2, v[232:235] offset:17408
    v_lshrrev_b32 v2, 4, v1
    v_mul_u32_u24 v2, 20, v2
    v_and_b32 v3, 3, v1
    v_add_u32 v2, v2, v3
    v_mul_u32_u24 v2, 272, v2
    s_lshl_b32 s48, s26, 3
    v_add_u32 v2, s48, v2
    v_bfe_u32 v3, v1, 2, 2
    v_mul_u32_u24 v3, 1088, v3
    v_add_u32 v3, v3, v2
    s_waitcnt lgkmcnt(0)
    s_barrier
    ds_read_b64_tr_b16 v[184:185], v3 offset:0
    ds_read_b64_tr_b16 v[186:187], v2 offset:4352
    ds_read_b64_tr_b16 v[188:189], v3 offset:32
    ds_read_b64_tr_b16 v[190:191], v2 offset:4384
    ds_read_b64_tr_b16 v[192:193], v3 offset:64
    ds_read_b64_tr_b16 v[194:195], v2 offset:4416
    ds_read_b64_tr_b16 v[196:197], v3 offset:96
    ds_read_b64_tr_b16 v[198:199], v2 offset:4448
    ds_read_b64_tr_b16 v[200:201], v3 offset:128
    ds_read_b64_tr_b16 v[202:203], v2 offset:4480
    ds_read_b64_tr_b16 v[204:205], v3 offset:160
    ds_read_b64_tr_b16 v[206:207], v2 offset:4512
SC_e55:
PAD_36:
    s_cbranch_execz SC_ret
    ds_read_b64_tr_b16 v[208:209], v3 offset:192
    ds_read_b64_tr_b16 v[210:211], v2 offset:4544
    ds_read_b64_tr_b16 v[212:213], v3 offset:224
    ds_read_b64_tr_b16 v[214:215], v2 offset:4576
    s_lshr_b32 s48, s28, 1
    s_mul_i32 s48, s48, 40960
    s_and_b32 s49, s28, 1
    s_lshl_b32 s49, s49, 8
    s_add_u32 s48, s48, s49
    s_mul_i32 s49, s26, 10240
    s_add_u32 s48, s48, s49
    s_add_u32 s40, s48, 0x730000
    s_add_u32 s41, s40, 2048
    s_add_u32 s42, s41, 2048
    s_add_u32 s43, s42, 2048
    s_add_u32 s44, s43, 2048
    s_and_b32 s48, s26, 1
    s_lshl_b32 s48, s48, 7
    s_lshr_b32 s49, s26, 1
    s_lshl_b32 s49, s49, 6
    s_add_u32 s48, s48, s49
    v_lshrrev_b32 v4, 4, v1
    v_lshl_add_u32 v87, v4, 8, v7
    v_add_u32 v87, s48, v87
    v_and_b32 v5, 15, v1
    v_lshlrev_b32 v5, 4, v5
    v_lshl_add_u32 v89, v4, 9, v5
    v_mov_b32 v90, v89
    s_branch K1_core
K1_ow2:
    v_and_b32 v4, 3, v1
    v_mul_u32_u24 v4, 64, v4
    s_mul_i32 s48, s26, 5376
    s_add_u32 s48, s48, 81920
    v_and_b32 v5, 0xffff, v86
    v_add3_u32 v4, v4, v5, s48
    ds_write_b128 v4, v[216:219] offset:0
    ds_write_b128 v4, v[220:223] offset:64
    ds_write_b128 v4, v[224:227] offset:128
    ds_write_b128 v4, v[228:231] offset:192
    ds_write_b128 v4, v[232:235] offset:256
SC_e8:
PAD_37:
    s_cbranch_execz PAD_38
    s_lshr_b32 s48, s28, 1
    s_mul_i32 s40, s48, 5120
    s_and_b32 s48, s28, 1
    s_lshl_b32 s48, s48, 9
    s_add_u32 s40, s40, s48
    s_mul_i32 s48, s26, 552960
    s_add_u32 s40, s40, s48
    s_add_u32 s40, s40, 0x514000
    s_add_u32 s41, s40, 2048
    s_add_u32 s42, s40, 4096
    s_add_u32 s43, s40, 277504
    s_add_u32 s44, s40, 279552
    v_and_b32 v5, 31, v1
    v_lshlrev_b32 v5, 4, v5
    v_lshrrev_b32 v4, 5, v1
    v_or_b32 v5, s45, v5
    v_lshl_add_u32 v89, v4, 10, v5
    v_mul_u32_u24 v90, 272384, v4
    v_add_u32 v90, v90, v5
    v_lshl_add_u32 v87, v4, 9, v7
    v_bfe_u32 v4, v1, 4, 1
    v_lshl_add_u32 v87, v4, 7, v87
    s_lshr_b32 s48, s26, 1
    s_lshl_b32 s48, s48, 8
    s_and_b32 s49, s26, 1
    s_lshl_b32 s49, s49, 3
    s_add_u32 s48, s48, s49
    v_add_u32 v87, s48, v87
    s_cmp_eq_u32 s27, 2
    s_cbranch_scc1 K1_core
    v_lshlrev_b32 v87, 5, v6
    v_add_u32 v88, 1280, v87
    s_mov_b32 s40, 0xb7e000
    v_mov_b32 v5, 0x40000000
    s_mov_b32 s50, 0x7ff07ff
    s_mov_b32 s51, 0x7ff07ff
    s_mov_b32 s52, 0x3fe03fe
    s_mov_b32 s53, 0x3fe03fe
    v_cndmask_b32 v87, v5, v87, s[50:51]
    v_cndmask_b32 v88, v5, v88, s[52:53]
    v_mov_b32 v89, v5
    v_mov_b32 v90, v5
    s_branch K1_core
K1_st1:
PAD_38:
    s_cbranch_execz SC_ret
    s_mov_b32 exec_lo, 0x7ff07ff
    s_mov_b32 exec_hi, 0x7ff07ff
    v_cvt_pk_bf16_f32 v152, v184, v185
    v_cvt_pk_bf16_f32 v153, v186, v187
    v_cvt_pk_bf16_f32 v154, v188, v189
    v_cvt_pk_bf16_f32 v155, v190, v191
    ds_write_b128 v87, v[152:155] offset:21760
    v_cvt_pk_bf16_f32 v160, v200, v201
    v_cvt_pk_bf16_f32 v161, v202, v203
    v_cvt_pk_bf16_f32 v162, v204, v205
    v_cvt_pk_bf16_f32 v163, v206, v207
    ds_write_b128 v87, v[160:163] offset:21776
    v_cvt_pk_bf16_f32 v168, v216, v217
    v_cvt_pk_bf16_f32 v169, v218, v219
    v_cvt_pk_bf16_f32 v170, v220, v221
    v_cvt_pk_bf16_f32 v171, v222, v223
    ds_write_b128 v87, v[168:171] offset:21792
    v_cvt_pk_bf16_f32 v176, v232, v233
    v_cvt_pk_bf16_f32 v177, v234, v235
    v_cvt_pk_bf16_f32 v178, v236, v237
    v_cvt_pk_bf16_f32 v179, v238, v239
    ds_write_b128 v87, v[176:179] offset:21808
    s_mov_b32 exec_lo, 0x3fe03fe
    s_mov_b32 exec_hi, 0x3fe03fe
    v_cvt_pk_bf16_f32 v156, v192, -v193
    v_cvt_pk_bf16_f32 v157, v194, -v195
    v_cvt_pk_bf16_f32 v158, v196, -v197
    v_cvt_pk_bf16_f32 v159, v198, -v199
    ds_write_b128 v87, v[156:159] offset:32160
    v_cvt_pk_bf16_f32 v164, v208, -v209
    v_cvt_pk_bf16_f32 v165, v210, -v211
    v_cvt_pk_bf16_f32 v166, v212, -v213
SC_e24:
PAD_39:
    s_cbranch_execz SC_ret
    v_cvt_pk_bf16_f32 v167, v214, -v215
    ds_write_b128 v87, v[164:167] offset:32176
    v_cvt_pk_bf16_f32 v172, v224, -v225
    v_cvt_pk_bf16_f32 v173, v226, -v227
    v_cvt_pk_bf16_f32 v174, v228, -v229
    v_cvt_pk_bf16_f32 v175, v230, -v231
    ds_write_b128 v87, v[172:175] offset:32192
    v_cvt_pk_bf16_f32 v180, v240, -v241
    v_cvt_pk_bf16_f32 v181, v242, -v243
    v_cvt_pk_bf16_f32 v182, v244, -v245
    v_cvt_pk_bf16_f32 v183, v246, -v247
    ds_write_b128 v87, v[180:183] offset:32208
    s_branch K1_out
K1_st2:
    s_cmp_eq_u32 s27, 3
    s_cbranch_scc1 K1_st3
    s_mov_b32 exec_lo, 0x7ff07ff
    s_mov_b32 exec_hi, 0x7ff07ff
    v_cvt_pk_bf16_f32 v152, v184, v200
    v_cvt_pk_bf16_f32 v153, v216, v232
    ds_write_b64 v87, v[152:153] offset:21760
    v_cvt_pk_bf16_f32 v154, v185, v201
    v_cvt_pk_bf16_f32 v155, v217, v233
    ds_write_b64 v87, v[154:155] offset:21776
    v_cvt_pk_bf16_f32 v156, v186, v202
    v_cvt_pk_bf16_f32 v157, v218, v234
    ds_write_b64 v87, v[156:157] offset:21792
    v_cvt_pk_bf16_f32 v158, v187, v203
    v_cvt_pk_bf16_f32 v159, v219, v235
    ds_write_b64 v87, v[158:159] offset:21808
    v_cvt_pk_bf16_f32 v160, v188, v204
    v_cvt_pk_bf16_f32 v161, v220, v236
    ds_write_b64 v87, v[160:161] offset:21824
    v_cvt_pk_bf16_f32 v162, v189, v205
SC_e40:
PAD_40:
    s_cbranch_execz SC_ret
    v_cvt_pk_bf16_f32 v163, v221, v237
    ds_write_b64 v87, v[162:163] offset:21840
    v_cvt_pk_bf16_f32 v164, v190, v206
    v_cvt_pk_bf16_f32 v165, v222, v238
    ds_write_b64 v87, v[164:165] offset:21856
    v_cvt_pk_bf16_f32 v166, v191, v207
    v_cvt_pk_bf16_f32 v167, v223, v239
    ds_write_b64 v87, v[166:167] offset:21872
    s_mov_b32 exec_lo, 0x3fe03fe
    s_mov_b32 exec_hi, 0x3fe03fe
    v_cvt_pk_bf16_f32 v168, v192, v208
    v_cvt_pk_bf16_f32 v169, v224, v240
    ds_write_b64 v87, v[168:169] offset:32160
    v_cvt_pk_bf16_f32 v170, -v193, -v209
    v_cvt_pk_bf16_f32 v171, -v225, -v241
    ds_write_b64 v87, v[170:171] offset:32176
    v_cvt_pk_bf16_f32 v172, v194, v210
    v_cvt_pk_bf16_f32 v173, v226, v242
    ds_write_b64 v87, v[172:173] offset:32192
    v_cvt_pk_bf16_f32 v174, -v195, -v211
    v_cvt_pk_bf16_f32 v175, -v227, -v243
    ds_write_b64 v87, v[174:175] offset:32208
    v_cvt_pk_bf16_f32 v176, v196, v212
    v_cvt_pk_bf16_f32 v177, v228, v244
    ds_write_b64 v87, v[176:177] offset:32224
    v_cvt_pk_bf16_f32 v178, -v197, -v213
    v_cvt_pk_bf16_f32 v179, -v229, -v245
    ds_write_b64 v87, v[178:179] offset:32240
    v_cvt_pk_bf16_f32 v180, v198, v214
    v_cvt_pk_bf16_f32 v181, v230, v246
    ds_write_b64 v87, v[180:181] offset:32256
SC_e56:
PAD_41:
    s_cbranch_execz SC_ret
    v_cvt_pk_bf16_f32 v182, -v199, -v215
    v_cvt_pk_bf16_f32 v183, -v231, -v247
    ds_write_b64 v87, v[182:183] offset:32272
    s_branch K1_out
K1_more:
    s_cmp_lg_u32 s29, 0
    s_cbranch_scc1 K1_done
    s_mov_b32 s29, 1
    s_mov_b32 s27, 2
    s_mov_b32 s28, s11
    s_mov_b32 s45, 0
    v_mov_b32 v93, 0x40000000
    s_lshr_b32 s50, s2, 6
    s_lshl_b32 s50, s50, 1
    s_and_b32 s48, s2, 1
    s_add_u32 s50, s50, s48
    s_lshr_b32 s48, s50, 1
    s_mul_i32 s48, s48, 14
    s_add_u32 s48, s48, s26
    s_and_b32 s49, s50, 1
    s_lshl_b32 s51, s49, 2
    s_add_u32 s51, s51, s48
    s_cmp_lt_u32 s50, 6
    s_cselect_b32 s53, 3, 2
    s_mul_i32 s49, s49, s53
    s_add_u32 s52, s48, s49
    s_add_u32 s52, s52, 8
    s_cmp_lt_u32 s26, s53
    s_cselect_b32 s53, 1, 0
    s_lshr_b32 s48, s51, 1
    s_lshr_b32 s49, s52, 1
    s_sub_u32 s49, s49, s48
    s_lshl_b32 s48, s48, 7
    s_lshl_b32 s49, s49, 7
    s_add_u32 s48, s48, 0xb80000
    v_sub_u32 v251, 1, v1
    v_and_b32 v251, 0x40000000, v251
    v_mad_u32_u24 v251, v1, s49, v251
    v_add_u32 v251, s48, v251
    v_mov_b32 v7, 12
    s_waitcnt vmcnt(0)
    v_readfirstlane_b32 s57, v248
    s_nop 3
    s_or_b32 s57, s57, s26
    s_cmp_eq_u32 s57, 0
    s_cbranch_scc1 flg_retry_7
flg_6:
    s_barrier
    buffer_store_dword v7, v94, s[32:35], s59 offen sc1
    v_accvgpr_read_b32 v216, a96
    v_accvgpr_read_b32 v217, a97
    v_accvgpr_read_b32 v218, a98
    v_accvgpr_read_b32 v219, a99
    v_accvgpr_read_b32 v220, a100
SC_e9:
PAD_42:
    s_cbranch_execz SC_ret
    v_accvgpr_read_b32 v221, a101
    v_accvgpr_read_b32 v222, a102
    v_accvgpr_read_b32 v223, a103
    v_accvgpr_read_b32 v224, a104
    v_accvgpr_read_b32 v225, a105
    v_accvgpr_read_b32 v226, a106
    v_accvgpr_read_b32 v227, a107
    v_accvgpr_read_b32 v228, a108
    v_accvgpr_read_b32 v229, a109
    v_accvgpr_read_b32 v230, a110
    v_accvgpr_read_b32 v231, a111
    v_accvgpr_read_b32 v232, a112
    v_accvgpr_read_b32 v233, a113
    v_accvgpr_read_b32 v234, a114
    v_accvgpr_read_b32 v235, a115
    s_nop 1
    s_branch K1_go
col_chk_11_first:
    v_lshrrev_b32 v184, 3, v0
    v_and_b32 v185, 7, v0
    v_lshlrev_b32 v185, 4, v185
    v_lshl_add_u32 v80, v184, 9, v185
    v_lshrrev_b32 v85, 1, v80
    s_mul_i32 s48, s2, 16640
    v_add_u32 v80, s48, v80
    v_lshlrev_b32 v85, 4, v0
    v_lshrrev_b32 v184, 4, v1
    v_and_b32 v185, 15, v1
    v_lshlrev_b32 v185, 4, v185
    v_lshl_add_u32 v186, v184, 12, v185
    s_mul_i32 s48, s2, 16640
    s_lshl_b32 s49, s26, 8
    s_add_u32 s48, s48, s49
    s_add_u32 s48, s48, 0x28a000
    buffer_load_dwordx4 v[104:107], v186, s[32:35], s48 offen offset:0 sc1
    buffer_load_dwordx4 v[108:111], v186, s[32:35], s48 offen offset:1024 sc1
    buffer_load_dwordx4 v[112:115], v186, s[32:35], s48 offen offset:2048 sc1
    buffer_load_dwordx4 v[116:119], v186, s[32:35], s48 offen offset:3072 sc1
    s_mul_i32 s48, s26, 3072
SC_e25:
PAD_43:
    s_cbranch_execz PAD_44
    v_add_u32 v184, 144384, v2
    v_add_u32 v185, s48, v184
    ds_read_b128 v[32:35], v184 offset:0
    ds_read_b128 v[36:39], v184 offset:1024
    ds_read_b128 v[40:43], v184 offset:2048
    ds_read_b128 v[44:47], v184 offset:3072
    ds_read_b128 v[8:11], v185 offset:4096
    ds_read_b128 v[72:75], v185 offset:5120
    ds_read_b128 v[76:79], v185 offset:6144
    v_and_b32 v184, 15, v1
    v_lshlrev_b32 v185, 2, v184
    v_add_u32 v185, s26, v185
    v_cvt_f32_ubyte0 v188, v185
    v_lshrrev_b32 v185, 4, v1
    v_cvt_f32_ubyte0 v189, v185
    v_mul_f32 v186, v188, v189
    v_mul_f32 v187, 0xbb800000, v186
    v_fmamk_f32 v184, v188, 0x00000000, v187
    v_cos_f32 v16, v184
    v_sin_f32 v24, v184
    v_fmamk_f32 v184, v188, 0xba000000, v187
    v_cos_f32 v17, v184
    v_sin_f32 v25, v184
    v_fmamk_f32 v184, v188, 0xba800000, v187
    v_cos_f32 v18, v184
    v_sin_f32 v26, v184
    v_fmamk_f32 v184, v188, 0xbac00000, v187
    v_cos_f32 v19, v184
    v_sin_f32 v27, v184
    v_fmamk_f32 v184, v188, 0xbb000000, v187
    v_cos_f32 v20, v184
    v_sin_f32 v28, v184
    v_fmamk_f32 v184, v188, 0xbb200000, v187
    v_cos_f32 v21, v184
    v_sin_f32 v29, v184
    v_fmamk_f32 v184, v188, 0xbb400000, v187
    v_cos_f32 v22, v184
    v_sin_f32 v30, v184
    v_fmamk_f32 v184, v188, 0xbb600000, v187
    v_cos_f32 v23, v184
    v_sin_f32 v31, v184
    v_and_b32 v184, 15, v1
    v_and_b32 v185, 12, v1
    v_add_u32 v184, v184, v185
    v_cvt_f32_ubyte0 v190, v184
    s_waitcnt lgkmcnt(4)
PAD_44:
    s_cbranch_execz SC_ret
    v_xor_b32 v48, 0x80008000, v40
    v_xor_b32 v49, 0x80008000, v41
    v_xor_b32 v50, 0x80008000, v42
    v_xor_b32 v51, 0x80008000, v43
    s_waitcnt lgkmcnt(2)
    v_alignbit_b32 v12, v8, v8, 16
    v_xor_b32 v12, 0x8000, v12
    v_alignbit_b32 v13, v9, v9, 16
    v_xor_b32 v13, 0x8000, v13
    v_add_f32 v191, 4.0, v190
    v_xor_b32 v52, 0x80008000, v44
    v_xor_b32 v53, 0x80008000, v45
    v_xor_b32 v54, 0x80008000, v46
    v_xor_b32 v55, 0x80008000, v47
    v_alignbit_b32 v14, v10, v10, 16
    v_xor_b32 v14, 0x8000, v14
    v_alignbit_b32 v15, v11, v11, 16
    v_xor_b32 v15, 0x8000, v15
    v_cvt_f32_ubyte0 v184, s26
    v_fmamk_f32 v188, v189, 0x41800000, v184
    v_mul_f32 v186, v190, v188
    v_mul_f32 v187, 0x3a000000, v186
    v_fmamk_f32 v184, v190, 0x00000000, v187
    v_cos_f32 v56, v184
    v_sin_f32 v64, v184
    v_fmamk_f32 v184, v190, 0x3b000000, v187
    v_cos_f32 v57, v184
    v_sin_f32 v65, v184
    v_fmamk_f32 v184, v190, 0x3b800000, v187
    v_cos_f32 v58, v184
    v_sin_f32 v66, v184
    v_fmamk_f32 v184, v190, 0x3bc00000, v187
    v_cos_f32 v59, v184
    v_sin_f32 v67, v184
    v_mul_f32 v186, v191, v188
    v_mul_f32 v187, 0x3a000000, v186
    v_fmamk_f32 v184, v191, 0x00000000, v187
    v_cos_f32 v60, v184
    v_sin_f32 v68, v184
SC_e41:
PAD_45:
    s_cbranch_execz SC_ret
    v_fmamk_f32 v184, v191, 0x3b000000, v187
    v_cos_f32 v61, v184
    v_sin_f32 v69, v184
    v_fmamk_f32 v184, v191, 0x3b800000, v187
    v_cos_f32 v62, v184
    v_sin_f32 v70, v184
    v_fmamk_f32 v184, v191, 0x3bc00000, v187
    v_cos_f32 v63, v184
    v_sin_f32 v71, v184
    v_bfe_u32 v184, v0, 1, 2
    v_bfe_u32 v185, v0, 3, 2
    s_lshl_b32 s48, s26, 2
    v_or_b32 v185, s48, v185
    v_lshlrev_b32 v186, 1, v184
    v_xor_b32 v185, v185, v186
    v_lshlrev_b32 v185, 4, v185
    v_lshl_add_u32 v185, v184, 8, v185
    v_bfe_u32 v184, v0, 5, 1
    v_lshl_add_u32 v185, v184, 10, v185
    v_and_b32 v184, 1, v0
    v_lshl_add_u32 v81, v184, 3, v185
    v_lshrrev_b32 v184, 4, v1
    v_lshlrev_b32 v185, 1, v184
    v_xor_b32 v185, v185, v1
    v_lshlrev_b32 v185, 4, v185
    s_lshl_b32 s48, s26, 12
    v_add_u32 v82, s48, v185
    v_and_b32 v185, 7, v1
    v_xor_b32 v185, v185, v184
    v_lshlrev_b32 v185, 4, v185
    v_and_b32 v184, 15, v1
    v_and_b32 v186, 12, v1
    v_add_u32 v184, v184, v186
    v_lshl_add_u32 v185, v184, 7, v185
    s_lshl_b32 s48, s26, 13
    v_add_u32 v83, s48, v185
    v_bfe_u32 v184, v0, 3, 2
    v_bfe_u32 v185, v0, 6, 1
    v_lshl_add_u32 v184, v185, 2, v184
    v_xor_b32 v184, v0, v184
    v_lshlrev_b32 v84, 4, v184
    s_mul_i32 s48, s26, 15360
    s_add_u32 s48, s48, 81920
    v_add_u32 v231, s48, v2
    s_min_u32 s48, s26, 1
    s_add_u32 s48, s48, s26
    s_add_u32 s48, s48, 6
    v_lshrrev_b32 v222, 4, v1
SC_e57:
PAD_46:
    s_cbranch_execz SC_ret
    v_mul_u32_u24 v222, 40, v222
    v_add_u32 v222, s48, v222
    v_cvt_f32_u32 v224, v222
    v_add_f32 v225, 0x41a00000, v224
    s_mul_i32 s49, s28, 80
    v_and_b32 v222, 15, v1
    v_add_u32 v222, s49, v222
    v_cvt_f32_u32 v227, v222
    v_and_b32 v223, 12, v1
    v_add_u32 v222, v222, v223
    v_cvt_f32_u32 v226, v222
    v_lshlrev_b32 v228, 4, v1
    v_lshlrev_b32 v222, 30, v1
    v_lshlrev_b32 v223, 31, v1
    v_xor_b32 v229, v222, v223
    v_lshrrev_b32 v222, 16, v222
    v_and_b32 v222, 0x8000, v222
    v_bfrev_b32 v230, 1
    v_and_or_b32 v229, v229, v230, v222
    v_alignbit_b32 v230, v230, v230, v228
    s_cmp_eq_u32 s26, 1
    s_cselect_b32 s48, -1, 0
    s_lshl_b32 s49, s48, 31
    v_and_b32 v232, s48, v230
    v_add_f32 v222, 0x00000000, v226
    v_mul_f32 v222, 0xbacccccd, v222
    v_cos_f32 v212, v222
    v_sin_f32 v213, v222
    v_mul_f32 v193, v222, v224
    v_mul_f32 v195, v222, v225
    v_fract_f32 v193, v193
    v_fract_f32 v195, v195
    v_cos_f32 v192, v193
    v_cos_f32 v194, v195
    v_sin_f32 v193, v193
    v_sin_f32 v195, v195
    v_xor_b32 v213, s49, v213
    v_mul_f32 v192, 0x3d64f92e, v192
    v_mul_f32 v193, 0x3d64f92e, v193
    v_mul_f32 v194, 0x3d64f92e, v194
    v_mul_f32 v195, 0x3d64f92e, v195
    v_cvt_pk_bf16_f32 v236, v192, v193
    v_cvt_pk_bf16_f32 v237, v194, v195
    v_alignbit_b32 v238, v236, v236, v228
    v_alignbit_b32 v239, v237, v237, v228
    v_xor_b32 v238, v229, v238
    v_xor_b32 v239, v229, v239
    ds_write_b128 v231, v[236:239] offset:0
SC_e10:
PAD_47:
    s_cbranch_execz SC_ret
    v_xor_b32 v240, v230, v236
    v_xor_b32 v241, v230, v237
    v_xor_b32 v242, v230, v238
    v_xor_b32 v243, v230, v239
    ds_write_b128 v231, v[240:243] offset:5120
    v_pk_mul_f32 v[222:223], v[192:193], v[212:213] op_sel:[0,0] op_sel_hi:[0,1]
    v_pk_fma_f32 v[192:193], v[192:193], v[212:213], v[222:223] op_sel:[1,1,0] op_sel_hi:[1,0,1] neg_lo:[0,1,0]
    v_pk_mul_f32 v[222:223], v[194:195], v[212:213] op_sel:[0,0] op_sel_hi:[0,1]
    v_pk_fma_f32 v[194:195], v[194:195], v[212:213], v[222:223] op_sel:[1,1,0] op_sel_hi:[1,0,1] neg_lo:[0,1,0]
    v_cvt_pk_bf16_f32 v244, v192, v193
    v_cvt_pk_bf16_f32 v245, v194, v195
    v_alignbit_b32 v246, v244, v244, v228
    v_alignbit_b32 v247, v245, v245, v228
    v_xor_b32 v246, v229, v246
    v_xor_b32 v247, v229, v247
    v_xor_b32 v244, v232, v244
    v_xor_b32 v245, v232, v245
    v_xor_b32 v246, v232, v246
    v_xor_b32 v247, v232, v247
    ds_write_b128 v231, v[244:247] offset:10240
    v_add_f32 v222, 0x40800000, v226
    v_mul_f32 v222, 0xbacccccd, v222
    v_cos_f32 v214, v222
    v_sin_f32 v215, v222
    v_mul_f32 v197, v222, v224
    v_mul_f32 v199, v222, v225
    v_fract_f32 v197, v197
    v_fract_f32 v199, v199
    v_cos_f32 v196, v197
    v_cos_f32 v198, v199
    v_sin_f32 v197, v197
    v_sin_f32 v199, v199
    v_xor_b32 v215, s49, v215
    v_mul_f32 v196, 0x3d64f92e, v196
    v_mul_f32 v197, 0x3d64f92e, v197
    v_mul_f32 v198, 0x3d64f92e, v198
    v_mul_f32 v199, 0x3d64f92e, v199
    v_cvt_pk_bf16_f32 v236, v196, v197
    v_cvt_pk_bf16_f32 v237, v198, v199
    v_alignbit_b32 v238, v236, v236, v228
    v_alignbit_b32 v239, v237, v237, v228
    v_xor_b32 v238, v229, v238
    v_xor_b32 v239, v229, v239
    ds_write_b128 v231, v[236:239] offset:1024
SC_e26:
PAD_48:
    s_cbranch_execz SC_ret
    v_xor_b32 v240, v230, v236
    v_xor_b32 v241, v230, v237
    v_xor_b32 v242, v230, v238
    v_xor_b32 v243, v230, v239
    buffer_load_dwordx4 v[88:91], v80, s[32:35], 0 offen offset:0 sc1
    buffer_load_dwordx4 v[92:95], v80, s[32:35], 0 offen offset:128 sc1
    buffer_load_dwordx4 v[96:99], v80, s[32:35], 0 offen offset:256 sc1
    buffer_load_dwordx4 v[100:103], v80, s[32:35], 0 offen offset:384 sc1
    s_mov_b32 s50, 0xc83000
    buffer_load_dwordx4 v[152:155], v85, s[32:35], s50 offen sc1
    s_mov_b32 s50, 0xc84000
    buffer_load_dwordx4 v[156:159], v85, s[32:35], s50 offen sc1
    s_mov_b32 s50, 0xc85000
    buffer_load_dwordx4 v[160:163], v85, s[32:35], s50 offen sc1
    s_mov_b32 s50, 0xc86000
    buffer_load_dwordx4 v[164:167], v85, s[32:35], s50 offen sc1
    s_mov_b32 s50, 0xc87000
    buffer_load_dwordx4 v[168:171], v85, s[32:35], s50 offen sc1
    s_mov_b32 s50, 0xc88000
    buffer_load_dwordx4 v[172:175], v85, s[32:35], s50 offen sc1
    s_mov_b32 s50, 0xc89000
    buffer_load_dwordx4 v[176:179], v85, s[32:35], s50 offen sc1
    s_mov_b32 s50, 0xc8a000
    buffer_load_dwordx4 v[180:183], v85, s[32:35], s50 offen sc1
    ds_write_b128 v231, v[240:243] offset:6144
    v_pk_mul_f32 v[222:223], v[196:197], v[214:215] op_sel:[0,0] op_sel_hi:[0,1]
    v_pk_fma_f32 v[196:197], v[196:197], v[214:215], v[222:223] op_sel:[1,1,0] op_sel_hi:[1,0,1] neg_lo:[0,1,0]
    v_pk_mul_f32 v[222:223], v[198:199], v[214:215] op_sel:[0,0] op_sel_hi:[0,1]
    v_pk_fma_f32 v[198:199], v[198:199], v[214:215], v[222:223] op_sel:[1,1,0] op_sel_hi:[1,0,1] neg_lo:[0,1,0]
    v_cvt_pk_bf16_f32 v244, v196, v197
    v_cvt_pk_bf16_f32 v245, v198, v199
    v_alignbit_b32 v246, v244, v244, v228
    v_alignbit_b32 v247, v245, v245, v228
SC_e42:
PAD_49:
    s_cbranch_execz PAD_50
    v_xor_b32 v246, v229, v246
    v_xor_b32 v247, v229, v247
    v_xor_b32 v244, v232, v244
    v_xor_b32 v245, v232, v245
    v_xor_b32 v246, v232, v246
    v_xor_b32 v247, v232, v247
    ds_write_b128 v231, v[244:247] offset:11264
    v_add_f32 v222, 0x42000000, v226
    v_mul_f32 v222, 0xbacccccd, v222
    v_cos_f32 v216, v222
    v_sin_f32 v217, v222
    v_mul_f32 v201, v222, v224
    v_mul_f32 v203, v222, v225
    v_fract_f32 v201, v201
    v_fract_f32 v203, v203
    v_cos_f32 v200, v201
    v_cos_f32 v202, v203
    v_sin_f32 v201, v201
    v_sin_f32 v203, v203
    v_xor_b32 v217, s49, v217
    v_mul_f32 v200, 0x3d64f92e, v200
    v_mul_f32 v201, 0x3d64f92e, v201
    v_mul_f32 v202, 0x3d64f92e, v202
    v_mul_f32 v203, 0x3d64f92e, v203
    v_cvt_pk_bf16_f32 v236, v200, v201
    v_cvt_pk_bf16_f32 v237, v202, v203
    v_alignbit_b32 v238, v236, v236, v228
    v_alignbit_b32 v239, v237, v237, v228
    v_xor_b32 v238, v229, v238
    v_xor_b32 v239, v229, v239
    ds_write_b128 v231, v[236:239] offset:2048
    v_xor_b32 v240, v230, v236
    v_xor_b32 v241, v230, v237
    v_xor_b32 v242, v230, v238
    v_xor_b32 v243, v230, v239
    ds_write_b128 v231, v[240:243] offset:7168
    v_pk_mul_f32 v[222:223], v[200:201], v[216:217] op_sel:[0,0] op_sel_hi:[0,1]
    v_pk_fma_f32 v[200:201], v[200:201], v[216:217], v[222:223] op_sel:[1,1,0] op_sel_hi:[1,0,1] neg_lo:[0,1,0]
    v_pk_mul_f32 v[222:223], v[202:203], v[216:217] op_sel:[0,0] op_sel_hi:[0,1]
    v_pk_fma_f32 v[202:203], v[202:203], v[216:217], v[222:223] op_sel:[1,1,0] op_sel_hi:[1,0,1] neg_lo:[0,1,0]
    v_cvt_pk_bf16_f32 v244, v200, v201
    v_cvt_pk_bf16_f32 v245, v202, v203
    v_alignbit_b32 v246, v244, v244, v228
PAD_50:
    s_cbranch_execz SC_ret
    v_alignbit_b32 v247, v245, v245, v228
    v_xor_b32 v246, v229, v246
    v_xor_b32 v247, v229, v247
    v_xor_b32 v244, v232, v244
    v_xor_b32 v245, v232, v245
    v_xor_b32 v246, v232, v246
    v_xor_b32 v247, v232, v247
    ds_write_b128 v231, v[244:247] offset:12288
    v_add_f32 v222, 0x42100000, v226
    v_mul_f32 v222, 0xbacccccd, v222
    v_cos_f32 v218, v222
    v_sin_f32 v219, v222
    v_mul_f32 v205, v222, v224
    v_mul_f32 v207, v222, v225
    v_fract_f32 v205, v205
    v_fract_f32 v207, v207
    v_cos_f32 v204, v205
    v_cos_f32 v206, v207
    v_sin_f32 v205, v205
    v_sin_f32 v207, v207
    v_xor_b32 v219, s49, v219
    v_mul_f32 v204, 0x3d64f92e, v204
    v_mul_f32 v205, 0x3d64f92e, v205
    v_mul_f32 v206, 0x3d64f92e, v206
    v_mul_f32 v207, 0x3d64f92e, v207
    v_cvt_pk_bf16_f32 v236, v204, v205
    v_cvt_pk_bf16_f32 v237, v206, v207
    v_alignbit_b32 v238, v236, v236, v228
    v_alignbit_b32 v239, v237, v237, v228
    v_xor_b32 v238, v229, v238
    v_xor_b32 v239, v229, v239
    ds_write_b128 v231, v[236:239] offset:3072
    v_xor_b32 v240, v230, v236
    v_xor_b32 v241, v230, v237
    v_xor_b32 v242, v230, v238
    v_xor_b32 v243, v230, v239
    ds_write_b128 v231, v[240:243] offset:8192
    v_pk_mul_f32 v[222:223], v[204:205], v[218:219] op_sel:[0,0] op_sel_hi:[0,1]
    v_pk_fma_f32 v[204:205], v[204:205], v[218:219], v[222:223] op_sel:[1,1,0] op_sel_hi:[1,0,1] neg_lo:[0,1,0]
    v_pk_mul_f32 v[222:223], v[206:207], v[218:219] op_sel:[0,0] op_sel_hi:[0,1]
    v_pk_fma_f32 v[206:207], v[206:207], v[218:219], v[222:223] op_sel:[1,1,0] op_sel_hi:[1,0,1] neg_lo:[0,1,0]
    v_cvt_pk_bf16_f32 v244, v204, v205
    v_cvt_pk_bf16_f32 v245, v206, v207
SC_e58:
PAD_51:
    s_cbranch_execz SC_ret
    v_alignbit_b32 v246, v244, v244, v228
    v_alignbit_b32 v247, v245, v245, v228
    v_xor_b32 v246, v229, v246
    v_xor_b32 v247, v229, v247
    v_xor_b32 v244, v232, v244
    v_xor_b32 v245, v232, v245
    v_xor_b32 v246, v232, v246
    v_xor_b32 v247, v232, v247
    ds_write_b128 v231, v[244:247] offset:13312
    v_add_f32 v222, 0x42800000, v227
    v_mul_f32 v222, 0xbacccccd, v222
    v_cos_f32 v220, v222
    v_sin_f32 v221, v222
    v_mul_f32 v209, v222, v224
    v_mul_f32 v211, v222, v225
    v_fract_f32 v209, v209
    v_fract_f32 v211, v211
    v_cos_f32 v208, v209
    v_cos_f32 v210, v211
    v_sin_f32 v209, v209
    v_sin_f32 v211, v211
    v_xor_b32 v221, s49, v221
    v_mul_f32 v208, 0x3d64f92e, v208
    v_mul_f32 v209, 0x3d64f92e, v209
    v_mul_f32 v210, 0x3d64f92e, v210
    v_mul_f32 v211, 0x3d64f92e, v211
    v_cvt_pk_bf16_f32 v236, v208, v209
    v_cvt_pk_bf16_f32 v237, v210, v211
    v_alignbit_b32 v238, v236, v236, v228
    v_alignbit_b32 v239, v237, v237, v228
    v_xor_b32 v238, v229, v238
    v_xor_b32 v239, v229, v239
    ds_write_b128 v231, v[236:239] offset:4096
    v_xor_b32 v240, v230, v236
    v_xor_b32 v241, v230, v237
    v_xor_b32 v242, v230, v238
    v_xor_b32 v243, v230, v239
    ds_write_b128 v231, v[240:243] offset:9216
    v_pk_mul_f32 v[222:223], v[208:209], v[220:221] op_sel:[0,0] op_sel_hi:[0,1]
    v_pk_fma_f32 v[208:209], v[208:209], v[220:221], v[222:223] op_sel:[1,1,0] op_sel_hi:[1,0,1] neg_lo:[0,1,0]
    v_pk_mul_f32 v[222:223], v[210:211], v[220:221] op_sel:[0,0] op_sel_hi:[0,1]
    v_pk_fma_f32 v[210:211], v[210:211], v[220:221], v[222:223] op_sel:[1,1,0] op_sel_hi:[1,0,1] neg_lo:[0,1,0]
    v_cvt_pk_bf16_f32 v244, v208, v209
SC_e11:
PAD_52:
    s_cbranch_execz SC_ret
    v_cvt_pk_bf16_f32 v245, v210, v211
    v_alignbit_b32 v246, v244, v244, v228
    v_alignbit_b32 v247, v245, v245, v228
    v_xor_b32 v246, v229, v246
    v_xor_b32 v247, v229, v247
    v_xor_b32 v244, v232, v244
    v_xor_b32 v245, v232, v245
    v_xor_b32 v246, v232, v246
    v_xor_b32 v247, v232, v247
    ds_write_b128 v231, v[244:247] offset:14336
col_chk_11:
    s_waitcnt vmcnt(9)
    v_or3_b32 v184, v88, v92, v96
    s_waitcnt vmcnt(8)
    v_bitop3_b32 v184, v184, v100, 1 bitop3:0xa8
    v_cmp_ne_u32 s[48:49], 0, v184
    s_waitcnt vmcnt(5)
    v_or3_b32 v184, v152, v156, v160
    s_waitcnt vmcnt(2)
    v_or3_b32 v185, v164, v168, v172
    s_waitcnt vmcnt(0)
    v_or3_b32 v184, v184, v176, v180
    v_or_b32 v184, v184, v185
    v_cmp_gt_i32 vcc, 0, v184
    s_nop 3
    s_or_b64 s[4:5], vcc, s[48:49]
    s_cbranch_scc1 col_retry_12
col_chk_11_ok:
    v_mov_b32 v120, 0x3f80
    v_mov_b32 v121, 1.0
    v_dot2_f32_bf16 v184, v152, v120, s61
    v_dot2_f32_bf16 v185, v152, v121, s61
    v_dot2_f32_bf16 v186, v153, v120, s61
    v_dot2_f32_bf16 v187, v153, v121, s61
    v_dot2_f32_bf16 v188, v154, v120, s61
    v_dot2_f32_bf16 v189, v154, v121, s61
    v_dot2_f32_bf16 v190, v155, v120, s61
    v_dot2_f32_bf16 v191, v155, v121, s61
    v_dot2_f32_bf16 v184, v156, v120, v184
    v_dot2_f32_bf16 v185, v156, v121, v185
    v_dot2_f32_bf16 v186, v157, v120, v186
    v_dot2_f32_bf16 v187, v157, v121, v187
SC_e27:
PAD_53:
    s_cbranch_execz SC_ret
    v_dot2_f32_bf16 v188, v158, v120, v188
    v_dot2_f32_bf16 v189, v158, v121, v189
    v_dot2_f32_bf16 v190, v159, v120, v190
    v_dot2_f32_bf16 v191, v159, v121, v191
    v_dot2_f32_bf16 v184, v160, v120, v184
    v_dot2_f32_bf16 v185, v160, v121, v185
    v_dot2_f32_bf16 v186, v161, v120, v186
    v_dot2_f32_bf16 v187, v161, v121, v187
    v_dot2_f32_bf16 v188, v162, v120, v188
    v_dot2_f32_bf16 v189, v162, v121, v189
    v_dot2_f32_bf16 v190, v163, v120, v190
    v_dot2_f32_bf16 v191, v163, v121, v191
    v_dot2_f32_bf16 v184, v164, v120, v184
    v_dot2_f32_bf16 v185, v164, v121, v185
    v_dot2_f32_bf16 v186, v165, v120, v186
    v_dot2_f32_bf16 v187, v165, v121, v187
    v_dot2_f32_bf16 v188, v166, v120, v188
    v_dot2_f32_bf16 v189, v166, v121, v189
    v_dot2_f32_bf16 v190, v167, v120, v190
    v_dot2_f32_bf16 v191, v167, v121, v191
    v_dot2_f32_bf16 v184, v168, v120, v184
    v_dot2_f32_bf16 v185, v168, v121, v185
    v_dot2_f32_bf16 v186, v169, v120, v186
    v_dot2_f32_bf16 v187, v169, v121, v187
    v_dot2_f32_bf16 v188, v170, v120, v188
    v_dot2_f32_bf16 v189, v170, v121, v189
    v_dot2_f32_bf16 v190, v171, v120, v190
    v_dot2_f32_bf16 v191, v171, v121, v191
    v_dot2_f32_bf16 v184, v172, v120, v184
    v_dot2_f32_bf16 v185, v172, v121, v185
    v_dot2_f32_bf16 v186, v173, v120, v186
    v_dot2_f32_bf16 v187, v173, v121, v187
SC_e43:
PAD_54:
    s_cbranch_execz SC_ret
    v_dot2_f32_bf16 v188, v174, v120, v188
    v_dot2_f32_bf16 v189, v174, v121, v189
    v_dot2_f32_bf16 v190, v175, v120, v190
    v_dot2_f32_bf16 v191, v175, v121, v191
    v_dot2_f32_bf16 v184, v176, v120, v184
    v_dot2_f32_bf16 v185, v176, v121, v185
    v_dot2_f32_bf16 v186, v177, v120, v186
    v_dot2_f32_bf16 v187, v177, v121, v187
    v_dot2_f32_bf16 v188, v178, v120, v188
    v_dot2_f32_bf16 v189, v178, v121, v189
    v_dot2_f32_bf16 v190, v179, v120, v190
    v_dot2_f32_bf16 v191, v179, v121, v191
    v_dot2_f32_bf16 v184, v180, v120, v184
    v_dot2_f32_bf16 v185, v180, v121, v185
    v_dot2_f32_bf16 v186, v181, v120, v186
    v_dot2_f32_bf16 v187, v181, v121, v187
    v_dot2_f32_bf16 v188, v182, v120, v188
    v_dot2_f32_bf16 v189, v182, v121, v189
    v_dot2_f32_bf16 v190, v183, v120, v190
    v_dot2_f32_bf16 v191, v183, v121, v191
col_chk_11_sum:
    v_mul_f32 v184, 0x45cccccd, v184
    v_mul_f32 v185, 0x45cccccd, v185
    v_mul_f32 v186, 0x45cccccd, v186
    v_mul_f32 v187, 0x45cccccd, v187
    v_mul_f32 v188, 0x45cccccd, v188
    v_mul_f32 v189, 0x45cccccd, v189
    v_mul_f32 v190, 0x45cccccd, v190
    v_mul_f32 v191, 0x45cccccd, v191
    v_rsq_f32 v168, v184
    v_rsq_f32 v169, v185
    v_rsq_f32 v170, v186
    v_rsq_f32 v171, v187
    v_rsq_f32 v172, v188
    v_rsq_f32 v173, v189
SC_e59:
PAD_55:
    s_cbranch_execz PAD_56
    v_rsq_f32 v174, v190
    v_rsq_f32 v175, v191
    v_perm_b32 v120, v88, v88, s54
    v_and_b32 v121, 0xffff0000, v88
    v_perm_b32 v122, v92, v92, s54
    v_and_b32 v123, 0xffff0000, v92
    v_perm_b32 v124, v96, v96, s54
    v_and_b32 v125, 0xffff0000, v96
    v_perm_b32 v126, v100, v100, s54
    v_and_b32 v127, 0xffff0000, v100
    v_pk_mul_f32 v[120:121], v[120:121], v[168:169] op_sel:[0,0] op_sel_hi:[1,0]
    v_pk_fma_f32 v[128:129], v[124:125], v[172:173], v[120:121] op_sel:[0,0,0] op_sel_hi:[1,0,1]
    v_pk_fma_f32 v[130:131], v[124:125], v[172:173], v[120:121] op_sel:[0,0,0] op_sel_hi:[1,0,1] neg_lo:[1,0,0] neg_hi:[1,0,0]
    v_pk_mul_f32 v[122:123], v[122:123], v[170:171] op_sel:[0,0] op_sel_hi:[1,0]
    v_pk_fma_f32 v[132:133], v[126:127], v[174:175], v[122:123] op_sel:[0,0,0] op_sel_hi:[1,0,1]
    v_pk_fma_f32 v[134:135], v[126:127], v[174:175], v[122:123] op_sel:[0,0,0] op_sel_hi:[1,0,1] neg_lo:[1,0,0] neg_hi:[1,0,0]
    v_pk_add_f32 v[120:121], v[128:129], v[132:133]
    v_pk_add_f32 v[122:123], v[130:131], v[134:135] op_sel:[0,1] op_sel_hi:[1,0] neg_hi:[0,1]
    v_pk_add_f32 v[124:125], v[128:129], v[132:133] neg_lo:[0,1] neg_hi:[0,1]
    v_pk_add_f32 v[126:127], v[130:131], v[134:135] op_sel:[0,1] op_sel_hi:[1,0] neg_lo:[0,1]
    v_cvt_pk_bf16_f32 v152, v120, v121
    v_cvt_pk_bf16_f32 v156, v122, v123
    v_cvt_pk_bf16_f32 v160, v124, v125
    v_cvt_pk_bf16_f32 v164, v126, v127
    v_lshlrev_b32 v136, 16, v89
    v_and_b32 v137, 0xffff0000, v89
    v_lshlrev_b32 v138, 16, v93
    v_and_b32 v139, 0xffff0000, v93
    v_lshlrev_b32 v140, 16, v97
    v_and_b32 v141, 0xffff0000, v97
    v_lshlrev_b32 v142, 16, v101
    v_and_b32 v143, 0xffff0000, v101
    v_pk_mul_f32 v[136:137], v[136:137], v[168:169] op_sel:[0,0] op_sel_hi:[1,0]
    v_pk_fma_f32 v[144:145], v[140:141], v[172:173], v[136:137] op_sel:[0,0,0] op_sel_hi:[1,0,1]
    v_pk_fma_f32 v[146:147], v[140:141], v[172:173], v[136:137] op_sel:[0,0,0] op_sel_hi:[1,0,1] neg_lo:[1,0,0] neg_hi:[1,0,0]
PAD_56:
    s_cbranch_execz SC_ret
    v_pk_mul_f32 v[138:139], v[138:139], v[170:171] op_sel:[0,0] op_sel_hi:[1,0]
    v_pk_fma_f32 v[148:149], v[142:143], v[174:175], v[138:139] op_sel:[0,0,0] op_sel_hi:[1,0,1]
    v_pk_fma_f32 v[150:151], v[142:143], v[174:175], v[138:139] op_sel:[0,0,0] op_sel_hi:[1,0,1] neg_lo:[1,0,0] neg_hi:[1,0,0]
    v_pk_add_f32 v[136:137], v[144:145], v[148:149]
    v_pk_add_f32 v[138:139], v[146:147], v[150:151] op_sel:[0,1] op_sel_hi:[1,0] neg_hi:[0,1]
    v_pk_add_f32 v[140:141], v[144:145], v[148:149] neg_lo:[0,1] neg_hi:[0,1]
    v_pk_add_f32 v[142:143], v[146:147], v[150:151] op_sel:[0,1] op_sel_hi:[1,0] neg_lo:[0,1]
    v_cvt_pk_bf16_f32 v154, v136, v137
    v_cvt_pk_bf16_f32 v158, v138, v139
    v_cvt_pk_bf16_f32 v162, v140, v141
    v_cvt_pk_bf16_f32 v166, v142, v143
    v_perm_b32 v120, v90, v90, s54
    v_and_b32 v121, 0xffff0000, v90
    v_perm_b32 v122, v94, v94, s54
    v_and_b32 v123, 0xffff0000, v94
    v_perm_b32 v124, v98, v98, s54
    v_and_b32 v125, 0xffff0000, v98
    v_perm_b32 v126, v102, v102, s54
    v_and_b32 v127, 0xffff0000, v102
    v_pk_mul_f32 v[120:121], v[120:121], v[168:169] op_sel:[0,1] op_sel_hi:[1,1]
    v_pk_fma_f32 v[128:129], v[124:125], v[172:173], v[120:121] op_sel:[0,1,0] op_sel_hi:[1,1,1]
    v_pk_fma_f32 v[130:131], v[124:125], v[172:173], v[120:121] op_sel:[0,1,0] op_sel_hi:[1,1,1] neg_lo:[1,0,0] neg_hi:[1,0,0]
    v_pk_mul_f32 v[122:123], v[122:123], v[170:171] op_sel:[0,1] op_sel_hi:[1,1]
    v_pk_fma_f32 v[132:133], v[126:127], v[174:175], v[122:123] op_sel:[0,1,0] op_sel_hi:[1,1,1]
    v_pk_fma_f32 v[134:135], v[126:127], v[174:175], v[122:123] op_sel:[0,1,0] op_sel_hi:[1,1,1] neg_lo:[1,0,0] neg_hi:[1,0,0]
    v_pk_add_f32 v[120:121], v[128:129], v[132:133]
    v_pk_add_f32 v[122:123], v[130:131], v[134:135] op_sel:[0,1] op_sel_hi:[1,0] neg_hi:[0,1]
    v_pk_add_f32 v[124:125], v[128:129], v[132:133] neg_lo:[0,1] neg_hi:[0,1]
    v_pk_add_f32 v[126:127], v[130:131], v[134:135] op_sel:[0,1] op_sel_hi:[1,0] neg_lo:[0,1]
    v_cvt_pk_bf16_f32 v153, v120, v121
    v_cvt_pk_bf16_f32 v157, v122, v123
SC_e12:
PAD_57:
    s_cbranch_execz SC_ret
    v_cvt_pk_bf16_f32 v161, v124, v125
    v_cvt_pk_bf16_f32 v165, v126, v127
    v_lshlrev_b32 v136, 16, v91
    v_and_b32 v137, 0xffff0000, v91
    v_lshlrev_b32 v138, 16, v95
    v_and_b32 v139, 0xffff0000, v95
    v_lshlrev_b32 v140, 16, v99
    v_and_b32 v141, 0xffff0000, v99
    v_lshlrev_b32 v142, 16, v103
    v_and_b32 v143, 0xffff0000, v103
    v_pk_mul_f32 v[136:137], v[136:137], v[168:169] op_sel:[0,1] op_sel_hi:[1,1]
    v_pk_fma_f32 v[144:145], v[140:141], v[172:173], v[136:137] op_sel:[0,1,0] op_sel_hi:[1,1,1]
    v_pk_fma_f32 v[146:147], v[140:141], v[172:173], v[136:137] op_sel:[0,1,0] op_sel_hi:[1,1,1] neg_lo:[1,0,0] neg_hi:[1,0,0]
    v_pk_mul_f32 v[138:139], v[138:139], v[170:171] op_sel:[0,1] op_sel_hi:[1,1]
    v_pk_fma_f32 v[148:149], v[142:143], v[174:175], v[138:139] op_sel:[0,1,0] op_sel_hi:[1,1,1]
    v_pk_fma_f32 v[150:151], v[142:143], v[174:175], v[138:139] op_sel:[0,1,0] op_sel_hi:[1,1,1] neg_lo:[1,0,0] neg_hi:[1,0,0]
    v_pk_add_f32 v[136:137], v[144:145], v[148:149]
    v_pk_add_f32 v[138:139], v[146:147], v[150:151] op_sel:[0,1] op_sel_hi:[1,0] neg_hi:[0,1]
    v_pk_add_f32 v[140:141], v[144:145], v[148:149] neg_lo:[0,1] neg_hi:[0,1]
    v_pk_add_f32 v[142:143], v[146:147], v[150:151] op_sel:[0,1] op_sel_hi:[1,0] neg_lo:[0,1]
    v_cvt_pk_bf16_f32 v155, v136, v137
    v_cvt_pk_bf16_f32 v159, v138, v139
    v_cvt_pk_bf16_f32 v163, v140, v141
    v_cvt_pk_bf16_f32 v167, v142, v143
    ds_write_b64 v81, v[152:153] offset:0
    ds_write_b64 v81, v[154:155] offset:2048
    ds_write_b64 v81, v[156:157] offset:4096
    ds_write_b64 v81, v[158:159] offset:6144
    ds_write_b64 v81, v[160:161] offset:8192
    ds_write_b64 v81, v[162:163] offset:10240
    ds_write_b64 v81, v[164:165] offset:12288
    ds_write_b64 v81, v[166:167] offset:14336
    s_waitcnt lgkmcnt(0)
    s_barrier
    ds_read_b128 v[168:171], v82 offset:0
SC_e28:
PAD_58:
    s_cbranch_execz SC_ret
    ds_read_b128 v[172:175], v82 offset:1024
    ds_read_b128 v[176:179], v82 offset:2048
    ds_read_b128 v[180:183], v82 offset:3072
    s_cmp_lg_u32 s63, 0
    s_cbranch_scc1 first_15
    s_waitcnt vmcnt(0)
    v_or3_b32 v184, v252, v253, v254
    v_bitop3_b32 v184, v184, v255, 2 bitop3:0xa8
    v_cmp_ne_u32 vcc, 0, v184
    s_nop 3
    s_cmp_lg_u64 vcc, 0
    s_cbranch_scc1 flg_retry_17
flg_16:
first_15:
    s_cmp_eq_u32 s63, 0
    s_cselect_b64 vcc, -1, 0
    s_waitcnt lgkmcnt(3)
    v_mfma_f32_16x16x32_bf16 v[120:123], v[168:171], v[8:11], 0
    s_waitcnt lgkmcnt(2)
    v_mfma_f32_16x16x32_bf16 v[124:127], v[172:175], v[8:11], 0
    v_mfma_f32_16x16x32_bf16 v[128:131], v[168:171], v[12:15], 0
    v_mfma_f32_16x16x32_bf16 v[132:135], v[172:175], v[12:15], 0
    s_waitcnt lgkmcnt(1)
    v_mfma_f32_16x16x32_bf16 v[136:139], v[176:179], v[8:11], 0
    s_waitcnt lgkmcnt(0)
    v_mfma_f32_16x16x32_bf16 v[140:143], v[180:183], v[8:11], 0
    v_mfma_f32_16x16x32_bf16 v[144:147], v[176:179], v[12:15], 0
    v_mfma_f32_16x16x32_bf16 v[148:151], v[180:183], v[12:15], 0
    s_mov_b32 s51, 0x730000
    buffer_load_dwordx4 a[0:3], v4, s[32:35], s51 offen offset:0 sc1
    v_pk_mul_f32 v[184:185], v[120:121], v[16:17]
    v_pk_mul_f32 v[186:187], v[120:121], v[24:25]
    v_pk_fma_f32 v[184:185], v[128:129], v[24:25], v[184:185] neg_lo:[1,0,0] neg_hi:[1,0,0]
    v_pk_fma_f32 v[186:187], v[128:129], v[16:17], v[186:187]
    v_cvt_pk_bf16_f32 v120, v184, v185
    v_cvt_pk_bf16_f32 v128, v186, v187
    v_pk_mul_f32 v[184:185], v[122:123], v[18:19]
    v_pk_mul_f32 v[186:187], v[122:123], v[26:27]
    buffer_load_dwordx4 a[4:7], v4, s[32:35], s51 offen offset:128 sc1
    v_pk_fma_f32 v[184:185], v[130:131], v[26:27], v[184:185] neg_lo:[1,0,0] neg_hi:[1,0,0]
SC_e44:
PAD_59:
    s_cbranch_execz SC_ret
    v_pk_fma_f32 v[186:187], v[130:131], v[18:19], v[186:187]
    v_cvt_pk_bf16_f32 v121, v184, v185
    v_cvt_pk_bf16_f32 v129, v186, v187
    v_pk_mul_f32 v[184:185], v[124:125], v[20:21]
    v_pk_mul_f32 v[186:187], v[124:125], v[28:29]
    v_pk_fma_f32 v[184:185], v[132:133], v[28:29], v[184:185] neg_lo:[1,0,0] neg_hi:[1,0,0]
    v_pk_fma_f32 v[186:187], v[132:133], v[20:21], v[186:187]
    buffer_load_dwordx4 a[8:11], v4, s[32:35], s51 offen offset:2048 sc1
    v_cvt_pk_bf16_f32 v122, v184, v185
    v_cvt_pk_bf16_f32 v130, v186, v187
    v_pk_mul_f32 v[184:185], v[126:127], v[22:23]
    v_pk_mul_f32 v[186:187], v[126:127], v[30:31]
    v_pk_fma_f32 v[184:185], v[134:135], v[30:31], v[184:185] neg_lo:[1,0,0] neg_hi:[1,0,0]
    v_pk_fma_f32 v[186:187], v[134:135], v[22:23], v[186:187]
    v_cvt_pk_bf16_f32 v123, v184, v185
    v_cvt_pk_bf16_f32 v131, v186, v187
    buffer_load_dwordx4 a[12:15], v4, s[32:35], s51 offen offset:2176 sc1
    v_mfma_f32_16x16x32_bf16 v[152:155], v[32:35], v[120:123], 0
    v_mfma_f32_16x16x32_bf16 v[160:163], v[48:51], v[120:123], 0
    v_mfma_f32_16x16x32_bf16 v[156:159], v[36:39], v[120:123], 0
    v_mfma_f32_16x16x32_bf16 v[164:167], v[52:55], v[120:123], 0
    v_mfma_f32_16x16x32_bf16 v[152:155], v[40:43], v[128:131], v[152:155]
    v_mfma_f32_16x16x32_bf16 v[160:163], v[32:35], v[128:131], v[160:163]
    v_mfma_f32_16x16x32_bf16 v[156:159], v[44:47], v[128:131], v[156:159]
    v_mfma_f32_16x16x32_bf16 v[164:167], v[36:39], v[128:131], v[164:167]
    s_mov_b32 s51, 0x731000
    buffer_load_dwordx4 a[16:19], v4, s[32:35], s51 offen offset:0 sc1
    v_pk_mul_f32 v[184:185], v[136:137], v[16:17]
    v_pk_mul_f32 v[186:187], v[136:137], v[24:25]
    v_pk_fma_f32 v[184:185], v[144:145], v[24:25], v[184:185] neg_lo:[1,0,0] neg_hi:[1,0,0]
    v_pk_fma_f32 v[186:187], v[144:145], v[16:17], v[186:187]
SC_e60:
PAD_60:
    s_cbranch_execz PAD_61
    v_cvt_pk_bf16_f32 v136, v184, v185
    v_cvt_pk_bf16_f32 v144, v186, v187
    v_pk_mul_f32 v[184:185], v[138:139], v[18:19]
    v_pk_mul_f32 v[186:187], v[138:139], v[26:27]
    buffer_load_dwordx4 a[20:23], v4, s[32:35], s51 offen offset:128 sc1
    v_pk_fma_f32 v[184:185], v[146:147], v[26:27], v[184:185] neg_lo:[1,0,0] neg_hi:[1,0,0]
    v_pk_fma_f32 v[186:187], v[146:147], v[18:19], v[186:187]
    v_cvt_pk_bf16_f32 v137, v184, v185
    v_cvt_pk_bf16_f32 v145, v186, v187
    v_pk_mul_f32 v[184:185], v[140:141], v[20:21]
    v_pk_mul_f32 v[186:187], v[140:141], v[28:29]
    v_pk_fma_f32 v[184:185], v[148:149], v[28:29], v[184:185] neg_lo:[1,0,0] neg_hi:[1,0,0]
    v_pk_fma_f32 v[186:187], v[148:149], v[20:21], v[186:187]
    buffer_load_dwordx4 a[24:27], v4, s[32:35], s51 offen offset:2048 sc1
    v_cvt_pk_bf16_f32 v138, v184, v185
    v_cvt_pk_bf16_f32 v146, v186, v187
    v_pk_mul_f32 v[184:185], v[142:143], v[22:23]
    v_pk_mul_f32 v[186:187], v[142:143], v[30:31]
    v_pk_fma_f32 v[184:185], v[150:151], v[30:31], v[184:185] neg_lo:[1,0,0] neg_hi:[1,0,0]
    v_pk_fma_f32 v[186:187], v[150:151], v[22:23], v[186:187]
    v_cvt_pk_bf16_f32 v139, v184, v185
    v_cvt_pk_bf16_f32 v147, v186, v187
    buffer_load_dwordx4 a[28:31], v4, s[32:35], s51 offen offset:2176 sc1
    v_mfma_f32_16x16x32_bf16 v[168:171], v[32:35], v[136:139], 0
    v_mfma_f32_16x16x32_bf16 v[176:179], v[48:51], v[136:139], 0
    v_mfma_f32_16x16x32_bf16 v[172:175], v[36:39], v[136:139], 0
    v_mfma_f32_16x16x32_bf16 v[180:183], v[52:55], v[136:139], 0
    v_mfma_f32_16x16x32_bf16 v[168:171], v[40:43], v[144:147], v[168:171]
    v_mfma_f32_16x16x32_bf16 v[176:179], v[32:35], v[144:147], v[176:179]
    v_mfma_f32_16x16x32_bf16 v[172:175], v[44:47], v[144:147], v[172:175]
    v_mfma_f32_16x16x32_bf16 v[180:183], v[36:39], v[144:147], v[180:183]
    s_mov_b32 s51, 0x732000
PAD_61:
    s_cbranch_execz SC_ret
    buffer_load_dwordx4 a[32:35], v4, s[32:35], s51 offen offset:0 sc1
    s_waitcnt vmcnt(10)
    v_mov_b32 v184, v116
    v_lshlrev_b32 v188, 16, v104
    v_and_b32 v190, 0xffff0000, v104
    v_lshlrev_b32 v189, 16, v106
    v_and_b32 v191, 0xffff0000, v106
    v_pk_mul_f32 v[184:185], v[152:153], v[188:189]
    v_pk_mul_f32 v[186:187], v[152:153], v[190:191]
    v_pk_fma_f32 v[184:185], v[160:161], v[190:191], v[184:185] neg_lo:[1,0,0] neg_hi:[1,0,0]
    buffer_load_dwordx4 a[36:39], v4, s[32:35], s51 offen offset:128 sc1
    v_pk_fma_f32 v[186:187], v[160:161], v[188:189], v[186:187]
    v_cvt_pk_bf16_f32 v152, v184, v185
    v_cvt_pk_bf16_f32 v160, v186, v187
    v_lshlrev_b32 v188, 16, v108
    v_and_b32 v190, 0xffff0000, v108
    v_lshlrev_b32 v189, 16, v110
    v_and_b32 v191, 0xffff0000, v110
    v_pk_mul_f32 v[184:185], v[154:155], v[188:189]
    buffer_load_dwordx4 a[40:43], v4, s[32:35], s51 offen offset:2048 sc1
    v_pk_mul_f32 v[186:187], v[154:155], v[190:191]
    v_pk_fma_f32 v[184:185], v[162:163], v[190:191], v[184:185] neg_lo:[1,0,0] neg_hi:[1,0,0]
    v_pk_fma_f32 v[186:187], v[162:163], v[188:189], v[186:187]
    v_cvt_pk_bf16_f32 v153, v184, v185
    v_cvt_pk_bf16_f32 v161, v186, v187
    v_lshlrev_b32 v188, 16, v112
    v_and_b32 v190, 0xffff0000, v112
    v_lshlrev_b32 v189, 16, v114
    buffer_load_dwordx4 a[44:47], v4, s[32:35], s51 offen offset:2176 sc1
    v_and_b32 v191, 0xffff0000, v114
    v_pk_mul_f32 v[184:185], v[156:157], v[188:189]
    v_pk_mul_f32 v[186:187], v[156:157], v[190:191]
    v_pk_fma_f32 v[184:185], v[164:165], v[190:191], v[184:185] neg_lo:[1,0,0] neg_hi:[1,0,0]
    v_pk_fma_f32 v[186:187], v[164:165], v[188:189], v[186:187]
    v_cvt_pk_bf16_f32 v154, v184, v185
SC_e13:
PAD_62:
    s_cbranch_execz SC_ret
    v_cvt_pk_bf16_f32 v162, v186, v187
    v_lshlrev_b32 v188, 16, v116
    s_mov_b32 s51, 0x733000
    buffer_load_dwordx4 a[48:51], v4, s[32:35], s51 offen offset:0 sc1
    v_and_b32 v190, 0xffff0000, v116
    v_lshlrev_b32 v189, 16, v118
    v_and_b32 v191, 0xffff0000, v118
    v_pk_mul_f32 v[184:185], v[158:159], v[188:189]
    v_pk_mul_f32 v[186:187], v[158:159], v[190:191]
    v_pk_fma_f32 v[184:185], v[166:167], v[190:191], v[184:185] neg_lo:[1,0,0] neg_hi:[1,0,0]
    v_pk_fma_f32 v[186:187], v[166:167], v[188:189], v[186:187]
    v_cvt_pk_bf16_f32 v155, v184, v185
    buffer_load_dwordx4 a[52:55], v4, s[32:35], s51 offen offset:128 sc1
    v_cvt_pk_bf16_f32 v163, v186, v187
    v_mfma_f32_16x16x32_bf16 v[120:123], v[152:155], v[32:35], 0
    v_mfma_f32_16x16x32_bf16 v[128:131], v[152:155], v[40:43], 0
    v_mfma_f32_16x16x32_bf16 v[124:127], v[152:155], v[36:39], 0
    v_mfma_f32_16x16x32_bf16 v[132:135], v[152:155], v[44:47], 0
    v_mfma_f32_16x16x32_bf16 v[120:123], v[160:163], v[48:51], v[120:123]
    v_mfma_f32_16x16x32_bf16 v[128:131], v[160:163], v[32:35], v[128:131]
    v_mfma_f32_16x16x32_bf16 v[124:127], v[160:163], v[52:55], v[124:127]
    buffer_load_dwordx4 a[56:59], v4, s[32:35], s51 offen offset:2048 sc1
    v_mfma_f32_16x16x32_bf16 v[132:135], v[160:163], v[36:39], v[132:135]
    v_lshlrev_b32 v188, 16, v105
    v_and_b32 v190, 0xffff0000, v105
    v_lshlrev_b32 v189, 16, v107
    v_and_b32 v191, 0xffff0000, v107
    v_pk_mul_f32 v[184:185], v[168:169], v[188:189]
    v_pk_mul_f32 v[186:187], v[168:169], v[190:191]
    v_pk_fma_f32 v[184:185], v[176:177], v[190:191], v[184:185] neg_lo:[1,0,0] neg_hi:[1,0,0]
    buffer_load_dwordx4 a[60:63], v4, s[32:35], s51 offen offset:2176 sc1
    v_pk_fma_f32 v[186:187], v[176:177], v[188:189], v[186:187]
    v_cvt_pk_bf16_f32 v168, v184, v185
    v_cvt_pk_bf16_f32 v176, v186, v187
SC_e29:
PAD_63:
    s_cbranch_execz SC_ret
    v_lshlrev_b32 v188, 16, v109
    v_and_b32 v190, 0xffff0000, v109
    v_lshlrev_b32 v189, 16, v111
    v_and_b32 v191, 0xffff0000, v111
    v_pk_mul_f32 v[184:185], v[170:171], v[188:189]
    s_mov_b32 s51, 0x734000
    buffer_load_dwordx4 a[64:67], v4, s[32:35], s51 offen offset:0 sc1
    v_pk_mul_f32 v[186:187], v[170:171], v[190:191]
    v_pk_fma_f32 v[184:185], v[178:179], v[190:191], v[184:185] neg_lo:[1,0,0] neg_hi:[1,0,0]
    v_pk_fma_f32 v[186:187], v[178:179], v[188:189], v[186:187]
    v_cvt_pk_bf16_f32 v169, v184, v185
    v_cvt_pk_bf16_f32 v177, v186, v187
    v_lshlrev_b32 v188, 16, v113
    v_and_b32 v190, 0xffff0000, v113
    v_lshlrev_b32 v189, 16, v115
    buffer_load_dwordx4 a[68:71], v4, s[32:35], s51 offen offset:128 sc1
    v_and_b32 v191, 0xffff0000, v115
    v_pk_mul_f32 v[184:185], v[172:173], v[188:189]
    v_pk_mul_f32 v[186:187], v[172:173], v[190:191]
    v_pk_fma_f32 v[184:185], v[180:181], v[190:191], v[184:185] neg_lo:[1,0,0] neg_hi:[1,0,0]
    v_pk_fma_f32 v[186:187], v[180:181], v[188:189], v[186:187]
    v_cvt_pk_bf16_f32 v170, v184, v185
    v_cvt_pk_bf16_f32 v178, v186, v187
    v_lshlrev_b32 v188, 16, v117
    buffer_load_dwordx4 a[72:75], v4, s[32:35], s51 offen offset:2048 sc1
    v_and_b32 v190, 0xffff0000, v117
    v_lshlrev_b32 v189, 16, v119
    v_and_b32 v191, 0xffff0000, v119
    v_pk_mul_f32 v[184:185], v[174:175], v[188:189]
    v_pk_mul_f32 v[186:187], v[174:175], v[190:191]
    v_pk_fma_f32 v[184:185], v[182:183], v[190:191], v[184:185] neg_lo:[1,0,0] neg_hi:[1,0,0]
    v_pk_fma_f32 v[186:187], v[182:183], v[188:189], v[186:187]
    v_cvt_pk_bf16_f32 v171, v184, v185
    buffer_load_dwordx4 a[76:79], v4, s[32:35], s51 offen offset:2176 sc1
SC_e45:
PAD_64:
    s_cbranch_execz SC_ret
    v_cvt_pk_bf16_f32 v179, v186, v187
    v_mfma_f32_16x16x32_bf16 v[136:139], v[168:171], v[32:35], 0
    v_mfma_f32_16x16x32_bf16 v[144:147], v[168:171], v[40:43], 0
    v_mfma_f32_16x16x32_bf16 v[140:143], v[168:171], v[36:39], 0
    v_mfma_f32_16x16x32_bf16 v[148:151], v[168:171], v[44:47], 0
    v_mfma_f32_16x16x32_bf16 v[136:139], v[176:179], v[48:51], v[136:139]
    v_mfma_f32_16x16x32_bf16 v[144:147], v[176:179], v[32:35], v[144:147]
    v_mfma_f32_16x16x32_bf16 v[140:143], v[176:179], v[52:55], v[140:143]
    s_mov_b32 s51, 0x735000
    buffer_load_dwordx4 a[80:83], v4, s[32:35], s51 offen offset:0 sc1
    v_mfma_f32_16x16x32_bf16 v[148:151], v[176:179], v[36:39], v[148:151]
    v_pk_mul_f32 v[184:185], v[120:121], v[56:57]
    v_pk_mul_f32 v[186:187], v[120:121], v[64:65]
    v_pk_fma_f32 v[184:185], v[128:129], v[64:65], v[184:185] neg_lo:[1,0,0] neg_hi:[1,0,0]
    v_pk_fma_f32 v[186:187], v[128:129], v[56:57], v[186:187]
    v_cvt_pk_bf16_f32 v120, v184, v186
    v_cvt_pk_bf16_f32 v121, v185, v187
    v_pk_mul_f32 v[184:185], v[122:123], v[58:59]
    buffer_load_dwordx4 a[84:87], v4, s[32:35], s51 offen offset:128 sc1
    v_pk_mul_f32 v[186:187], v[122:123], v[66:67]
    v_pk_fma_f32 v[184:185], v[130:131], v[66:67], v[184:185] neg_lo:[1,0,0] neg_hi:[1,0,0]
    v_pk_fma_f32 v[186:187], v[130:131], v[58:59], v[186:187]
    v_cvt_pk_bf16_f32 v122, v184, v186
    v_cvt_pk_bf16_f32 v123, v185, v187
    v_pk_mul_f32 v[184:185], v[124:125], v[60:61]
    v_pk_mul_f32 v[186:187], v[124:125], v[68:69]
    v_pk_fma_f32 v[184:185], v[132:133], v[68:69], v[184:185] neg_lo:[1,0,0] neg_hi:[1,0,0]
    buffer_load_dwordx4 a[88:91], v4, s[32:35], s51 offen offset:2048 sc1
    v_pk_fma_f32 v[186:187], v[132:133], v[60:61], v[186:187]
    v_cvt_pk_bf16_f32 v124, v184, v186
    v_cvt_pk_bf16_f32 v125, v185, v187
    v_pk_mul_f32 v[184:185], v[126:127], v[62:63]
SC_e61:
PAD_65:
    s_cbranch_execz SC_ret
    v_pk_mul_f32 v[186:187], v[126:127], v[70:71]
    v_pk_fma_f32 v[184:185], v[134:135], v[70:71], v[184:185] neg_lo:[1,0,0] neg_hi:[1,0,0]
    v_pk_fma_f32 v[186:187], v[134:135], v[62:63], v[186:187]
    v_cvt_pk_bf16_f32 v126, v184, v186
    buffer_load_dwordx4 a[92:95], v4, s[32:35], s51 offen offset:2176 sc1
    v_cvt_pk_bf16_f32 v127, v185, v187
    v_mfma_f32_16x16x32_bf16 v[152:155], v[72:75], v[120:123], 0
    v_mfma_f32_16x16x32_bf16 v[156:159], v[76:79], v[120:123], 0
    v_mfma_f32_16x16x32_bf16 v[160:163], v[72:75], v[124:127], 0
    v_mfma_f32_16x16x32_bf16 v[164:167], v[76:79], v[124:127], 0
    v_mov_b32 v190, v83
    v_xor_b32 v191, 64, v83
    v_pk_mul_f32 v[184:185], v[136:137], v[56:57]
    s_mov_b32 s51, 0x736000
    buffer_load_dwordx4 a[96:99], v4, s[32:35], s51 offen offset:0 sc1
    v_pk_mul_f32 v[186:187], v[136:137], v[64:65]
    v_pk_fma_f32 v[184:185], v[144:145], v[64:65], v[184:185] neg_lo:[1,0,0] neg_hi:[1,0,0]
    v_pk_fma_f32 v[186:187], v[144:145], v[56:57], v[186:187]
    v_cvt_pk_bf16_f32 v136, v184, v186
    v_cvt_pk_bf16_f32 v137, v185, v187
    v_pk_mul_f32 v[184:185], v[138:139], v[58:59]
    v_pk_mul_f32 v[186:187], v[138:139], v[66:67]
    v_pk_fma_f32 v[184:185], v[146:147], v[66:67], v[184:185] neg_lo:[1,0,0] neg_hi:[1,0,0]
    buffer_load_dwordx4 a[100:103], v4, s[32:35], s51 offen offset:128 sc1
    v_pk_fma_f32 v[186:187], v[146:147], v[58:59], v[186:187]
    v_cvt_pk_bf16_f32 v138, v184, v186
    v_cvt_pk_bf16_f32 v139, v185, v187
    v_pk_mul_f32 v[184:185], v[140:141], v[60:61]
    v_pk_mul_f32 v[186:187], v[140:141], v[68:69]
    v_pk_fma_f32 v[184:185], v[148:149], v[68:69], v[184:185] neg_lo:[1,0,0] neg_hi:[1,0,0]
    v_pk_fma_f32 v[186:187], v[148:149], v[60:61], v[186:187]
    v_cvt_pk_bf16_f32 v140, v184, v186
SC_e14:
PAD_66:
    s_cbranch_execz PAD_67
    buffer_load_dwordx4 a[104:107], v4, s[32:35], s51 offen offset:2048 sc1
    v_cvt_pk_bf16_f32 v141, v185, v187
    v_pk_mul_f32 v[184:185], v[142:143], v[62:63]
    v_pk_mul_f32 v[186:187], v[142:143], v[70:71]
    v_pk_fma_f32 v[184:185], v[150:151], v[70:71], v[184:185] neg_lo:[1,0,0] neg_hi:[1,0,0]
    v_pk_fma_f32 v[186:187], v[150:151], v[62:63], v[186:187]
    v_cvt_pk_bf16_f32 v142, v184, v186
    v_cvt_pk_bf16_f32 v143, v185, v187
    ds_write_b128 v190, v[152:155] offset:16384
    buffer_load_dwordx4 a[108:111], v4, s[32:35], s51 offen offset:2176 sc1
    ds_write_b128 v191, v[156:159] offset:16384
    ds_write_b128 v190, v[160:163] offset:16896
    ds_write_b128 v191, v[164:167] offset:16896
    v_mfma_f32_16x16x32_bf16 v[168:171], v[72:75], v[136:139], 0
    v_mfma_f32_16x16x32_bf16 v[172:175], v[76:79], v[136:139], 0
    v_mfma_f32_16x16x32_bf16 v[176:179], v[72:75], v[140:143], 0
    v_mfma_f32_16x16x32_bf16 v[180:183], v[76:79], v[140:143], 0
    s_nop 4
    ds_write_b128 v190, v[168:171] offset:20480
    s_mov_b32 s51, 0x737000
    buffer_load_dwordx4 a[112:115], v4, s[32:35], s51 offen offset:0 sc1
    ds_write_b128 v191, v[172:175] offset:20480
    ds_write_b128 v190, v[176:179] offset:20992
    ds_write_b128 v191, v[180:183] offset:20992
    s_waitcnt lgkmcnt(0)
    s_barrier
    s_mov_b32 s49, 0x10000
    s_or_b32 s50, s16, 1
    ds_read_b128 v[120:123], v84 offset:16384
    ds_read_b128 v[124:127], v84 offset:24576
    buffer_load_dwordx4 a[116:119], v4, s[32:35], s51 offen offset:128 sc1
    ds_read_b128 v[128:131], v84 offset:32768
    ds_read_b128 v[132:135], v84 offset:40960
    ds_read_b128 v[136:139], v84 offset:20480
PAD_67:
    s_cbranch_execz SC_ret
    ds_read_b128 v[140:143], v84 offset:28672
    ds_read_b128 v[144:147], v84 offset:36864
    ds_read_b128 v[148:151], v84 offset:45056
    v_lshlrev_b32 v152, 16, v88
    v_and_b32 v153, 0xffff0000, v88
    buffer_load_dwordx4 a[120:123], v4, s[32:35], s51 offen offset:2048 sc1
    v_lshlrev_b32 v154, 16, v92
    v_and_b32 v155, 0xffff0000, v92
    v_lshlrev_b32 v156, 16, v96
    v_and_b32 v157, 0xffff0000, v96
    v_lshlrev_b32 v158, 16, v100
    v_and_b32 v159, 0xffff0000, v100
    s_waitcnt lgkmcnt(5)
    v_pk_add_f32 v[160:161], v[120:121], v[128:129]
    v_pk_add_f32 v[162:163], v[120:121], v[128:129] neg_lo:[0,1] neg_hi:[0,1]
    buffer_load_dwordx4 a[124:127], v4, s[32:35], s51 offen offset:2176 sc1
    s_waitcnt lgkmcnt(4)
    v_pk_add_f32 v[164:165], v[124:125], v[132:133]
    v_pk_add_f32 v[166:167], v[124:125], v[132:133] neg_lo:[0,1] neg_hi:[0,1]
    v_pk_add_f32 v[184:185], v[160:161], v[164:165]
    v_pk_add_f32 v[186:187], v[162:163], v[166:167] op_sel:[0,1] op_sel_hi:[1,0] neg_lo:[0,1]
    v_pk_add_f32 v[188:189], v[160:161], v[164:165] neg_lo:[0,1] neg_hi:[0,1]
    v_pk_add_f32 v[190:191], v[162:163], v[166:167] op_sel:[0,1] op_sel_hi:[1,0] neg_hi:[0,1]
    v_pk_fma_f32 v[152:153], v[184:185], s[56:57], v[152:153]
    v_and_or_b32 v152, v152, v3, s49
    s_mov_b32 s51, 0x738000
    buffer_load_dwordx4 a[128:131], v4, s[32:35], s51 offen offset:0 sc1
    v_add_u32 v153, s15, v153
    v_and_or_b32 v153, v153, v3, s16
    v_cvt_pk_bf16_f32 v88, v152, v153
    v_or_b32 v88, s50, v88
    v_pk_fma_f32 v[154:155], v[186:187], s[56:57], v[154:155]
    v_and_or_b32 v154, v154, v3, s49
    v_add_u32 v155, s15, v155
    v_and_or_b32 v155, v155, v3, s16
    buffer_load_dwordx4 a[132:135], v4, s[32:35], s51 offen offset:128 sc1
SC_e30:
PAD_68:
    s_cbranch_execz SC_ret
    v_cvt_pk_bf16_f32 v92, v154, v155
    v_or_b32 v92, s50, v92
    v_pk_fma_f32 v[156:157], v[188:189], s[56:57], v[156:157]
    v_and_or_b32 v156, v156, v3, s49
    v_add_u32 v157, s15, v157
    v_and_or_b32 v157, v157, v3, s16
    v_cvt_pk_bf16_f32 v96, v156, v157
    v_or_b32 v96, s50, v96
    buffer_load_dwordx4 a[136:139], v4, s[32:35], s51 offen offset:2048 sc1
    v_pk_fma_f32 v[158:159], v[190:191], s[56:57], v[158:159]
    v_and_or_b32 v158, v158, v3, s49
    v_add_u32 v159, s15, v159
    v_and_or_b32 v159, v159, v3, s16
    v_cvt_pk_bf16_f32 v100, v158, v159
    v_or_b32 v100, s50, v100
    v_lshlrev_b32 v168, 16, v90
    v_and_b32 v169, 0xffff0000, v90
    buffer_load_dwordx4 a[140:143], v4, s[32:35], s51 offen offset:2176 sc1
    v_lshlrev_b32 v170, 16, v94
    v_and_b32 v171, 0xffff0000, v94
    v_lshlrev_b32 v172, 16, v98
    v_and_b32 v173, 0xffff0000, v98
    v_lshlrev_b32 v174, 16, v102
    v_and_b32 v175, 0xffff0000, v102
    v_pk_add_f32 v[176:177], v[122:123], v[130:131]
    v_pk_add_f32 v[178:179], v[122:123], v[130:131] neg_lo:[0,1] neg_hi:[0,1]
    s_mov_b32 s51, 0x730000
    buffer_load_dwordx4 v[192:195], v5, s[32:35], s51 offen offset:0 sc1
    v_pk_add_f32 v[180:181], v[126:127], v[134:135]
    v_pk_add_f32 v[182:183], v[126:127], v[134:135] neg_lo:[0,1] neg_hi:[0,1]
    v_pk_add_f32 v[184:185], v[176:177], v[180:181]
    v_pk_add_f32 v[186:187], v[178:179], v[182:183] op_sel:[0,1] op_sel_hi:[1,0] neg_lo:[0,1]
    v_pk_add_f32 v[188:189], v[176:177], v[180:181] neg_lo:[0,1] neg_hi:[0,1]
    v_pk_add_f32 v[190:191], v[178:179], v[182:183] op_sel:[0,1] op_sel_hi:[1,0] neg_hi:[0,1]
    v_pk_fma_f32 v[168:169], v[184:185], s[56:57], v[168:169]
    v_cvt_pk_bf16_f32 v90, v168, v169
SC_e46:
PAD_69:
    s_cbranch_execz SC_ret
    buffer_load_dwordx4 v[196:199], v5, s[32:35], s51 offen offset:128 sc1
    v_pk_fma_f32 v[170:171], v[186:187], s[56:57], v[170:171]
    v_cvt_pk_bf16_f32 v94, v170, v171
    v_pk_fma_f32 v[172:173], v[188:189], s[56:57], v[172:173]
    v_cvt_pk_bf16_f32 v98, v172, v173
    v_pk_fma_f32 v[174:175], v[190:191], s[56:57], v[174:175]
    v_cvt_pk_bf16_f32 v102, v174, v175
    v_lshlrev_b32 v152, 16, v89
    v_and_b32 v153, 0xffff0000, v89
    buffer_load_dwordx4 v[200:203], v5, s[32:35], s51 offen offset:2048 sc1
    v_lshlrev_b32 v154, 16, v93
    v_and_b32 v155, 0xffff0000, v93
    v_lshlrev_b32 v156, 16, v97
    v_and_b32 v157, 0xffff0000, v97
    v_lshlrev_b32 v158, 16, v101
    v_and_b32 v159, 0xffff0000, v101
    s_waitcnt lgkmcnt(1)
    v_pk_add_f32 v[160:161], v[136:137], v[144:145]
    v_pk_add_f32 v[162:163], v[136:137], v[144:145] neg_lo:[0,1] neg_hi:[0,1]
    buffer_load_dwordx4 v[204:207], v5, s[32:35], s51 offen offset:2176 sc1
    s_waitcnt lgkmcnt(0)
    v_pk_add_f32 v[164:165], v[140:141], v[148:149]
    v_pk_add_f32 v[166:167], v[140:141], v[148:149] neg_lo:[0,1] neg_hi:[0,1]
    v_pk_add_f32 v[184:185], v[160:161], v[164:165]
    v_pk_add_f32 v[186:187], v[162:163], v[166:167] op_sel:[0,1] op_sel_hi:[1,0] neg_lo:[0,1]
    v_pk_add_f32 v[188:189], v[160:161], v[164:165] neg_lo:[0,1] neg_hi:[0,1]
    v_pk_add_f32 v[190:191], v[162:163], v[166:167] op_sel:[0,1] op_sel_hi:[1,0] neg_hi:[0,1]
    v_pk_add_f32 v[152:153], v[184:185], v[152:153]
    v_cvt_pk_bf16_f32 v89, v152, v153
    s_mov_b32 s51, 0x731000
    buffer_load_dwordx4 v[208:211], v5, s[32:35], s51 offen offset:0 sc1
    v_pk_add_f32 v[154:155], v[186:187], v[154:155]
    v_cvt_pk_bf16_f32 v93, v154, v155
    v_pk_add_f32 v[156:157], v[188:189], v[156:157]
SC_e62:
PAD_70:
    s_cbranch_execz SC_ret
    v_cvt_pk_bf16_f32 v97, v156, v157
    v_pk_add_f32 v[158:159], v[190:191], v[158:159]
    v_cvt_pk_bf16_f32 v101, v158, v159
    v_lshlrev_b32 v168, 16, v91
    v_and_b32 v169, 0xffff0000, v91
    buffer_load_dwordx4 v[212:215], v5, s[32:35], s51 offen offset:128 sc1
    v_lshlrev_b32 v170, 16, v95
    v_and_b32 v171, 0xffff0000, v95
    v_lshlrev_b32 v172, 16, v99
    v_and_b32 v173, 0xffff0000, v99
    v_lshlrev_b32 v174, 16, v103
    v_and_b32 v175, 0xffff0000, v103
    v_pk_add_f32 v[176:177], v[138:139], v[146:147]
    v_pk_add_f32 v[178:179], v[138:139], v[146:147] neg_lo:[0,1] neg_hi:[0,1]
    buffer_load_dwordx4 v[216:219], v5, s[32:35], s51 offen offset:2048 sc1
    v_pk_add_f32 v[180:181], v[142:143], v[150:151]
    v_pk_add_f32 v[182:183], v[142:143], v[150:151] neg_lo:[0,1] neg_hi:[0,1]
    v_pk_add_f32 v[184:185], v[176:177], v[180:181]
    v_pk_add_f32 v[186:187], v[178:179], v[182:183] op_sel:[0,1] op_sel_hi:[1,0] neg_lo:[0,1]
    v_pk_add_f32 v[188:189], v[176:177], v[180:181] neg_lo:[0,1] neg_hi:[0,1]
    v_pk_add_f32 v[190:191], v[178:179], v[182:183] op_sel:[0,1] op_sel_hi:[1,0] neg_hi:[0,1]
    v_pk_add_f32 v[168:169], v[184:185], v[168:169]
    v_cvt_pk_bf16_f32 v91, v168, v169
    buffer_load_dwordx4 v[220:223], v5, s[32:35], s51 offen offset:2176 sc1
    v_pk_add_f32 v[170:171], v[186:187], v[170:171]
    v_cvt_pk_bf16_f32 v95, v170, v171
    v_pk_add_f32 v[172:173], v[188:189], v[172:173]
    v_cvt_pk_bf16_f32 v99, v172, v173
    v_pk_add_f32 v[174:175], v[190:191], v[174:175]
    v_cvt_pk_bf16_f32 v103, v174, v175
    buffer_store_dwordx4 v[88:91], v80, s[32:35], 0 offen offset:0 sc1
    buffer_store_dwordx4 v[92:95], v80, s[32:35], 0 offen offset:128 sc1
    s_mov_b32 s51, 0x732000
    buffer_load_dwordx4 v[224:227], v5, s[32:35], s51 offen offset:0 sc1
SC_e15:
PAD_71:
    s_cbranch_execz SC_ret
    buffer_store_dwordx4 v[96:99], v80, s[32:35], 0 offen offset:256 sc1
    buffer_store_dwordx4 v[100:103], v80, s[32:35], 0 offen offset:384 sc1
    buffer_load_dwordx4 v[228:231], v5, s[32:35], s51 offen offset:128 sc1
    buffer_load_dwordx4 v[232:235], v5, s[32:35], s51 offen offset:2048 sc1
    buffer_load_dwordx4 v[236:239], v5, s[32:35], s51 offen offset:2176 sc1
    s_mov_b32 s51, 0x733000
    buffer_load_dwordx4 v[240:243], v5, s[32:35], s51 offen offset:0 sc1
    buffer_load_dwordx4 v[244:247], v5, s[32:35], s51 offen offset:128 sc1
    buffer_load_dwordx4 v[248:251], v5, s[32:35], s51 offen offset:2048 sc1
    buffer_load_dwordx4 v[252:255], v5, s[32:35], s51 offen offset:2176 sc1
    s_cbranch_vccz wl_18
    s_mov_b32 s51, 0x739000
    buffer_load_dwordx4 a[144:147], v4, s[32:35], s51 offen offset:0 sc1
    buffer_load_dwordx4 a[148:151], v4, s[32:35], s51 offen offset:128 sc1
wl_18:
    s_cbranch_vccz wl_19
    s_mov_b32 s51, 0x739000
    buffer_load_dwordx4 a[152:155], v4, s[32:35], s51 offen offset:2048 sc1
    buffer_load_dwordx4 a[156:159], v4, s[32:35], s51 offen offset:2176 sc1
wl_19:
    s_cbranch_vccz wl_20
    s_mov_b32 s51, 0x739000
    buffer_load_dwordx4 a[240:243], v5, s[32:35], s51 offen offset:0 sc1
    buffer_load_dwordx4 a[244:247], v5, s[32:35], s51 offen offset:128 sc1
wl_20:
    s_cbranch_vccz wl_21
    s_mov_b32 s51, 0x739000
    buffer_load_dwordx4 a[248:251], v5, s[32:35], s51 offen offset:2048 sc1
    buffer_load_dwordx4 a[252:255], v5, s[32:35], s51 offen offset:2176 sc1
wl_21:
    s_cmp_lg_u32 s63, 0
    s_cbranch_scc1 first_22
    v_mov_b32 v8, -1
    v_mov_b32 v9, -1
    v_mov_b32 v10, -1
    v_mov_b32 v11, -1
    s_cmp_eq_u32 s30, 0
    s_cselect_b32 s48, 0x40000000, 0
    v_or_b32 v12, s48, v2
    s_mul_i32 s48, s29, 4096
    s_add_u32 s48, s48, s53
    buffer_store_dwordx4 v[8:11], v2, s[32:35], s48 offen offset:0 sc1
SC_e31:
PAD_72:
    s_cbranch_execz PAD_73
    buffer_store_dwordx4 v[8:11], v2, s[32:35], s48 offen offset:1024 sc1
    buffer_store_dwordx4 v[8:11], v2, s[32:35], s48 offen offset:2048 sc1
    buffer_store_dwordx4 v[8:11], v2, s[32:35], s48 offen offset:3072 sc1
    s_mul_i32 s48, s31, 4096
    s_add_u32 s48, s48, s53
    buffer_store_dwordx4 v[8:11], v12, s[32:35], s48 offen offset:0 sc1
    buffer_store_dwordx4 v[8:11], v12, s[32:35], s48 offen offset:1024 sc1
    buffer_store_dwordx4 v[8:11], v12, s[32:35], s48 offen offset:2048 sc1
    buffer_store_dwordx4 v[8:11], v12, s[32:35], s48 offen offset:3072 sc1
    s_mov_b32 s51, 0x734000
    buffer_load_dwordx4 a[160:163], v5, s[32:35], s51 offen offset:0 sc1
    buffer_load_dwordx4 a[164:167], v5, s[32:35], s51 offen offset:128 sc1
    buffer_load_dwordx4 a[168:171], v5, s[32:35], s51 offen offset:2048 sc1
    buffer_load_dwordx4 a[172:175], v5, s[32:35], s51 offen offset:2176 sc1
    s_mov_b32 s51, 0x735000
    buffer_load_dwordx4 a[176:179], v5, s[32:35], s51 offen offset:0 sc1
    buffer_load_dwordx4 a[180:183], v5, s[32:35], s51 offen offset:128 sc1
    buffer_load_dwordx4 a[184:187], v5, s[32:35], s51 offen offset:2048 sc1
    buffer_load_dwordx4 a[188:191], v5, s[32:35], s51 offen offset:2176 sc1
    s_mov_b32 s51, 0x736000
    buffer_load_dwordx4 a[192:195], v5, s[32:35], s51 offen offset:0 sc1
    buffer_load_dwordx4 a[196:199], v5, s[32:35], s51 offen offset:128 sc1
    buffer_load_dwordx4 a[200:203], v5, s[32:35], s51 offen offset:2048 sc1
    buffer_load_dwordx4 a[204:207], v5, s[32:35], s51 offen offset:2176 sc1
    s_mov_b32 s51, 0x737000
    buffer_load_dwordx4 a[208:211], v5, s[32:35], s51 offen offset:0 sc1
    buffer_load_dwordx4 a[212:215], v5, s[32:35], s51 offen offset:128 sc1
    buffer_load_dwordx4 a[216:219], v5, s[32:35], s51 offen offset:2048 sc1
    buffer_load_dwordx4 a[220:223], v5, s[32:35], s51 offen offset:2176 sc1
    s_mov_b32 s51, 0x738000
    buffer_load_dwordx4 a[224:227], v5, s[32:35], s51 offen offset:0 sc1
    buffer_load_dwordx4 a[228:231], v5, s[32:35], s51 offen offset:128 sc1
PAD_73:
    s_cbranch_execz SC_ret
    buffer_load_dwordx4 a[232:235], v5, s[32:35], s51 offen offset:2048 sc1
    buffer_load_dwordx4 a[236:239], v5, s[32:35], s51 offen offset:2176 sc1
first_22:
    v_and_b32 v92, 31, v0
    v_lshlrev_b32 v92, 4, v92
    v_lshrrev_b32 v93, 5, v0
    v_mul_u32_u24 v109, 33280, v93
    v_add_u32 v109, v109, v92
    s_lshl_b32 s48, s27, 9
    v_add_u32 v109, s48, v109
    v_lshl_add_u32 v110, v93, 10, v92
    v_add_u32 v6, s14, v2
    v_lshrrev_b32 v92, 4, v1
    v_and_b32 v93, 15, v1
    v_lshlrev_b32 v93, 4, v93
    v_lshl_add_u32 v7, v92, 10, v93
    v_mov_b32 v108, v7
    s_mul_i32 s48, s26, 57344
    s_add_u32 s48, s48, s53
    v_add_u32 v7, s48, v7
    s_barrier
    s_cmp_eq_u32 s63, 0
    s_cbranch_scc1 L_g1
    s_waitcnt vmcnt(0)
    s_branch L_g1
L_nocol:
    s_cmp_lg_u32 s63, 0
    s_cbranch_scc1 L_prep
    s_waitcnt vmcnt(6)
    v_or3_b32 v14, v252, v253, v254
    v_bitop3_b32 v14, v14, v255, 2 bitop3:0xa8
    v_cmp_ne_u32 vcc, 0, v14
    s_nop 3
    s_cmp_lg_u64 vcc, 0
    s_cbranch_scc1 flg_retry_24
flg_23:
    s_mov_b32 s51, 0x730000
    buffer_load_dwordx4 a[0:3], v4, s[32:35], s51 offen offset:0 sc1
    buffer_load_dwordx4 a[4:7], v4, s[32:35], s51 offen offset:128 sc1
    buffer_load_dwordx4 a[8:11], v4, s[32:35], s51 offen offset:2048 sc1
    buffer_load_dwordx4 a[12:15], v4, s[32:35], s51 offen offset:2176 sc1
    s_mov_b32 s51, 0x731000
    buffer_load_dwordx4 a[16:19], v4, s[32:35], s51 offen offset:0 sc1
    buffer_load_dwordx4 a[20:23], v4, s[32:35], s51 offen offset:128 sc1
    buffer_load_dwordx4 a[24:27], v4, s[32:35], s51 offen offset:2048 sc1
    buffer_load_dwordx4 a[28:31], v4, s[32:35], s51 offen offset:2176 sc1
    s_waitcnt vmcnt(8)
    s_barrier
SC_e47:
PAD_74:
    s_cbranch_execz SC_ret
    v_sub_u32 v8, 0, v0
    v_and_b32 v8, 0x40000000, v8
    v_mov_b32 v9, 8
    buffer_store_dword v9, v8, s[32:35], s18 offen sc1
    v_mov_b32 v12, -1
    v_mov_b32 v13, -1
    v_mov_b32 v14, -1
    v_mov_b32 v15, -1
    s_cmp_eq_u32 s30, 0
    s_cselect_b32 s48, 0x40000000, 0
    v_or_b32 v16, s48, v2
    s_mul_i32 s48, s29, 4096
    s_add_u32 s48, s48, s53
    buffer_store_dwordx4 v[12:15], v2, s[32:35], s48 offen offset:0 sc1
    buffer_store_dwordx4 v[12:15], v2, s[32:35], s48 offen offset:1024 sc1
    buffer_store_dwordx4 v[12:15], v2, s[32:35], s48 offen offset:2048 sc1
    buffer_store_dwordx4 v[12:15], v2, s[32:35], s48 offen offset:3072 sc1
    s_mul_i32 s48, s31, 4096
    s_add_u32 s48, s48, s53
    buffer_store_dwordx4 v[12:15], v16, s[32:35], s48 offen offset:0 sc1
    buffer_store_dwordx4 v[12:15], v16, s[32:35], s48 offen offset:1024 sc1
    buffer_store_dwordx4 v[12:15], v16, s[32:35], s48 offen offset:2048 sc1
    buffer_store_dwordx4 v[12:15], v16, s[32:35], s48 offen offset:3072 sc1
    s_mov_b32 s51, 0x732000
    buffer_load_dwordx4 a[32:35], v4, s[32:35], s51 offen offset:0 sc1
    buffer_load_dwordx4 a[36:39], v4, s[32:35], s51 offen offset:128 sc1
    buffer_load_dwordx4 a[40:43], v4, s[32:35], s51 offen offset:2048 sc1
    buffer_load_dwordx4 a[44:47], v4, s[32:35], s51 offen offset:2176 sc1
    s_mov_b32 s51, 0x733000
    buffer_load_dwordx4 a[48:51], v4, s[32:35], s51 offen offset:0 sc1
    buffer_load_dwordx4 a[52:55], v4, s[32:35], s51 offen offset:128 sc1
    buffer_load_dwordx4 a[56:59], v4, s[32:35], s51 offen offset:2048 sc1
    buffer_load_dwordx4 a[60:63], v4, s[32:35], s51 offen offset:2176 sc1
    s_mov_b32 s51, 0x734000
    buffer_load_dwordx4 a[64:67], v4, s[32:35], s51 offen offset:0 sc1
    buffer_load_dwordx4 a[68:71], v4, s[32:35], s51 offen offset:128 sc1
    buffer_load_dwordx4 a[72:75], v4, s[32:35], s51 offen offset:2048 sc1
    buffer_load_dwordx4 a[76:79], v4, s[32:35], s51 offen offset:2176 sc1
SC_e63:
PAD_75:
    s_cbranch_execz SC_ret
    s_mov_b32 s51, 0x735000
    buffer_load_dwordx4 a[80:83], v4, s[32:35], s51 offen offset:0 sc1
    buffer_load_dwordx4 a[84:87], v4, s[32:35], s51 offen offset:128 sc1
    buffer_load_dwordx4 a[88:91], v4, s[32:35], s51 offen offset:2048 sc1
    buffer_load_dwordx4 a[92:95], v4, s[32:35], s51 offen offset:2176 sc1
    s_mov_b32 s51, 0x736000
    buffer_load_dwordx4 a[96:99], v4, s[32:35], s51 offen offset:0 sc1
    buffer_load_dwordx4 a[100:103], v4, s[32:35], s51 offen offset:128 sc1
    buffer_load_dwordx4 a[104:107], v4, s[32:35], s51 offen offset:2048 sc1
    buffer_load_dwordx4 a[108:111], v4, s[32:35], s51 offen offset:2176 sc1
    s_mov_b32 s51, 0x737000
    buffer_load_dwordx4 a[112:115], v4, s[32:35], s51 offen offset:0 sc1
    buffer_load_dwordx4 a[116:119], v4, s[32:35], s51 offen offset:128 sc1
    buffer_load_dwordx4 a[120:123], v4, s[32:35], s51 offen offset:2048 sc1
    buffer_load_dwordx4 a[124:127], v4, s[32:35], s51 offen offset:2176 sc1
    s_mov_b32 s51, 0x738000
    buffer_load_dwordx4 a[128:131], v4, s[32:35], s51 offen offset:0 sc1
    buffer_load_dwordx4 a[132:135], v4, s[32:35], s51 offen offset:128 sc1
    buffer_load_dwordx4 a[136:139], v4, s[32:35], s51 offen offset:2048 sc1
    buffer_load_dwordx4 a[140:143], v4, s[32:35], s51 offen offset:2176 sc1
    s_mov_b32 s51, 0x739000
    buffer_load_dwordx4 a[144:147], v4, s[32:35], s51 offen offset:0 sc1
    buffer_load_dwordx4 a[148:151], v4, s[32:35], s51 offen offset:128 sc1
    buffer_load_dwordx4 a[152:155], v4, s[32:35], s51 offen offset:2048 sc1
    s_sub_u32 s48, s2, 160
    s_lshr_b32 s48, s48, 3
    s_mov_b64 exec, 0
    s_cmp_eq_u32 s26, 1
    s_cbranch_scc1 SCB_c1
    s_cmp_eq_u32 s26, 2
    s_cbranch_scc1 SCB_c2
    s_cmp_eq_u32 s26, 3
    s_cbranch_scc1 SCB_c3
SCB_c0:
    s_sub_u32 s48, s48, 1
    s_cbranch_scc1 SCB_e0
    s_sub_u32 s48, s48, 1
    s_cbranch_scc1 SCB_e1
    s_sub_u32 s48, s48, 1
    s_cbranch_scc1 SCB_e2
    s_sub_u32 s48, s48, 1
    s_cbranch_scc1 SCB_e3
    s_sub_u32 s48, s48, 1
    s_cbranch_scc1 SCB_e4
    s_sub_u32 s48, s48, 1
    s_cbranch_scc1 SCB_e5
    s_sub_u32 s48, s48, 1
    s_cbranch_scc1 SCB_e6
    s_sub_u32 s48, s48, 1
    s_cbranch_scc1 SCB_e7
    s_sub_u32 s48, s48, 1
    s_cbranch_scc1 SCB_e8
    s_sub_u32 s48, s48, 1
    s_cbranch_scc1 SCB_e9
    s_sub_u32 s48, s48, 1
    s_cbranch_scc1 SCB_e10
    s_branch SCB_e11
SCB_c1:
    s_sub_u32 s48, s48, 1
    s_cbranch_scc1 SCB_e12
    s_sub_u32 s48, s48, 1
    s_cbranch_scc1 SCB_e13
    s_sub_u32 s48, s48, 1
    s_cbranch_scc1 SCB_e14
    s_sub_u32 s48, s48, 1
    s_cbranch_scc1 SCB_e15
    s_sub_u32 s48, s48, 1
    s_cbranch_scc1 SCB_e16
    s_sub_u32 s48, s48, 1
    s_cbranch_scc1 SCB_e17
    s_sub_u32 s48, s48, 1
    s_cbranch_scc1 SCB_e18
    s_sub_u32 s48, s48, 1
    s_cbranch_scc1 SCB_e19
    s_sub_u32 s48, s48, 1
    s_cbranch_scc1 SCB_e20
    s_sub_u32 s48, s48, 1
    s_cbranch_scc1 SCB_e21
    s_sub_u32 s48, s48, 1
    s_cbranch_scc1 SCB_e22
    s_branch SCB_e23
SCB_c2:
    s_sub_u32 s48, s48, 1
    s_cbranch_scc1 SCB_e24
    s_sub_u32 s48, s48, 1
    s_cbranch_scc1 SCB_e25
    s_sub_u32 s48, s48, 1
    s_cbranch_scc1 SCB_e26
    s_sub_u32 s48, s48, 1
    s_cbranch_scc1 SCB_e27
    s_sub_u32 s48, s48, 1
    s_cbranch_scc1 SCB_e28
    s_sub_u32 s48, s48, 1
    s_cbranch_scc1 SCB_e29
    s_sub_u32 s48, s48, 1
    s_cbranch_scc1 SCB_e30
    s_sub_u32 s48, s48, 1
    s_cbranch_scc1 SCB_e31
    s_sub_u32 s48, s48, 1
    s_cbranch_scc1 SCB_e32
    s_sub_u32 s48, s48, 1
    s_cbranch_scc1 SCB_e33
    s_sub_u32 s48, s48, 1
    s_cbranch_scc1 SCB_e34
    s_branch SCB_e35
SCB_c3:
    s_sub_u32 s48, s48, 1
    s_cbranch_scc1 SCB_e36
    s_sub_u32 s48, s48, 1
    s_cbranch_scc1 SCB_e37
    s_sub_u32 s48, s48, 1
    s_cbranch_scc1 SCB_e38
    s_sub_u32 s48, s48, 1
    s_cbranch_scc1 SCB_e39
    s_sub_u32 s48, s48, 1
    s_cbranch_scc1 SCB_e40
    s_sub_u32 s48, s48, 1
    s_cbranch_scc1 SCB_e41
    s_sub_u32 s48, s48, 1
    s_cbranch_scc1 SCB_e42
    s_sub_u32 s48, s48, 1
    s_cbranch_scc1 SCB_e43
    s_sub_u32 s48, s48, 1
    s_cbranch_scc1 SCB_e44
    s_sub_u32 s48, s48, 1
    s_cbranch_scc1 SCB_e45
    s_sub_u32 s48, s48, 1
    s_cbranch_scc1 SCB_e46
    s_branch SCB_e47
SCB_ret:
    s_mov_b64 exec, -1
SCB_e0:
PAD_76:
    s_cbranch_execz PAD_77
    v_sub_u32 v8, 31, v1
    v_and_b32 v8, 0x40000000, v8
    v_lshl_add_u32 v8, v1, 7, v8
    v_add_u32 v8, 0xb7f000, v8
    s_mov_b32 s51, 0x739000
    buffer_load_dwordx4 a[156:159], v4, s[32:35], s51 offen offset:2176 sc1
    s_mov_b32 s51, 0x730000
    buffer_load_dwordx4 v[192:195], v5, s[32:35], s51 offen offset:0 sc1
    buffer_load_dwordx4 v[196:199], v5, s[32:35], s51 offen offset:128 sc1
    buffer_load_dwordx4 v[200:203], v5, s[32:35], s51 offen offset:2048 sc1
    buffer_load_dwordx4 v[204:207], v5, s[32:35], s51 offen offset:2176 sc1
    s_mov_b32 s51, 0x731000
    buffer_load_dwordx4 v[208:211], v5, s[32:35], s51 offen offset:0 sc1
    buffer_load_dwordx4 v[212:215], v5, s[32:35], s51 offen offset:128 sc1
    buffer_load_dwordx4 v[216:219], v5, s[32:35], s51 offen offset:2048 sc1
    buffer_load_dwordx4 v[220:223], v5, s[32:35], s51 offen offset:2176 sc1
    s_mov_b32 s51, 0x732000
    buffer_load_dwordx4 v[224:227], v5, s[32:35], s51 offen offset:0 sc1
    buffer_load_dwordx4 v[228:231], v5, s[32:35], s51 offen offset:128 sc1
    buffer_load_dwordx4 v[232:235], v5, s[32:35], s51 offen offset:2048 sc1
PAD_77:
    s_cbranch_execz PAD_78
    buffer_load_dwordx4 v[236:239], v5, s[32:35], s51 offen offset:2176 sc1
    s_mov_b32 s51, 0x733000
    buffer_load_dwordx4 v[240:243], v5, s[32:35], s51 offen offset:0 sc1
    buffer_load_dwordx4 v[244:247], v5, s[32:35], s51 offen offset:128 sc1
    buffer_load_dwordx4 v[248:251], v5, s[32:35], s51 offen offset:2048 sc1
    buffer_load_dwordx4 v[252:255], v5, s[32:35], s51 offen offset:2176 sc1
    s_mov_b32 s51, 0x734000
    buffer_load_dwordx4 a[160:163], v5, s[32:35], s51 offen offset:0 sc1
    buffer_load_dwordx4 a[164:167], v5, s[32:35], s51 offen offset:128 sc1
    buffer_load_dwordx4 a[168:171], v5, s[32:35], s51 offen offset:2048 sc1
    buffer_load_dwordx4 a[172:175], v5, s[32:35], s51 offen offset:2176 sc1
    s_mov_b32 s51, 0x735000
    buffer_load_dwordx4 a[176:179], v5, s[32:35], s51 offen offset:0 sc1
    buffer_load_dwordx4 a[180:183], v5, s[32:35], s51 offen offset:128 sc1
    buffer_load_dwordx4 a[184:187], v5, s[32:35], s51 offen offset:2048 sc1
    buffer_load_dwordx4 a[188:191], v5, s[32:35], s51 offen offset:2176 sc1
    s_mov_b32 s51, 0x736000
    buffer_load_dwordx4 a[192:195], v5, s[32:35], s51 offen offset:0 sc1
    buffer_load_dwordx4 a[196:199], v5, s[32:35], s51 offen offset:128 sc1
    buffer_load_dwordx4 a[200:203], v5, s[32:35], s51 offen offset:2048 sc1
    buffer_load_dwordx4 a[204:207], v5, s[32:35], s51 offen offset:2176 sc1
    s_mov_b32 s51, 0x737000
    buffer_load_dwordx4 a[208:211], v5, s[32:35], s51 offen offset:0 sc1
    buffer_load_dwordx4 a[212:215], v5, s[32:35], s51 offen offset:128 sc1
    buffer_load_dwordx4 a[216:219], v5, s[32:35], s51 offen offset:2048 sc1
    buffer_load_dwordx4 a[220:223], v5, s[32:35], s51 offen offset:2176 sc1
    buffer_load_dwordx4 v[12:15], v8, s[32:35], s101 offen sc1
    s_mov_b32 s51, 0x738000
    buffer_load_dwordx4 a[224:227], v5, s[32:35], s51 offen offset:0 sc1
    buffer_load_dwordx4 a[228:231], v5, s[32:35], s51 offen offset:128 sc1
    buffer_load_dwordx4 a[232:235], v5, s[32:35], s51 offen offset:2048 sc1
    buffer_load_dwordx4 a[236:239], v5, s[32:35], s51 offen offset:2176 sc1
PAD_78:
    s_cbranch_execz PAD_79
    s_mov_b32 s51, 0x739000
    buffer_load_dwordx4 a[240:243], v5, s[32:35], s51 offen offset:0 sc1
    buffer_load_dwordx4 a[244:247], v5, s[32:35], s51 offen offset:128 sc1
    buffer_load_dwordx4 a[248:251], v5, s[32:35], s51 offen offset:2048 sc1
    buffer_load_dwordx4 a[252:255], v5, s[32:35], s51 offen offset:2176 sc1
    s_waitcnt vmcnt(8)
    v_or3_b32 v9, v12, v13, v14
    v_bitop3_b32 v9, v9, v15, 2 bitop3:0xa8
    v_cmp_ne_u32 vcc, 0, v9
    s_nop 3
    s_cmp_lg_u64 vcc, 0
    s_cbranch_scc1 flg_retry_26
flg_25:
    s_branch L_spin
L_prep:
    s_mov_b32 s51, 0x730000
    buffer_load_dwordx4 a[0:3], v4, s[32:35], s51 offen offset:0 sc1
    buffer_load_dwordx4 a[4:7], v4, s[32:35], s51 offen offset:128 sc1
    buffer_load_dwordx4 a[8:11], v4, s[32:35], s51 offen offset:2048 sc1
    buffer_load_dwordx4 a[12:15], v4, s[32:35], s51 offen offset:2176 sc1
    s_mov_b32 s51, 0x731000
    buffer_load_dwordx4 a[16:19], v4, s[32:35], s51 offen offset:0 sc1
    buffer_load_dwordx4 a[20:23], v4, s[32:35], s51 offen offset:128 sc1
    buffer_load_dwordx4 a[24:27], v4, s[32:35], s51 offen offset:2048 sc1
    buffer_load_dwordx4 a[28:31], v4, s[32:35], s51 offen offset:2176 sc1
    s_mov_b32 s51, 0x732000
    buffer_load_dwordx4 a[32:35], v4, s[32:35], s51 offen offset:0 sc1
    buffer_load_dwordx4 a[36:39], v4, s[32:35], s51 offen offset:128 sc1
    buffer_load_dwordx4 a[40:43], v4, s[32:35], s51 offen offset:2048 sc1
    buffer_load_dwordx4 a[44:47], v4, s[32:35], s51 offen offset:2176 sc1
    s_mov_b32 s51, 0x733000
    buffer_load_dwordx4 a[48:51], v4, s[32:35], s51 offen offset:0 sc1
    buffer_load_dwordx4 a[52:55], v4, s[32:35], s51 offen offset:128 sc1
    buffer_load_dwordx4 a[56:59], v4, s[32:35], s51 offen offset:2048 sc1
    buffer_load_dwordx4 a[60:63], v4, s[32:35], s51 offen offset:2176 sc1
    s_mov_b32 s51, 0x734000
PAD_79:
    s_cbranch_execz SCB_ret
    buffer_load_dwordx4 a[64:67], v4, s[32:35], s51 offen offset:0 sc1
    buffer_load_dwordx4 a[68:71], v4, s[32:35], s51 offen offset:128 sc1
    buffer_load_dwordx4 a[72:75], v4, s[32:35], s51 offen offset:2048 sc1
    buffer_load_dwordx4 a[76:79], v4, s[32:35], s51 offen offset:2176 sc1
    s_mov_b32 s51, 0x735000
    buffer_load_dwordx4 a[80:83], v4, s[32:35], s51 offen offset:0 sc1
    buffer_load_dwordx4 a[84:87], v4, s[32:35], s51 offen offset:128 sc1
    buffer_load_dwordx4 a[88:91], v4, s[32:35], s51 offen offset:2048 sc1
    buffer_load_dwordx4 a[92:95], v4, s[32:35], s51 offen offset:2176 sc1
    s_mov_b32 s51, 0x736000
    buffer_load_dwordx4 a[96:99], v4, s[32:35], s51 offen offset:0 sc1
    buffer_load_dwordx4 a[100:103], v4, s[32:35], s51 offen offset:128 sc1
    buffer_load_dwordx4 a[104:107], v4, s[32:35], s51 offen offset:2048 sc1
    buffer_load_dwordx4 a[108:111], v4, s[32:35], s51 offen offset:2176 sc1
    s_mov_b32 s51, 0x737000
    buffer_load_dwordx4 a[112:115], v4, s[32:35], s51 offen offset:0 sc1
    buffer_load_dwordx4 a[116:119], v4, s[32:35], s51 offen offset:128 sc1
    buffer_load_dwordx4 a[120:123], v4, s[32:35], s51 offen offset:2048 sc1
    buffer_load_dwordx4 a[124:127], v4, s[32:35], s51 offen offset:2176 sc1
    s_mov_b32 s51, 0x738000
    buffer_load_dwordx4 a[128:131], v4, s[32:35], s51 offen offset:0 sc1
    buffer_load_dwordx4 a[132:135], v4, s[32:35], s51 offen offset:128 sc1
    buffer_load_dwordx4 a[136:139], v4, s[32:35], s51 offen offset:2048 sc1
    buffer_load_dwordx4 a[140:143], v4, s[32:35], s51 offen offset:2176 sc1
    s_mov_b32 s51, 0x730000
    buffer_load_dwordx4 v[192:195], v5, s[32:35], s51 offen offset:0 sc1
    buffer_load_dwordx4 v[196:199], v5, s[32:35], s51 offen offset:128 sc1
    buffer_load_dwordx4 v[200:203], v5, s[32:35], s51 offen offset:2048 sc1
    buffer_load_dwordx4 v[204:207], v5, s[32:35], s51 offen offset:2176 sc1
    s_mov_b32 s51, 0x731000
    buffer_load_dwordx4 v[208:211], v5, s[32:35], s51 offen offset:0 sc1
    buffer_load_dwordx4 v[212:215], v5, s[32:35], s51 offen offset:128 sc1
SCB_e12:
PAD_80:
    s_cbranch_execz PAD_81
    buffer_load_dwordx4 v[216:219], v5, s[32:35], s51 offen offset:2048 sc1
    buffer_load_dwordx4 v[220:223], v5, s[32:35], s51 offen offset:2176 sc1
    s_mov_b32 s51, 0x732000
    buffer_load_dwordx4 v[224:227], v5, s[32:35], s51 offen offset:0 sc1
    buffer_load_dwordx4 v[228:231], v5, s[32:35], s51 offen offset:128 sc1
    buffer_load_dwordx4 v[232:235], v5, s[32:35], s51 offen offset:2048 sc1
    buffer_load_dwordx4 v[236:239], v5, s[32:35], s51 offen offset:2176 sc1
    s_mov_b32 s51, 0x733000
    buffer_load_dwordx4 v[240:243], v5, s[32:35], s51 offen offset:0 sc1
    buffer_load_dwordx4 v[244:247], v5, s[32:35], s51 offen offset:128 sc1
    buffer_load_dwordx4 v[248:251], v5, s[32:35], s51 offen offset:2048 sc1
    buffer_load_dwordx4 v[252:255], v5, s[32:35], s51 offen offset:2176 sc1
    s_mul_i32 s48, s26, 15360
    s_add_u32 s48, s48, 81920
    v_add_u32 v47, s48, v2
    s_min_u32 s48, s26, 1
    s_add_u32 s48, s48, s26
    s_add_u32 s48, s48, 6
    v_lshrrev_b32 v38, 4, v1
    v_mul_u32_u24 v38, 40, v38
    v_add_u32 v38, s48, v38
    v_cvt_f32_u32 v40, v38
    v_add_f32 v41, 0x41a00000, v40
    s_mul_i32 s49, s28, 80
    v_and_b32 v38, 15, v1
    v_add_u32 v38, s49, v38
    v_cvt_f32_u32 v43, v38
    v_and_b32 v39, 12, v1
    v_add_u32 v38, v38, v39
    v_cvt_f32_u32 v42, v38
    v_lshlrev_b32 v44, 4, v1
    v_lshlrev_b32 v38, 30, v1
    v_lshlrev_b32 v39, 31, v1
    v_xor_b32 v45, v38, v39
    v_lshrrev_b32 v38, 16, v38
    v_and_b32 v38, 0x8000, v38
    v_bfrev_b32 v46, 1
    v_and_or_b32 v45, v45, v46, v38
    v_alignbit_b32 v46, v46, v46, v44
    s_cmp_eq_u32 s26, 1
    s_cselect_b32 s48, -1, 0
    s_lshl_b32 s49, s48, 31
    v_and_b32 v48, s48, v46
PAD_81:
    s_cbranch_execz PAD_82
    v_add_f32 v38, 0x00000000, v42
    v_mul_f32 v38, 0xbacccccd, v38
    v_cos_f32 v28, v38
    v_sin_f32 v29, v38
    v_mul_f32 v9, v38, v40
    v_mul_f32 v11, v38, v41
    v_fract_f32 v9, v9
    v_fract_f32 v11, v11
    v_cos_f32 v8, v9
    v_cos_f32 v10, v11
    v_sin_f32 v9, v9
    v_sin_f32 v11, v11
    v_xor_b32 v29, s49, v29
    v_mul_f32 v8, 0x3d64f92e, v8
    v_mul_f32 v9, 0x3d64f92e, v9
    v_mul_f32 v10, 0x3d64f92e, v10
    v_mul_f32 v11, 0x3d64f92e, v11
    v_cvt_pk_bf16_f32 v52, v8, v9
    v_cvt_pk_bf16_f32 v53, v10, v11
    v_alignbit_b32 v54, v52, v52, v44
    v_alignbit_b32 v55, v53, v53, v44
    v_xor_b32 v54, v45, v54
    v_xor_b32 v55, v45, v55
    ds_write_b128 v47, v[52:55] offset:0
    v_xor_b32 v56, v46, v52
    v_xor_b32 v57, v46, v53
    v_xor_b32 v58, v46, v54
    v_xor_b32 v59, v46, v55
    ds_write_b128 v47, v[56:59] offset:5120
    v_pk_mul_f32 v[38:39], v[8:9], v[28:29] op_sel:[0,0] op_sel_hi:[0,1]
    v_pk_fma_f32 v[8:9], v[8:9], v[28:29], v[38:39] op_sel:[1,1,0] op_sel_hi:[1,0,1] neg_lo:[0,1,0]
    v_pk_mul_f32 v[38:39], v[10:11], v[28:29] op_sel:[0,0] op_sel_hi:[0,1]
    v_pk_fma_f32 v[10:11], v[10:11], v[28:29], v[38:39] op_sel:[1,1,0] op_sel_hi:[1,0,1] neg_lo:[0,1,0]
    v_cvt_pk_bf16_f32 v60, v8, v9
    v_cvt_pk_bf16_f32 v61, v10, v11
    v_alignbit_b32 v62, v60, v60, v44
    v_alignbit_b32 v63, v61, v61, v44
    v_xor_b32 v62, v45, v62
    v_xor_b32 v63, v45, v63
    v_xor_b32 v60, v48, v60
    v_xor_b32 v61, v48, v61
    v_xor_b32 v62, v48, v62
    v_xor_b32 v63, v48, v63
    ds_write_b128 v47, v[60:63] offset:10240
PAD_82:
    s_cbranch_execz PAD_83
    v_add_f32 v38, 0x40800000, v42
    v_mul_f32 v38, 0xbacccccd, v38
    v_cos_f32 v30, v38
    v_sin_f32 v31, v38
    v_mul_f32 v13, v38, v40
    v_mul_f32 v15, v38, v41
    v_fract_f32 v13, v13
    v_fract_f32 v15, v15
    v_cos_f32 v12, v13
    v_cos_f32 v14, v15
    v_sin_f32 v13, v13
    v_sin_f32 v15, v15
    v_xor_b32 v31, s49, v31
    v_mul_f32 v12, 0x3d64f92e, v12
    v_mul_f32 v13, 0x3d64f92e, v13
    v_mul_f32 v14, 0x3d64f92e, v14
    v_mul_f32 v15, 0x3d64f92e, v15
    v_cvt_pk_bf16_f32 v52, v12, v13
    v_cvt_pk_bf16_f32 v53, v14, v15
    v_alignbit_b32 v54, v52, v52, v44
    v_alignbit_b32 v55, v53, v53, v44
    v_xor_b32 v54, v45, v54
    v_xor_b32 v55, v45, v55
    ds_write_b128 v47, v[52:55] offset:1024
    v_xor_b32 v56, v46, v52
    v_xor_b32 v57, v46, v53
    v_xor_b32 v58, v46, v54
    v_xor_b32 v59, v46, v55
    ds_write_b128 v47, v[56:59] offset:6144
    v_pk_mul_f32 v[38:39], v[12:13], v[30:31] op_sel:[0,0] op_sel_hi:[0,1]
    v_pk_fma_f32 v[12:13], v[12:13], v[30:31], v[38:39] op_sel:[1,1,0] op_sel_hi:[1,0,1] neg_lo:[0,1,0]
    v_pk_mul_f32 v[38:39], v[14:15], v[30:31] op_sel:[0,0] op_sel_hi:[0,1]
    v_pk_fma_f32 v[14:15], v[14:15], v[30:31], v[38:39] op_sel:[1,1,0] op_sel_hi:[1,0,1] neg_lo:[0,1,0]
    v_cvt_pk_bf16_f32 v60, v12, v13
    v_cvt_pk_bf16_f32 v61, v14, v15
    v_alignbit_b32 v62, v60, v60, v44
    v_alignbit_b32 v63, v61, v61, v44
    v_xor_b32 v62, v45, v62
    v_xor_b32 v63, v45, v63
    v_xor_b32 v60, v48, v60
    v_xor_b32 v61, v48, v61
    v_xor_b32 v62, v48, v62
    v_xor_b32 v63, v48, v63
PAD_83:
    s_cbranch_execz SCB_ret
    ds_write_b128 v47, v[60:63] offset:11264
    v_add_f32 v38, 0x42000000, v42
    v_mul_f32 v38, 0xbacccccd, v38
    v_cos_f32 v32, v38
    v_sin_f32 v33, v38
    v_mul_f32 v17, v38, v40
    v_mul_f32 v19, v38, v41
    v_fract_f32 v17, v17
    v_fract_f32 v19, v19
    v_cos_f32 v16, v17
    v_cos_f32 v18, v19
    v_sin_f32 v17, v17
    v_sin_f32 v19, v19
    v_xor_b32 v33, s49, v33
    v_mul_f32 v16, 0x3d64f92e, v16
    v_mul_f32 v17, 0x3d64f92e, v17
    v_mul_f32 v18, 0x3d64f92e, v18
    v_mul_f32 v19, 0x3d64f92e, v19
    v_cvt_pk_bf16_f32 v52, v16, v17
    v_cvt_pk_bf16_f32 v53, v18, v19
    v_alignbit_b32 v54, v52, v52, v44
    v_alignbit_b32 v55, v53, v53, v44
    v_xor_b32 v54, v45, v54
    v_xor_b32 v55, v45, v55
    ds_write_b128 v47, v[52:55] offset:2048
    v_xor_b32 v56, v46, v52
    v_xor_b32 v57, v46, v53
    v_xor_b32 v58, v46, v54
    v_xor_b32 v59, v46, v55
    ds_write_b128 v47, v[56:59] offset:7168
    v_pk_mul_f32 v[38:39], v[16:17], v[32:33] op_sel:[0,0] op_sel_hi:[0,1]
    v_pk_fma_f32 v[16:17], v[16:17], v[32:33], v[38:39] op_sel:[1,1,0] op_sel_hi:[1,0,1] neg_lo:[0,1,0]
    v_pk_mul_f32 v[38:39], v[18:19], v[32:33] op_sel:[0,0] op_sel_hi:[0,1]
    v_pk_fma_f32 v[18:19], v[18:19], v[32:33], v[38:39] op_sel:[1,1,0] op_sel_hi:[1,0,1] neg_lo:[0,1,0]
    v_cvt_pk_bf16_f32 v60, v16, v17
    v_cvt_pk_bf16_f32 v61, v18, v19
    v_alignbit_b32 v62, v60, v60, v44
    v_alignbit_b32 v63, v61, v61, v44
    v_xor_b32 v62, v45, v62
    v_xor_b32 v63, v45, v63
    v_xor_b32 v60, v48, v60
    v_xor_b32 v61, v48, v61
SCB_e24:
PAD_84:
    s_cbranch_execz PAD_85
    v_xor_b32 v62, v48, v62
    v_xor_b32 v63, v48, v63
    ds_write_b128 v47, v[60:63] offset:12288
    v_add_f32 v38, 0x42100000, v42
    v_mul_f32 v38, 0xbacccccd, v38
    v_cos_f32 v34, v38
    v_sin_f32 v35, v38
    v_mul_f32 v21, v38, v40
    v_mul_f32 v23, v38, v41
    v_fract_f32 v21, v21
    v_fract_f32 v23, v23
    v_cos_f32 v20, v21
    v_cos_f32 v22, v23
    v_sin_f32 v21, v21
    v_sin_f32 v23, v23
    v_xor_b32 v35, s49, v35
    v_mul_f32 v20, 0x3d64f92e, v20
    v_mul_f32 v21, 0x3d64f92e, v21
    v_mul_f32 v22, 0x3d64f92e, v22
    v_mul_f32 v23, 0x3d64f92e, v23
    v_cvt_pk_bf16_f32 v52, v20, v21
    v_cvt_pk_bf16_f32 v53, v22, v23
    v_alignbit_b32 v54, v52, v52, v44
    v_alignbit_b32 v55, v53, v53, v44
    v_xor_b32 v54, v45, v54
    v_xor_b32 v55, v45, v55
    ds_write_b128 v47, v[52:55] offset:3072
    v_xor_b32 v56, v46, v52
    v_xor_b32 v57, v46, v53
    v_xor_b32 v58, v46, v54
    v_xor_b32 v59, v46, v55
    ds_write_b128 v47, v[56:59] offset:8192
    v_pk_mul_f32 v[38:39], v[20:21], v[34:35] op_sel:[0,0] op_sel_hi:[0,1]
    v_pk_fma_f32 v[20:21], v[20:21], v[34:35], v[38:39] op_sel:[1,1,0] op_sel_hi:[1,0,1] neg_lo:[0,1,0]
    v_pk_mul_f32 v[38:39], v[22:23], v[34:35] op_sel:[0,0] op_sel_hi:[0,1]
    v_pk_fma_f32 v[22:23], v[22:23], v[34:35], v[38:39] op_sel:[1,1,0] op_sel_hi:[1,0,1] neg_lo:[0,1,0]
    v_cvt_pk_bf16_f32 v60, v20, v21
    v_cvt_pk_bf16_f32 v61, v22, v23
    v_alignbit_b32 v62, v60, v60, v44
    v_alignbit_b32 v63, v61, v61, v44
    v_xor_b32 v62, v45, v62
    v_xor_b32 v63, v45, v63
PAD_85:
    s_cbranch_execz PAD_86
    v_xor_b32 v60, v48, v60
    v_xor_b32 v61, v48, v61
    v_xor_b32 v62, v48, v62
    v_xor_b32 v63, v48, v63
    ds_write_b128 v47, v[60:63] offset:13312
    v_add_f32 v38, 0x42800000, v43
    v_mul_f32 v38, 0xbacccccd, v38
    v_cos_f32 v36, v38
    v_sin_f32 v37, v38
    v_mul_f32 v25, v38, v40
    v_mul_f32 v27, v38, v41
    v_fract_f32 v25, v25
    v_fract_f32 v27, v27
    v_cos_f32 v24, v25
    v_cos_f32 v26, v27
    v_sin_f32 v25, v25
    v_sin_f32 v27, v27
    v_xor_b32 v37, s49, v37
    v_mul_f32 v24, 0x3d64f92e, v24
    v_mul_f32 v25, 0x3d64f92e, v25
    v_mul_f32 v26, 0x3d64f92e, v26
    v_mul_f32 v27, 0x3d64f92e, v27
    v_cvt_pk_bf16_f32 v52, v24, v25
    v_cvt_pk_bf16_f32 v53, v26, v27
    v_alignbit_b32 v54, v52, v52, v44
    v_alignbit_b32 v55, v53, v53, v44
    v_xor_b32 v54, v45, v54
    v_xor_b32 v55, v45, v55
    ds_write_b128 v47, v[52:55] offset:4096
    v_xor_b32 v56, v46, v52
    v_xor_b32 v57, v46, v53
    v_xor_b32 v58, v46, v54
    v_xor_b32 v59, v46, v55
    ds_write_b128 v47, v[56:59] offset:9216
    v_pk_mul_f32 v[38:39], v[24:25], v[36:37] op_sel:[0,0] op_sel_hi:[0,1]
    v_pk_fma_f32 v[24:25], v[24:25], v[36:37], v[38:39] op_sel:[1,1,0] op_sel_hi:[1,0,1] neg_lo:[0,1,0]
    v_pk_mul_f32 v[38:39], v[26:27], v[36:37] op_sel:[0,0] op_sel_hi:[0,1]
    v_pk_fma_f32 v[26:27], v[26:27], v[36:37], v[38:39] op_sel:[1,1,0] op_sel_hi:[1,0,1] neg_lo:[0,1,0]
    v_cvt_pk_bf16_f32 v60, v24, v25
    v_cvt_pk_bf16_f32 v61, v26, v27
    v_alignbit_b32 v62, v60, v60, v44
    v_alignbit_b32 v63, v61, v61, v44
PAD_86:
    s_cbranch_execz SCB_ret
    v_xor_b32 v62, v45, v62
    v_xor_b32 v63, v45, v63
    v_xor_b32 v60, v48, v60
    v_xor_b32 v61, v48, v61
    v_xor_b32 v62, v48, v62
    v_xor_b32 v63, v48, v63
    ds_write_b128 v47, v[60:63] offset:14336
L_spin:
    v_and_b32 v92, 31, v0
    v_lshlrev_b32 v92, 4, v92
    v_lshrrev_b32 v93, 5, v0
    v_mul_u32_u24 v109, 33280, v93
    v_add_u32 v109, v109, v92
    s_lshl_b32 s48, s27, 9
    v_add_u32 v109, s48, v109
    v_lshl_add_u32 v110, v93, 10, v92
    v_add_u32 v6, s14, v2
    v_lshrrev_b32 v92, 4, v1
    v_and_b32 v93, 15, v1
    v_lshlrev_b32 v93, 4, v93
    v_lshl_add_u32 v7, v92, 10, v93
    v_mov_b32 v108, v7
    s_mul_i32 s48, s26, 57344
    s_add_u32 s48, s48, s53
    v_add_u32 v7, s48, v7
    s_waitcnt vmcnt(0)
spin_27:
    s_sub_u32 s55, s55, 1
    s_cbranch_scc1 spin_27_out
    buffer_load_dword v112, v109, s[32:35], 0 offen sc1
    s_waitcnt vmcnt(0)
    v_and_b32 v112, s60, v112
    v_cmp_ne_u32 vcc, s60, v112
    s_nop 3
    s_cbranch_vccz spin_27_ok
    s_sleep 2
    s_branch spin_27
spin_27_out:
    s_mov_b32 s55, 0
spin_27_ok:
L_g1:
    v_lshrrev_b32 v92, 2, v1
    v_and_b32 v92, 4, v92
    v_and_or_b32 v92, v1, 3, v92
    v_and_b32 v93, 12, v1
    v_lshl_or_b32 v92, v93, 1, v92
    s_lshl_b32 s48, s29, 5
    s_lshl_b32 s49, s31, 5
    v_mov_b32 v93, s48
    v_mov_b32 v94, s49
    v_cmp_gt_u32 vcc, 32, v1
    s_nop 1
    v_cndmask_b32 v93, v94, v93, vcc
    v_add_lshl_u32 v92, v92, v93, 1
    buffer_load_ushort v76, v92, s[36:39], 0 offen
    v_mov_b32 v77, 0
    v_mov_b32 v78, 0
    v_mov_b32 v79, 0
SCB_e36:
PAD_87:
    s_cbranch_execz PAD_88
    s_mov_b32 s4, 0
    s_mov_b32 s5, 0
    s_mov_b32 s6, 0
    s_mov_b32 s7, 0
    s_mov_b32 s8, 0
    s_mov_b32 s9, 0
    s_mov_b32 s10, 0
    s_mov_b32 s11, 0
    s_mov_b32 s12, 0
    s_mov_b32 s13, 0
    s_mov_b32 s50, 10
    v_cmp_gt_u32 vcc, 32, v0
    v_mov_b32 v92, 0xffff0000
    s_nop 0
    v_cndmask_b32 v92, -1, v92, vcc
    v_add_u32 v95, 40960, v110
    v_sub_u32 v100, 63, v0
    v_and_b32 v100, 0x40000000, v100
    v_lshl_add_u32 v100, v0, 7, v100
    v_add_u32 v100, 0xb7f000, v100
stage_28:
    buffer_load_dwordx4 v[104:107], v100, s[32:35], s101 offen sc1
    v_or_b32 v98, s4, v109
    s_mov_b32 s48, 0x0
    s_mov_b32 s49, 0x4100
    buffer_load_dwordx4 v[112:115], v98, s[32:35], s48 offen sc1
    buffer_load_dwordx4 v[116:119], v98, s[32:35], s49 offen sc1
    v_or_b32 v99, s5, v109
    s_mov_b32 s48, 0x41000
    s_mov_b32 s49, 0x45100
    buffer_load_dwordx4 v[120:123], v99, s[32:35], s48 offen sc1
    buffer_load_dwordx4 v[124:127], v99, s[32:35], s49 offen sc1
    v_or_b32 v98, s6, v109
    s_mov_b32 s48, 0x82000
    s_mov_b32 s49, 0x86100
    buffer_load_dwordx4 v[128:131], v98, s[32:35], s48 offen sc1
    buffer_load_dwordx4 v[132:135], v98, s[32:35], s49 offen sc1
    v_or_b32 v99, s7, v109
    s_mov_b32 s48, 0xc3000
    s_mov_b32 s49, 0xc7100
    buffer_load_dwordx4 v[136:139], v99, s[32:35], s48 offen sc1
    buffer_load_dwordx4 v[140:143], v99, s[32:35], s49 offen sc1
    v_or_b32 v98, s8, v109
    s_mov_b32 s48, 0x104000
PAD_88:
    s_cbranch_execz PAD_89
    s_mov_b32 s49, 0x108100
    buffer_load_dwordx4 v[144:147], v98, s[32:35], s48 offen sc1
    buffer_load_dwordx4 v[148:151], v98, s[32:35], s49 offen sc1
    v_or_b32 v99, s9, v109
    s_mov_b32 s48, 0x145000
    s_mov_b32 s49, 0x149100
    buffer_load_dwordx4 v[152:155], v99, s[32:35], s48 offen sc1
    buffer_load_dwordx4 v[156:159], v99, s[32:35], s49 offen sc1
    v_or_b32 v98, s10, v109
    s_mov_b32 s48, 0x186000
    s_mov_b32 s49, 0x18a100
    buffer_load_dwordx4 v[160:163], v98, s[32:35], s48 offen sc1
    buffer_load_dwordx4 v[164:167], v98, s[32:35], s49 offen sc1
    v_or_b32 v99, s11, v109
    s_mov_b32 s48, 0x1c7000
    s_mov_b32 s49, 0x1cb100
    buffer_load_dwordx4 v[168:171], v99, s[32:35], s48 offen sc1
    buffer_load_dwordx4 v[172:175], v99, s[32:35], s49 offen sc1
    v_or_b32 v98, s12, v109
    s_mov_b32 s48, 0x208000
    s_mov_b32 s49, 0x20c100
    buffer_load_dwordx4 v[176:179], v98, s[32:35], s48 offen sc1
    buffer_load_dwordx4 v[180:183], v98, s[32:35], s49 offen sc1
    v_or_b32 v99, s13, v109
    s_mov_b32 s48, 0x249000
    s_mov_b32 s49, 0x24d100
    buffer_load_dwordx4 v[184:187], v99, s[32:35], s48 offen sc1
    buffer_load_dwordx4 v[188:191], v99, s[32:35], s49 offen sc1
    s_waitcnt vmcnt(18)
    v_bitop3_b32 v96, v112, v116, s60 bitop3:0x80
    v_cmp_eq_u32 vcc, 0, v96
    s_cmp_lg_u32 s4, 0
    s_cbranch_scc1 stage_28_0
    s_nop 1
    s_cbranch_vccnz stage_28_0
    v_swap_b32 v114, v116
    v_swap_b32 v115, v117
    ds_write_b128 v110, v[112:115] offset:0
PAD_89:
    s_cbranch_execz PAD_90
    ds_write_b128 v110, v[116:119] offset:512
    s_mov_b32 s4, 0x40000000
    s_sub_u32 s50, s50, 1
    v_and_b32 v93, v92, v112
    v_dot2_f32_bf16 v8, v93, v93, 0
    v_and_b32 v94, v92, v116
    v_dot2_f32_bf16 v9, v94, v94, 0
    v_dot2_f32_bf16 v8, v113, v113, v8
    v_dot2_f32_bf16 v9, v117, v117, v9
    v_dot2_f32_bf16 v8, v114, v114, v8
    v_dot2_f32_bf16 v9, v118, v118, v9
    v_dot2_f32_bf16 v8, v115, v115, v8
    v_dot2_f32_bf16 v9, v119, v119, v9
stage_28_0:
    s_waitcnt vmcnt(16)
    v_bitop3_b32 v96, v120, v124, s60 bitop3:0x80
    v_cmp_eq_u32 vcc, 0, v96
    s_cmp_lg_u32 s5, 0
    s_cbranch_scc1 stage_28_1
    s_nop 1
    s_cbranch_vccnz stage_28_1
    v_swap_b32 v122, v124
    v_swap_b32 v123, v125
    ds_write_b128 v110, v[120:123] offset:8192
    ds_write_b128 v110, v[124:127] offset:8704
    s_mov_b32 s5, 0x40000000
    s_sub_u32 s50, s50, 1
    v_dot2_f32_bf16 v10, v120, v120, 0
    v_dot2_f32_bf16 v11, v124, v124, 0
    v_dot2_f32_bf16 v10, v121, v121, v10
    v_dot2_f32_bf16 v11, v125, v125, v11
    v_dot2_f32_bf16 v10, v122, v122, v10
    v_dot2_f32_bf16 v11, v126, v126, v11
    v_dot2_f32_bf16 v10, v123, v123, v10
    v_dot2_f32_bf16 v11, v127, v127, v11
stage_28_1:
    s_waitcnt vmcnt(14)
    v_bitop3_b32 v96, v128, v132, s60 bitop3:0x80
    v_cmp_eq_u32 vcc, 0, v96
    s_cmp_lg_u32 s6, 0
    s_cbranch_scc1 stage_28_2
    s_nop 1
    s_cbranch_vccnz stage_28_2
PAD_90:
    s_cbranch_execz SCB_ret
    v_swap_b32 v130, v132
    v_swap_b32 v131, v133
    ds_write_b128 v110, v[128:131] offset:16384
    ds_write_b128 v110, v[132:135] offset:16896
    s_mov_b32 s6, 0x40000000
    s_sub_u32 s50, s50, 1
    v_dot2_f32_bf16 v12, v128, v128, 0
    v_dot2_f32_bf16 v13, v132, v132, 0
    v_dot2_f32_bf16 v12, v129, v129, v12
    v_dot2_f32_bf16 v13, v133, v133, v13
    v_dot2_f32_bf16 v12, v130, v130, v12
    v_dot2_f32_bf16 v13, v134, v134, v13
    v_dot2_f32_bf16 v12, v131, v131, v12
    v_dot2_f32_bf16 v13, v135, v135, v13
stage_28_2:
    s_waitcnt vmcnt(12)
    v_bitop3_b32 v96, v136, v140, s60 bitop3:0x80
    v_cmp_eq_u32 vcc, 0, v96
    s_cmp_lg_u32 s7, 0
    s_cbranch_scc1 stage_28_3
    s_nop 1
    s_cbranch_vccnz stage_28_3
    v_swap_b32 v138, v140
    v_swap_b32 v139, v141
    ds_write_b128 v110, v[136:139] offset:24576
    ds_write_b128 v110, v[140:143] offset:25088
    s_mov_b32 s7, 0x40000000
    s_sub_u32 s50, s50, 1
    v_dot2_f32_bf16 v14, v136, v136, 0
    v_dot2_f32_bf16 v15, v140, v140, 0
    v_dot2_f32_bf16 v14, v137, v137, v14
    v_dot2_f32_bf16 v15, v141, v141, v15
    v_dot2_f32_bf16 v14, v138, v138, v14
    v_dot2_f32_bf16 v15, v142, v142, v15
    v_dot2_f32_bf16 v14, v139, v139, v14
    v_dot2_f32_bf16 v15, v143, v143, v15
stage_28_3:
    s_waitcnt vmcnt(10)
    v_bitop3_b32 v96, v144, v148, s60 bitop3:0x80
    v_cmp_eq_u32 vcc, 0, v96
    s_cmp_lg_u32 s8, 0
    s_cbranch_scc1 stage_28_4
    s_nop 1
SCB_e1:
PAD_91:
    s_cbranch_execz PAD_92
    s_cbranch_vccnz stage_28_4
    v_swap_b32 v146, v148
    v_swap_b32 v147, v149
    ds_write_b128 v110, v[144:147] offset:32768
    ds_write_b128 v110, v[148:151] offset:33280
    s_mov_b32 s8, 0x40000000
    s_sub_u32 s50, s50, 1
    v_dot2_f32_bf16 v16, v144, v144, 0
    v_dot2_f32_bf16 v17, v148, v148, 0
    v_dot2_f32_bf16 v16, v145, v145, v16
    v_dot2_f32_bf16 v17, v149, v149, v17
    v_dot2_f32_bf16 v16, v146, v146, v16
    v_dot2_f32_bf16 v17, v150, v150, v17
    v_dot2_f32_bf16 v16, v147, v147, v16
    v_dot2_f32_bf16 v17, v151, v151, v17
stage_28_4:
    s_waitcnt vmcnt(8)
    v_bitop3_b32 v96, v152, v156, s60 bitop3:0x80
    v_cmp_eq_u32 vcc, 0, v96
    s_cmp_lg_u32 s9, 0
    s_cbranch_scc1 stage_28_5
    s_nop 1
    s_cbranch_vccnz stage_28_5
    v_swap_b32 v154, v156
    v_swap_b32 v155, v157
    ds_write_b128 v95, v[152:155] offset:0
    ds_write_b128 v95, v[156:159] offset:512
    s_mov_b32 s9, 0x40000000
    s_sub_u32 s50, s50, 1
    v_dot2_f32_bf16 v18, v152, v152, 0
    v_dot2_f32_bf16 v19, v156, v156, 0
    v_dot2_f32_bf16 v18, v153, v153, v18
    v_dot2_f32_bf16 v19, v157, v157, v19
    v_dot2_f32_bf16 v18, v154, v154, v18
    v_dot2_f32_bf16 v19, v158, v158, v19
    v_dot2_f32_bf16 v18, v155, v155, v18
    v_dot2_f32_bf16 v19, v159, v159, v19
stage_28_5:
    s_waitcnt vmcnt(6)
    v_bitop3_b32 v96, v160, v164, s60 bitop3:0x80
    v_cmp_eq_u32 vcc, 0, v96
    s_cmp_lg_u32 s10, 0
    s_cbranch_scc1 stage_28_6
PAD_92:
    s_cbranch_execz PAD_93
    s_nop 1
    s_cbranch_vccnz stage_28_6
    v_swap_b32 v162, v164
    v_swap_b32 v163, v165
    ds_write_b128 v95, v[160:163] offset:8192
    ds_write_b128 v95, v[164:167] offset:8704
    s_mov_b32 s10, 0x40000000
    s_sub_u32 s50, s50, 1
    v_dot2_f32_bf16 v20, v160, v160, 0
    v_dot2_f32_bf16 v21, v164, v164, 0
    v_dot2_f32_bf16 v20, v161, v161, v20
    v_dot2_f32_bf16 v21, v165, v165, v21
    v_dot2_f32_bf16 v20, v162, v162, v20
    v_dot2_f32_bf16 v21, v166, v166, v21
    v_dot2_f32_bf16 v20, v163, v163, v20
    v_dot2_f32_bf16 v21, v167, v167, v21
stage_28_6:
    s_waitcnt vmcnt(4)
    v_bitop3_b32 v96, v168, v172, s60 bitop3:0x80
    v_cmp_eq_u32 vcc, 0, v96
    s_cmp_lg_u32 s11, 0
    s_cbranch_scc1 stage_28_7
    s_nop 1
    s_cbranch_vccnz stage_28_7
    v_swap_b32 v170, v172
    v_swap_b32 v171, v173
    ds_write_b128 v95, v[168:171] offset:16384
    ds_write_b128 v95, v[172:175] offset:16896
    s_mov_b32 s11, 0x40000000
    s_sub_u32 s50, s50, 1
    v_dot2_f32_bf16 v22, v168, v168, 0
    v_dot2_f32_bf16 v23, v172, v172, 0
    v_dot2_f32_bf16 v22, v169, v169, v22
    v_dot2_f32_bf16 v23, v173, v173, v23
    v_dot2_f32_bf16 v22, v170, v170, v22
    v_dot2_f32_bf16 v23, v174, v174, v23
    v_dot2_f32_bf16 v22, v171, v171, v22
    v_dot2_f32_bf16 v23, v175, v175, v23
stage_28_7:
    s_waitcnt vmcnt(2)
    v_bitop3_b32 v96, v176, v180, s60 bitop3:0x80
    v_cmp_eq_u32 vcc, 0, v96
    s_cmp_lg_u32 s12, 0
PAD_93:
    s_cbranch_execz PAD_94
    s_cbranch_scc1 stage_28_8
    s_nop 1
    s_cbranch_vccnz stage_28_8
    v_swap_b32 v178, v180
    v_swap_b32 v179, v181
    ds_write_b128 v95, v[176:179] offset:24576
    ds_write_b128 v95, v[180:183] offset:25088
    s_mov_b32 s12, 0x40000000
    s_sub_u32 s50, s50, 1
    v_dot2_f32_bf16 v24, v176, v176, 0
    v_dot2_f32_bf16 v25, v180, v180, 0
    v_dot2_f32_bf16 v24, v177, v177, v24
    v_dot2_f32_bf16 v25, v181, v181, v25
    v_dot2_f32_bf16 v24, v178, v178, v24
    v_dot2_f32_bf16 v25, v182, v182, v25
    v_dot2_f32_bf16 v24, v179, v179, v24
    v_dot2_f32_bf16 v25, v183, v183, v25
stage_28_8:
    s_waitcnt vmcnt(0)
    v_bitop3_b32 v96, v184, v188, s60 bitop3:0x80
    v_cmp_eq_u32 vcc, 0, v96
    s_cmp_lg_u32 s13, 0
    s_cbranch_scc1 stage_28_9
    s_nop 1
    s_cbranch_vccnz stage_28_9
    v_swap_b32 v186, v188
    v_swap_b32 v187, v189
    ds_write_b128 v95, v[184:187] offset:32768
    ds_write_b128 v95, v[188:191] offset:33280
    s_mov_b32 s13, 0x40000000
    s_sub_u32 s50, s50, 1
    v_dot2_f32_bf16 v26, v184, v184, 0
    v_dot2_f32_bf16 v27, v188, v188, 0
    v_dot2_f32_bf16 v26, v185, v185, v26
    v_dot2_f32_bf16 v27, v189, v189, v27
    v_dot2_f32_bf16 v26, v186, v186, v26
    v_dot2_f32_bf16 v27, v190, v190, v27
    v_dot2_f32_bf16 v26, v187, v187, v26
    v_dot2_f32_bf16 v27, v191, v191, v27
stage_28_9:
    v_or3_b32 v96, v104, v105, v106
    v_bitop3_b32 v96, v96, v107, s17 bitop3:0xa8
PAD_94:
    s_cbranch_execz SCB_ret
    v_cmp_ne_u32 vcc, 0, v96
    s_nop 3
    s_cmp_lg_u64 vcc, 0
    s_cselect_b32 s48, 0, 0x40000000
    v_or_b32 v100, s48, v100
    s_cselect_b32 s48, 1, 0
    s_or_b32 s48, s48, s50
    s_cbranch_scc0 stage_28_ok
    s_waitcnt lgkmcnt(0)
    s_sub_u32 s55, s55, 1
    s_cbranch_scc0 stage_28
    s_mov_b32 s55, 0
stage_28_ok:
    v_pk_add_f32 v[8:9], v[8:9], v[10:11]
    v_pk_add_f32 v[12:13], v[12:13], v[14:15]
    v_pk_add_f32 v[16:17], v[16:17], v[18:19]
    v_pk_add_f32 v[20:21], v[20:21], v[22:23]
    v_pk_add_f32 v[24:25], v[24:25], v[26:27]
    v_pk_add_f32 v[8:9], v[8:9], v[12:13]
    v_pk_add_f32 v[16:17], v[16:17], v[20:21]
    v_pk_add_f32 v[8:9], v[8:9], v[24:25]
    v_pk_add_f32 v[84:85], v[8:9], v[16:17]
    s_nop 1
    v_permlane32_swap_b32 v84, v85
    v_add_f32 v84, v84, v85
    s_lshl_b32 s48, s26, 2
    v_lshlrev_b32 v92, 4, v1
    v_add_u32 v92, s48, v92
    v_add_u32 v92, 143360, v92
    ds_write_b32 v92, v84
    s_waitcnt lgkmcnt(0)
    s_barrier
    s_cmp_lg_u32 s63, 0
    s_cbranch_scc1 first_29
    s_lshl_b32 s48, s27, 3
    s_add_u32 s48, s48, s28
    s_lshr_b32 s49, s48, 2
    s_lshl_b32 s49, s49, 5
    s_and_b32 s3, s48, 3
    s_add_u32 s49, s49, s3
    s_lshl_b32 s49, s49, 2
    s_add_u32 s49, s49, 0xb81000
    v_sub_u32 v4, 0, v0
    v_and_b32 v4, 0x40000000, v4
    v_mov_b32 v5, 0
    buffer_store_dword v5, v4, s[32:35], s49 offen sc1
first_29:
    s_mul_i32 s58, s29, 4096
    s_add_u32 s58, s58, s53
    s_mul_i32 s59, s31, 4096
SCB_e13:
PAD_95:
    s_cbranch_execz PAD_96
    s_add_u32 s59, s59, s53
    v_add_u32 v110, 40960, v108
    s_lshl_b32 s50, s27, 8
    s_lshr_b32 s49, s26, 1
    s_lshl_b32 s49, s49, 7
    s_add_u32 s50, s50, s49
    s_and_b32 s49, s26, 1
    s_lshl_b32 s49, s49, 3
    s_add_u32 s50, s50, s49
    s_add_u32 s50, s50, 0xb81000
    ds_read_b128 v[40:43], v108 offset:0
    ds_read_b128 v[44:47], v108 offset:256
    ds_read_b128 v[48:51], v108 offset:4096
    ds_read_b128 v[52:55], v108 offset:4352
    ds_read_b128 v[56:59], v108 offset:8192
    ds_read_b128 v[60:63], v108 offset:8448
    s_waitcnt lgkmcnt(2)
    v_mfma_f32_16x16x32_bf16 v[8:11], a[0:3], v[40:43], 0
    ds_read_b128 v[64:67], v108 offset:12288
    v_mfma_f32_16x16x32_bf16 v[12:15], a[4:7], v[40:43], 0
    s_mov_b32 s52, 0x0
    buffer_load_dwordx4 v[112:115], v6, s[32:35], s52 offen offset:0 sc1
    v_mfma_f32_16x16x32_bf16 v[16:19], a[0:3], v[44:47], 0
    ds_read_b128 v[40:43], v108 offset:12544
    v_and_b32 v92, 31, v1
    v_lshlrev_b32 v92, 4, v92
    v_mfma_f32_16x16x32_bf16 v[20:23], a[4:7], v[44:47], 0
    v_add_u32 v92, 143360, v92
    ds_read_b128 v[100:103], v92 offset:0
    v_mfma_f32_16x16x32_bf16 v[8:11], a[8:11], v[48:51], v[8:11]
    ds_read_b128 v[44:47], v108 offset:16384
    ds_read_b128 v[104:107], v92 offset:512
    v_mov_b32 v109, v108
    v_mfma_f32_16x16x32_bf16 v[12:15], a[12:15], v[48:51], v[12:15]
    buffer_load_dwordx4 v[116:119], v6, s[32:35], s52 offen offset:1024 sc1
    v_mov_b32 v93, 0x3727c5ac
    v_mfma_f32_16x16x32_bf16 v[16:19], a[8:11], v[52:55], v[16:19]
    ds_read_b128 v[48:51], v108 offset:16640
PAD_96:
    s_cbranch_execz PAD_97
    v_lshl_or_b32 v76, v76, 16, v76
    s_mov_b32 s4, 0xffff
    v_mfma_f32_16x16x32_bf16 v[20:23], a[12:15], v[52:55], v[20:23]
    s_mov_b32 s5, 0x0
    s_waitcnt lgkmcnt(4)
    v_mfma_f32_16x16x32_bf16 v[8:11], a[16:19], v[56:59], v[8:11]
    ds_read_b128 v[52:55], v108 offset:20480
    s_mov_b32 s6, 0xffff0000
    s_mov_b32 s7, 0x0
    v_mfma_f32_16x16x32_bf16 v[12:15], a[20:23], v[56:59], v[12:15]
    buffer_load_dwordx4 v[120:123], v6, s[32:35], s52 offen offset:2048 sc1
    s_mov_b32 s8, 0x0
    v_mfma_f32_16x16x32_bf16 v[16:19], a[16:19], v[60:63], v[16:19]
    ds_read_b128 v[56:59], v108 offset:20736
    s_mov_b32 s9, 0xffff
    s_mov_b32 s10, 0x0
    v_mfma_f32_16x16x32_bf16 v[20:23], a[20:23], v[60:63], v[20:23]
    s_mov_b32 s11, 0xffff0000
    v_mfma_f32_16x16x32_bf16 v[8:11], a[24:27], v[64:67], v[8:11]
    ds_read_b128 v[60:63], v108 offset:24576
    v_mfma_f32_16x16x32_bf16 v[12:15], a[28:31], v[64:67], v[12:15]
    buffer_load_dwordx4 v[124:127], v6, s[32:35], s52 offen offset:3072 sc1
    s_waitcnt lgkmcnt(6)
    v_add_f32 v100, v100, v101
    v_mfma_f32_16x16x32_bf16 v[16:19], a[24:27], v[40:43], v[16:19]
    ds_read_b128 v[64:67], v108 offset:24832
    s_waitcnt lgkmcnt(5)
    v_add_f32 v104, v104, v105
    v_mfma_f32_16x16x32_bf16 v[20:23], a[28:31], v[40:43], v[20:23]
    v_add_f32 v102, v102, v103
    s_waitcnt lgkmcnt(2)
    v_mfma_f32_16x16x32_bf16 v[8:11], a[32:35], v[44:47], v[8:11]
    ds_read_b128 v[40:43], v108 offset:28672
    v_add_f32 v106, v106, v107
    v_add_f32 v100, v100, v102
    v_mfma_f32_16x16x32_bf16 v[12:15], a[36:39], v[44:47], v[12:15]
    s_mov_b32 s52, 0x1000
    buffer_load_dwordx4 v[128:131], v6, s[32:35], s52 offen offset:0 sc1
PAD_97:
    s_cbranch_execz SCB_ret
    v_mfma_f32_16x16x32_bf16 v[16:19], a[32:35], v[48:51], v[16:19]
    ds_read_b128 v[44:47], v108 offset:28928
    v_add_f32 v104, v104, v106
    v_mul_f32 v100, 0x3acccccd, v100
    v_mfma_f32_16x16x32_bf16 v[20:23], a[36:39], v[48:51], v[20:23]
    v_mul_f32 v104, 0x3acccccd, v104
    v_add_f32 v101, v100, v93
    v_mfma_f32_16x16x32_bf16 v[8:11], a[40:43], v[52:55], v[8:11]
    ds_read_b128 v[48:51], v108 offset:32768
    v_add_f32 v105, v104, v93
    v_mfma_f32_16x16x32_bf16 v[12:15], a[44:47], v[52:55], v[12:15]
    buffer_load_dwordx4 v[132:135], v6, s[32:35], s52 offen offset:1024 sc1
    v_mfma_f32_16x16x32_bf16 v[16:19], a[40:43], v[56:59], v[16:19]
    ds_read_b128 v[52:55], v108 offset:33024
    v_rsq_f32 v101, v101
    v_mfma_f32_16x16x32_bf16 v[20:23], a[44:47], v[56:59], v[20:23]
    s_waitcnt lgkmcnt(2)
    v_mfma_f32_16x16x32_bf16 v[8:11], a[48:51], v[60:63], v[8:11]
    ds_read_b128 v[56:59], v108 offset:36864
    v_rsq_f32 v105, v105
    v_mfma_f32_16x16x32_bf16 v[12:15], a[52:55], v[60:63], v[12:15]
    buffer_load_dwordx4 v[136:139], v6, s[32:35], s52 offen offset:2048 sc1
    v_mul_f32 v100, v100, v101
    v_mfma_f32_16x16x32_bf16 v[16:19], a[48:51], v[64:67], v[16:19]
    ds_read_b128 v[60:63], v108 offset:37120
    v_mul_f32 v104, v104, v105
    v_fma_f32 v100, v100, v101, v93
    v_mfma_f32_16x16x32_bf16 v[20:23], a[52:55], v[64:67], v[20:23]
    v_fma_f32 v104, v104, v105, v93
    v_mfma_f32_16x16x32_bf16 v[8:11], a[56:59], v[40:43], v[8:11]
    ds_read_b128 v[64:67], v108 offset:40960
    v_rsq_f32 v100, v100
    v_mfma_f32_16x16x32_bf16 v[12:15], a[60:63], v[40:43], v[12:15]
    buffer_load_dwordx4 v[140:143], v6, s[32:35], s52 offen offset:3072 sc1
    v_mfma_f32_16x16x32_bf16 v[16:19], a[56:59], v[44:47], v[16:19]
    ds_read_b128 v[40:43], v108 offset:41216
SCB_e25:
PAD_98:
    s_cbranch_execz PAD_99
    v_rsq_f32 v104, v104
    v_mfma_f32_16x16x32_bf16 v[20:23], a[60:63], v[44:47], v[20:23]
    v_mul_f32 v100, v100, v101
    s_waitcnt lgkmcnt(2)
    v_mfma_f32_16x16x32_bf16 v[8:11], a[64:67], v[48:51], v[8:11]
    ds_read_b128 v[44:47], v108 offset:45056
    v_mul_f32 v104, v104, v105
    v_mfma_f32_16x16x32_bf16 v[12:15], a[68:71], v[48:51], v[12:15]
    s_mov_b32 s52, 0x2000
    buffer_load_dwordx4 v[144:147], v6, s[32:35], s52 offen offset:0 sc1
    v_mfma_f32_16x16x32_bf16 v[16:19], a[64:67], v[52:55], v[16:19]
    ds_read_b128 v[48:51], v108 offset:45312
    v_rcp_f32 v88, v100
    v_mfma_f32_16x16x32_bf16 v[20:23], a[68:71], v[52:55], v[20:23]
    v_rcp_f32 v90, v104
    v_mfma_f32_16x16x32_bf16 v[8:11], a[72:75], v[56:59], v[8:11]
    ds_read_b128 v[52:55], v108 offset:49152
    v_mul_f32 v80, 0xc0135761, v100
    v_mul_f32 v82, 0xc0135761, v104
    v_mfma_f32_16x16x32_bf16 v[12:15], a[76:79], v[56:59], v[12:15]
    buffer_load_dwordx4 v[148:151], v6, s[32:35], s52 offen offset:1024 sc1
    v_mul_f32 v100, v100, v100
    v_mfma_f32_16x16x32_bf16 v[16:19], a[72:75], v[60:63], v[16:19]
    ds_read_b128 v[56:59], v108 offset:49408
    v_mul_f32 v104, v104, v104
    v_and_b32 v101, 0xffff0000, v88
    v_mfma_f32_16x16x32_bf16 v[20:23], a[76:79], v[60:63], v[20:23]
    v_and_b32 v105, 0xffff0000, v90
    s_waitcnt lgkmcnt(2)
    v_mfma_f32_16x16x32_bf16 v[8:11], a[80:83], v[64:67], v[8:11]
    ds_read_b128 v[60:63], v108 offset:53248
    v_mul_f32 v100, 0x3d372713, v100
    v_mul_f32 v104, 0x3d372713, v104
    v_mfma_f32_16x16x32_bf16 v[12:15], a[84:87], v[64:67], v[12:15]
    buffer_load_dwordx4 v[152:155], v6, s[32:35], s52 offen offset:2048 sc1
    v_sub_f32 v102, v88, v101
    v_mfma_f32_16x16x32_bf16 v[16:19], a[80:83], v[40:43], v[16:19]
PAD_99:
    s_cbranch_execz PAD_100
    ds_read_b128 v[64:67], v108 offset:53504
    v_sub_f32 v106, v90, v105
    v_mul_f32 v84, v100, v80
    v_mfma_f32_16x16x32_bf16 v[20:23], a[84:87], v[40:43], v[20:23]
    v_mul_f32 v86, v104, v82
    v_cvt_pk_bf16_f32 v69, v101, v102
    v_mfma_f32_16x16x32_bf16 v[8:11], a[88:91], v[44:47], v[8:11]
    ds_read_b128 v[40:43], v108 offset:57344
    v_cvt_pk_bf16_f32 v73, v105, v106
    v_mov_b32 v89, v88
    v_mfma_f32_16x16x32_bf16 v[12:15], a[92:95], v[44:47], v[12:15]
    buffer_load_dwordx4 v[156:159], v6, s[32:35], s52 offen offset:3072 sc1
    v_mov_b32 v91, v90
    v_mfma_f32_16x16x32_bf16 v[16:19], a[88:91], v[48:51], v[16:19]
    ds_read_b128 v[44:47], v108 offset:57600
    v_mov_b32 v81, v80
    v_mov_b32 v83, v82
    v_mfma_f32_16x16x32_bf16 v[20:23], a[92:95], v[48:51], v[20:23]
    v_mov_b32 v85, v84
    s_waitcnt lgkmcnt(2)
    v_mfma_f32_16x16x32_bf16 v[8:11], a[96:99], v[52:55], v[8:11]
    ds_read_b128 v[48:51], v108 offset:61440
    v_mov_b32 v87, v86
    v_mov_b32 v71, v69
    v_mfma_f32_16x16x32_bf16 v[12:15], a[100:103], v[52:55], v[12:15]
    s_mov_b32 s52, 0x3000
    buffer_load_dwordx4 v[160:163], v6, s[32:35], s52 offen offset:0 sc1
    v_mfma_f32_16x16x32_bf16 v[16:19], a[96:99], v[56:59], v[16:19]
    ds_read_b128 v[52:55], v108 offset:61696
    v_mov_b32 v75, v73
    v_permlane16_swap_b32 v88, v89
    v_mfma_f32_16x16x32_bf16 v[20:23], a[100:103], v[56:59], v[20:23]
    v_permlane16_swap_b32 v90, v91
    v_permlane16_swap_b32 v80, v81
    v_mfma_f32_16x16x32_bf16 v[8:11], a[104:107], v[60:63], v[8:11]
    ds_read_b128 v[56:59], v110 offset:24576
    v_permlane16_swap_b32 v82, v83
    v_permlane16_swap_b32 v84, v85
    v_mfma_f32_16x16x32_bf16 v[12:15], a[108:111], v[60:63], v[12:15]
    buffer_load_dwordx4 v[164:167], v6, s[32:35], s52 offen offset:1024 sc1
PAD_100:
    s_cbranch_execz PAD_101
    v_permlane16_swap_b32 v86, v87
    v_mfma_f32_16x16x32_bf16 v[16:19], a[104:107], v[64:67], v[16:19]
    ds_read_b128 v[60:63], v110 offset:24832
    v_permlane16_swap_b32 v69, v71
    v_permlane16_swap_b32 v73, v75
    v_mfma_f32_16x16x32_bf16 v[20:23], a[108:111], v[64:67], v[20:23]
    s_waitcnt lgkmcnt(2)
    v_mfma_f32_16x16x32_bf16 v[8:11], a[112:115], v[40:43], v[8:11]
    ds_read_b128 v[64:67], v110 offset:28672
    v_mfma_f32_16x16x32_bf16 v[12:15], a[116:119], v[40:43], v[12:15]
    buffer_load_dwordx4 v[168:171], v6, s[32:35], s52 offen offset:2048 sc1
    v_mfma_f32_16x16x32_bf16 v[16:19], a[112:115], v[44:47], v[16:19]
    ds_read_b128 v[40:43], v110 offset:28928
    v_mfma_f32_16x16x32_bf16 v[20:23], a[116:119], v[44:47], v[20:23]
    v_mfma_f32_16x16x32_bf16 v[8:11], a[120:123], v[48:51], v[8:11]
    ds_read_b128 v[44:47], v110 offset:32768
    v_mfma_f32_16x16x32_bf16 v[12:15], a[124:127], v[48:51], v[12:15]
    buffer_load_dwordx4 v[172:175], v6, s[32:35], s52 offen offset:3072 sc1
    v_mfma_f32_16x16x32_bf16 v[16:19], a[120:123], v[52:55], v[16:19]
    ds_read_b128 v[48:51], v110 offset:33024
    v_mfma_f32_16x16x32_bf16 v[20:23], a[124:127], v[52:55], v[20:23]
    s_waitcnt lgkmcnt(2)
    v_mfma_f32_16x16x32_bf16 v[8:11], a[128:131], v[56:59], v[8:11]
    ds_read_b128 v[52:55], v110 offset:36864
    v_mfma_f32_16x16x32_bf16 v[12:15], a[132:135], v[56:59], v[12:15]
    s_mov_b32 s52, 0x4000
    buffer_load_dwordx4 v[176:179], v6, s[32:35], s52 offen offset:0 sc1
    v_mfma_f32_16x16x32_bf16 v[16:19], a[128:131], v[60:63], v[16:19]
    ds_read_b128 v[56:59], v110 offset:37120
    v_mfma_f32_16x16x32_bf16 v[20:23], a[132:135], v[60:63], v[20:23]
    v_mfma_f32_16x16x32_bf16 v[8:11], a[136:139], v[64:67], v[8:11]
    ds_read_b128 v[60:63], v108 offset:512
    v_mfma_f32_16x16x32_bf16 v[12:15], a[140:143], v[64:67], v[12:15]
    buffer_load_dwordx4 v[180:183], v6, s[32:35], s52 offen offset:1024 sc1
PAD_101:
    s_cbranch_execz SCB_ret
    v_mfma_f32_16x16x32_bf16 v[16:19], a[136:139], v[40:43], v[16:19]
    ds_read_b128 v[64:67], v108 offset:768
    v_mfma_f32_16x16x32_bf16 v[20:23], a[140:143], v[40:43], v[20:23]
    s_waitcnt lgkmcnt(2)
    v_mfma_f32_16x16x32_bf16 v[8:11], a[144:147], v[44:47], v[8:11]
    ds_read_b128 v[40:43], v108 offset:4608
    v_mfma_f32_16x16x32_bf16 v[12:15], a[148:151], v[44:47], v[12:15]
    buffer_load_dwordx4 v[184:187], v6, s[32:35], s52 offen offset:2048 sc1
    v_mfma_f32_16x16x32_bf16 v[16:19], a[144:147], v[48:51], v[16:19]
    ds_read_b128 v[44:47], v108 offset:4864
    v_mfma_f32_16x16x32_bf16 v[20:23], a[148:151], v[48:51], v[20:23]
    v_mfma_f32_16x16x32_bf16 v[8:11], a[152:155], v[52:55], v[8:11]
    ds_read_b128 v[48:51], v108 offset:8704
    v_mfma_f32_16x16x32_bf16 v[12:15], a[156:159], v[52:55], v[12:15]
    buffer_load_dwordx4 v[188:191], v6, s[32:35], s52 offen offset:3072 sc1
    v_mfma_f32_16x16x32_bf16 v[16:19], a[152:155], v[56:59], v[16:19]
    ds_read_b128 v[52:55], v108 offset:8960
    v_mfma_f32_16x16x32_bf16 v[20:23], a[156:159], v[56:59], v[20:23]
    v_cndmask_b32 v68, 0, v69, s[4:5]
    v_cndmask_b32 v70, 0, v69, s[6:7]
    v_cndmask_b32 v72, 0, v71, s[4:5]
    v_cndmask_b32 v74, 0, v71, s[6:7]
    v_mfma_f32_16x16x32_bf16 v[8:11], v[76:79], v[68:71], v[8:11]
    v_mfma_f32_16x16x32_bf16 v[12:15], v[76:79], v[70:73], v[12:15]
    v_mfma_f32_16x16x32_bf16 v[16:19], v[76:79], v[72:75], v[16:19]
    v_mfma_f32_16x16x32_bf16 v[20:23], v[76:79], v[74:77], v[20:23]
    s_waitcnt lgkmcnt(2)
    v_mfma_f32_16x16x32_bf16 v[24:27], a[0:3], v[60:63], 0
    ds_read_b128 v[56:59], v108 offset:12800
    v_mfma_f32_16x16x32_bf16 v[28:31], a[4:7], v[60:63], 0
    v_mfma_f32_16x16x32_bf16 v[32:35], a[0:3], v[64:67], 0
    ds_read_b128 v[60:63], v108 offset:13056
SCB_e37:
PAD_102:
    s_cbranch_execz PAD_103
    v_mul_f32 v92, v8, v8
    v_fma_f32 v92, v92, v84, v80
    v_mfma_f32_16x16x32_bf16 v[36:39], a[4:7], v[64:67], 0
    s_mov_b32 s52, 0x5000
    buffer_load_dwordx4 a[0:3], v6, s[32:35], s52 offen offset:0 sc1
    buffer_load_dwordx4 a[4:7], v6, s[32:35], s52 offen offset:1024 sc1
    v_mfma_f32_16x16x32_bf16 v[24:27], a[8:11], v[40:43], v[24:27]
    ds_read_b128 v[64:67], v108 offset:16896
    v_mul_f32 v92, v92, v8
    v_mfma_f32_16x16x32_bf16 v[28:31], a[12:15], v[40:43], v[28:31]
    v_exp_f32 v92, v92
    v_mfma_f32_16x16x32_bf16 v[32:35], a[8:11], v[44:47], v[32:35]
    ds_read_b128 v[40:43], v108 offset:17152
    v_mul_f32 v93, v9, v9
    v_fma_f32 v92, v92, v88, v88
    v_mfma_f32_16x16x32_bf16 v[36:39], a[12:15], v[44:47], v[36:39]
    v_fma_f32 v93, v93, v84, v80
    s_waitcnt lgkmcnt(2)
    v_mfma_f32_16x16x32_bf16 v[24:27], a[16:19], v[48:51], v[24:27]
    ds_read_b128 v[44:47], v108 offset:20992
    v_rcp_f32 v92, v92
    v_mfma_f32_16x16x32_bf16 v[28:31], a[20:23], v[48:51], v[28:31]
    buffer_load_dwordx4 a[8:11], v6, s[32:35], s52 offen offset:2048 sc1
    v_mul_f32 v93, v93, v9
    v_mfma_f32_16x16x32_bf16 v[32:35], a[16:19], v[52:55], v[32:35]
    ds_read_b128 v[48:51], v108 offset:21248
    v_mul_f32 v8, v8, v92
    v_mfma_f32_16x16x32_bf16 v[36:39], a[20:23], v[52:55], v[36:39]
    v_exp_f32 v93, v93
    v_mfma_f32_16x16x32_bf16 v[24:27], a[24:27], v[56:59], v[24:27]
    ds_read_b128 v[52:55], v108 offset:25088
    v_mul_f32 v94, v10, v10
    v_fma_f32 v93, v93, v88, v88
    v_mfma_f32_16x16x32_bf16 v[28:31], a[28:31], v[56:59], v[28:31]
    buffer_load_dwordx4 a[12:15], v6, s[32:35], s52 offen offset:3072 sc1
    v_fma_f32 v94, v94, v84, v80
    v_mfma_f32_16x16x32_bf16 v[32:35], a[24:27], v[60:63], v[32:35]
PAD_103:
    s_cbranch_execz PAD_104
    ds_read_b128 v[56:59], v108 offset:25344
    v_rcp_f32 v93, v93
    v_mfma_f32_16x16x32_bf16 v[36:39], a[28:31], v[60:63], v[36:39]
    v_mul_f32 v94, v94, v10
    s_waitcnt lgkmcnt(2)
    v_mfma_f32_16x16x32_bf16 v[24:27], a[32:35], v[64:67], v[24:27]
    ds_read_b128 v[60:63], v108 offset:29184
    v_mul_f32 v9, v9, v93
    v_mfma_f32_16x16x32_bf16 v[28:31], a[36:39], v[64:67], v[28:31]
    s_mov_b32 s52, 0x6000
    buffer_load_dwordx4 a[16:19], v6, s[32:35], s52 offen offset:0 sc1
    v_mfma_f32_16x16x32_bf16 v[32:35], a[32:35], v[40:43], v[32:35]
    ds_read_b128 v[64:67], v108 offset:29440
    v_exp_f32 v94, v94
    v_mfma_f32_16x16x32_bf16 v[36:39], a[36:39], v[40:43], v[36:39]
    v_add_u32 v8, s15, v8
    v_and_or_b32 v8, v8, v3, s16
    v_mfma_f32_16x16x32_bf16 v[24:27], a[40:43], v[44:47], v[24:27]
    ds_read_b128 v[40:43], v108 offset:33280
    v_cvt_pk_bf16_f32 v100, v8, v9
    v_mul_f32 v95, v11, v11
    v_mfma_f32_16x16x32_bf16 v[28:31], a[44:47], v[44:47], v[28:31]
    buffer_load_dwordx4 a[20:23], v6, s[32:35], s52 offen offset:1024 sc1
    v_fma_f32 v94, v94, v88, v88
    v_mfma_f32_16x16x32_bf16 v[32:35], a[40:43], v[48:51], v[32:35]
    ds_read_b128 v[44:47], v108 offset:33536
    v_fma_f32 v95, v95, v84, v80
    v_mfma_f32_16x16x32_bf16 v[36:39], a[44:47], v[48:51], v[36:39]
    s_waitcnt lgkmcnt(2)
    v_mfma_f32_16x16x32_bf16 v[24:27], a[48:51], v[52:55], v[24:27]
    ds_read_b128 v[48:51], v108 offset:37376
    v_rcp_f32 v94, v94
    v_mfma_f32_16x16x32_bf16 v[28:31], a[52:55], v[52:55], v[28:31]
    buffer_load_dwordx4 a[24:27], v6, s[32:35], s52 offen offset:2048 sc1
    v_mul_f32 v95, v95, v11
    v_mfma_f32_16x16x32_bf16 v[32:35], a[48:51], v[56:59], v[32:35]
PAD_104:
    s_cbranch_execz PAD_105
    ds_read_b128 v[52:55], v108 offset:37632
    v_mul_f32 v10, v10, v94
    v_mfma_f32_16x16x32_bf16 v[36:39], a[52:55], v[56:59], v[36:39]
    v_exp_f32 v95, v95
    v_mfma_f32_16x16x32_bf16 v[24:27], a[56:59], v[60:63], v[24:27]
    ds_read_b128 v[56:59], v108 offset:41472
    v_mul_f32 v92, v12, v12
    v_fma_f32 v95, v95, v88, v88
    v_mfma_f32_16x16x32_bf16 v[28:31], a[60:63], v[60:63], v[28:31]
    buffer_load_dwordx4 a[28:31], v6, s[32:35], s52 offen offset:3072 sc1
    v_fma_f32 v92, v92, v84, v80
    v_mfma_f32_16x16x32_bf16 v[32:35], a[56:59], v[64:67], v[32:35]
    ds_read_b128 v[60:63], v108 offset:41728
    v_rcp_f32 v95, v95
    v_mfma_f32_16x16x32_bf16 v[36:39], a[60:63], v[64:67], v[36:39]
    v_mul_f32 v92, v92, v12
    s_waitcnt lgkmcnt(2)
    v_mfma_f32_16x16x32_bf16 v[24:27], a[64:67], v[40:43], v[24:27]
    ds_read_b128 v[64:67], v108 offset:45568
    v_mul_f32 v11, v11, v95
    v_mfma_f32_16x16x32_bf16 v[28:31], a[68:71], v[40:43], v[28:31]
    s_mov_b32 s52, 0x7000
    buffer_load_dwordx4 a[32:35], v6, s[32:35], s52 offen offset:0 sc1
    v_mfma_f32_16x16x32_bf16 v[32:35], a[64:67], v[44:47], v[32:35]
    ds_read_b128 v[40:43], v108 offset:45824
    v_exp_f32 v92, v92
    v_mfma_f32_16x16x32_bf16 v[36:39], a[68:71], v[44:47], v[36:39]
    v_cvt_pk_bf16_f32 v101, v10, v11
    v_or_b32 v100, s63, v100
    v_mfma_f32_16x16x32_bf16 v[24:27], a[72:75], v[48:51], v[24:27]
    ds_read_b128 v[44:47], v108 offset:49664
    v_mul_f32 v93, v13, v13
    v_fma_f32 v92, v92, v88, v88
    v_mfma_f32_16x16x32_bf16 v[28:31], a[76:79], v[48:51], v[28:31]
    buffer_load_dwordx4 a[36:39], v6, s[32:35], s52 offen offset:1024 sc1
    v_fma_f32 v93, v93, v84, v80
    v_mfma_f32_16x16x32_bf16 v[32:35], a[72:75], v[52:55], v[32:35]
PAD_105:
    s_cbranch_execz SCB_ret
    ds_read_b128 v[48:51], v108 offset:49920
    v_rcp_f32 v92, v92
    v_mfma_f32_16x16x32_bf16 v[36:39], a[76:79], v[52:55], v[36:39]
    v_mul_f32 v93, v93, v13
    s_waitcnt lgkmcnt(2)
    v_mfma_f32_16x16x32_bf16 v[24:27], a[80:83], v[56:59], v[24:27]
    ds_read_b128 v[52:55], v108 offset:53760
    v_mul_f32 v12, v12, v92
    v_mfma_f32_16x16x32_bf16 v[28:31], a[84:87], v[56:59], v[28:31]
    buffer_load_dwordx4 a[40:43], v6, s[32:35], s52 offen offset:2048 sc1
    v_mfma_f32_16x16x32_bf16 v[32:35], a[80:83], v[60:63], v[32:35]
    ds_read_b128 v[56:59], v108 offset:54016
    v_exp_f32 v93, v93
    v_mfma_f32_16x16x32_bf16 v[36:39], a[84:87], v[60:63], v[36:39]
    v_mul_f32 v94, v14, v14
    v_fma_f32 v93, v93, v88, v88
    v_mfma_f32_16x16x32_bf16 v[24:27], a[88:91], v[64:67], v[24:27]
    ds_read_b128 v[60:63], v108 offset:57856
    v_fma_f32 v94, v94, v84, v80
    v_mfma_f32_16x16x32_bf16 v[28:31], a[92:95], v[64:67], v[28:31]
    buffer_load_dwordx4 a[44:47], v6, s[32:35], s52 offen offset:3072 sc1
    v_mfma_f32_16x16x32_bf16 v[32:35], a[88:91], v[40:43], v[32:35]
    ds_read_b128 v[64:67], v108 offset:58112
    v_rcp_f32 v93, v93
    v_mfma_f32_16x16x32_bf16 v[36:39], a[92:95], v[40:43], v[36:39]
    v_mul_f32 v94, v94, v14
    s_waitcnt lgkmcnt(2)
    v_mfma_f32_16x16x32_bf16 v[24:27], a[96:99], v[44:47], v[24:27]
    ds_read_b128 v[40:43], v108 offset:61952
    v_mul_f32 v13, v13, v93
    v_mfma_f32_16x16x32_bf16 v[28:31], a[100:103], v[44:47], v[28:31]
    s_mov_b32 s52, 0x8000
    buffer_load_dwordx4 a[48:51], v6, s[32:35], s52 offen offset:0 sc1
    v_mfma_f32_16x16x32_bf16 v[32:35], a[96:99], v[48:51], v[32:35]
    ds_read_b128 v[44:47], v108 offset:62208
    v_exp_f32 v94, v94
    v_mfma_f32_16x16x32_bf16 v[36:39], a[100:103], v[48:51], v[36:39]
SCB_e2:
PAD_106:
    s_cbranch_execz PAD_107
    v_cvt_pk_bf16_f32 v102, v12, v13
    v_mul_f32 v95, v15, v15
    v_mfma_f32_16x16x32_bf16 v[24:27], a[104:107], v[52:55], v[24:27]
    ds_read_b128 v[48:51], v110 offset:25088
    v_fma_f32 v94, v94, v88, v88
    v_fma_f32 v95, v95, v84, v80
    v_mfma_f32_16x16x32_bf16 v[28:31], a[108:111], v[52:55], v[28:31]
    buffer_load_dwordx4 a[52:55], v6, s[32:35], s52 offen offset:1024 sc1
    v_mfma_f32_16x16x32_bf16 v[32:35], a[104:107], v[56:59], v[32:35]
    ds_read_b128 v[52:55], v110 offset:25344
    v_rcp_f32 v94, v94
    v_mfma_f32_16x16x32_bf16 v[36:39], a[108:111], v[56:59], v[36:39]
    v_mul_f32 v95, v95, v15
    s_waitcnt lgkmcnt(2)
    v_mfma_f32_16x16x32_bf16 v[24:27], a[112:115], v[60:63], v[24:27]
    ds_read_b128 v[56:59], v110 offset:29184
    v_mul_f32 v14, v14, v94
    v_mfma_f32_16x16x32_bf16 v[28:31], a[116:119], v[60:63], v[28:31]
    buffer_load_dwordx4 a[56:59], v6, s[32:35], s52 offen offset:2048 sc1
    v_mfma_f32_16x16x32_bf16 v[32:35], a[112:115], v[64:67], v[32:35]
    ds_read_b128 v[60:63], v110 offset:29440
    v_exp_f32 v95, v95
    v_mfma_f32_16x16x32_bf16 v[36:39], a[116:119], v[64:67], v[36:39]
    v_mul_f32 v92, v16, v16
    v_fma_f32 v95, v95, v88, v88
    v_mfma_f32_16x16x32_bf16 v[24:27], a[120:123], v[40:43], v[24:27]
    ds_read_b128 v[64:67], v110 offset:33280
    v_fma_f32 v92, v92, v85, v81
    v_mfma_f32_16x16x32_bf16 v[28:31], a[124:127], v[40:43], v[28:31]
    buffer_load_dwordx4 a[60:63], v6, s[32:35], s52 offen offset:3072 sc1
    v_mfma_f32_16x16x32_bf16 v[32:35], a[120:123], v[44:47], v[32:35]
    ds_read_b128 v[40:43], v110 offset:33536
    v_rcp_f32 v95, v95
    v_mfma_f32_16x16x32_bf16 v[36:39], a[124:127], v[44:47], v[36:39]
    v_mul_f32 v92, v92, v16
    s_waitcnt lgkmcnt(2)
PAD_107:
    s_cbranch_execz PAD_108
    v_mfma_f32_16x16x32_bf16 v[24:27], a[128:131], v[48:51], v[24:27]
    ds_read_b128 v[44:47], v110 offset:37376
    v_mul_f32 v15, v15, v95
    v_mfma_f32_16x16x32_bf16 v[28:31], a[132:135], v[48:51], v[28:31]
    s_mov_b32 s52, 0x9000
    buffer_load_dwordx4 a[64:67], v6, s[32:35], s52 offen offset:0 sc1
    v_mfma_f32_16x16x32_bf16 v[32:35], a[128:131], v[52:55], v[32:35]
    ds_read_b128 v[48:51], v110 offset:37632
    v_exp_f32 v92, v92
    v_mfma_f32_16x16x32_bf16 v[36:39], a[132:135], v[52:55], v[36:39]
    v_cvt_pk_bf16_f32 v103, v14, v15
    buffer_store_dwordx4 v[100:103], v109, s[32:35], s58 offen offset:0 sc1
    v_mfma_f32_16x16x32_bf16 v[24:27], a[136:139], v[56:59], v[24:27]
    ds_read_b128 v[52:55], v108 offset:0
    v_mul_f32 v93, v17, v17
    v_fma_f32 v92, v92, v89, v89
    v_mfma_f32_16x16x32_bf16 v[28:31], a[140:143], v[56:59], v[28:31]
    buffer_load_dwordx4 a[68:71], v6, s[32:35], s52 offen offset:1024 sc1
    v_fma_f32 v93, v93, v85, v81
    v_mfma_f32_16x16x32_bf16 v[32:35], a[136:139], v[60:63], v[32:35]
    ds_read_b128 v[56:59], v108 offset:256
    v_rcp_f32 v92, v92
    v_mfma_f32_16x16x32_bf16 v[36:39], a[140:143], v[60:63], v[36:39]
    v_mul_f32 v93, v93, v17
    s_waitcnt lgkmcnt(2)
    v_mfma_f32_16x16x32_bf16 v[24:27], a[144:147], v[64:67], v[24:27]
    ds_read_b128 v[60:63], v108 offset:4096
    v_mul_f32 v16, v16, v92
    v_mfma_f32_16x16x32_bf16 v[28:31], a[148:151], v[64:67], v[28:31]
    buffer_load_dwordx4 a[72:75], v6, s[32:35], s52 offen offset:2048 sc1
    v_mfma_f32_16x16x32_bf16 v[32:35], a[144:147], v[40:43], v[32:35]
    ds_read_b128 v[64:67], v108 offset:4352
    v_exp_f32 v93, v93
    v_mfma_f32_16x16x32_bf16 v[36:39], a[148:151], v[40:43], v[36:39]
    v_mul_f32 v94, v18, v18
    v_fma_f32 v93, v93, v89, v89
PAD_108:
    s_cbranch_execz PAD_109
    v_mfma_f32_16x16x32_bf16 v[24:27], a[152:155], v[44:47], v[24:27]
    ds_read_b128 v[40:43], v108 offset:8192
    v_fma_f32 v94, v94, v85, v81
    v_mfma_f32_16x16x32_bf16 v[28:31], a[156:159], v[44:47], v[28:31]
    buffer_load_dwordx4 a[76:79], v6, s[32:35], s52 offen offset:3072 sc1
    v_mfma_f32_16x16x32_bf16 v[32:35], a[152:155], v[48:51], v[32:35]
    ds_read_b128 v[44:47], v108 offset:8448
    v_rcp_f32 v93, v93
    v_mfma_f32_16x16x32_bf16 v[36:39], a[156:159], v[48:51], v[36:39]
    v_mul_f32 v94, v94, v18
    v_mul_f32 v17, v17, v93
    v_cndmask_b32 v68, 0, v73, s[4:5]
    v_cndmask_b32 v70, 0, v73, s[6:7]
    v_cndmask_b32 v72, 0, v75, s[4:5]
    v_cndmask_b32 v74, 0, v75, s[6:7]
    v_mfma_f32_16x16x32_bf16 v[24:27], v[76:79], v[68:71], v[24:27]
    v_exp_f32 v94, v94
    v_mfma_f32_16x16x32_bf16 v[28:31], v[76:79], v[70:73], v[28:31]
    v_add_u32 v16, s15, v16
    v_and_or_b32 v16, v16, v3, s16
    v_mfma_f32_16x16x32_bf16 v[32:35], v[76:79], v[72:75], v[32:35]
    v_cvt_pk_bf16_f32 v104, v16, v17
    v_mul_f32 v95, v19, v19
    v_mfma_f32_16x16x32_bf16 v[36:39], v[76:79], v[74:77], v[36:39]
    v_fma_f32 v94, v94, v89, v89
    v_fma_f32 v95, v95, v85, v81
    buffer_load_dwordx2 v[4:5], off, s[32:35], s50 sc1
    v_rcp_f32 v94, v94
    v_mul_f32 v95, v95, v19
    v_mul_f32 v18, v18, v94
    v_exp_f32 v95, v95
    v_mul_f32 v92, v20, v20
    v_fma_f32 v95, v95, v89, v89
    v_fma_f32 v92, v92, v85, v81
    v_rcp_f32 v95, v95
    v_mul_f32 v92, v92, v20
    v_mul_f32 v19, v19, v95
    v_exp_f32 v92, v92
    v_cvt_pk_bf16_f32 v105, v18, v19
PAD_109:
    s_cbranch_execz SCB_ret
    v_or_b32 v104, s63, v104
    v_mul_f32 v93, v21, v21
    v_fma_f32 v92, v92, v89, v89
    v_fma_f32 v93, v93, v85, v81
    v_rcp_f32 v92, v92
    v_mul_f32 v93, v93, v21
    v_mul_f32 v20, v20, v92
    v_exp_f32 v93, v93
    v_mul_f32 v94, v22, v22
    v_fma_f32 v93, v93, v89, v89
    v_fma_f32 v94, v94, v85, v81
    v_rcp_f32 v93, v93
    v_mul_f32 v94, v94, v22
    v_mul_f32 v21, v21, v93
    v_exp_f32 v94, v94
    v_cvt_pk_bf16_f32 v106, v20, v21
    v_mul_f32 v95, v23, v23
    v_fma_f32 v94, v94, v89, v89
    v_fma_f32 v95, v95, v85, v81
    v_rcp_f32 v94, v94
    v_mul_f32 v95, v95, v23
    v_mul_f32 v22, v22, v94
    v_exp_f32 v95, v95
    s_nop 0
    v_fma_f32 v95, v95, v89, v89
    v_rcp_f32 v95, v95
    s_nop 0
    v_mul_f32 v23, v23, v95
    v_cvt_pk_bf16_f32 v107, v22, v23
    buffer_store_dwordx4 v[104:107], v109, s[32:35], s58 offen offset:256 sc1
    s_cmp_eq_u32 s30, 0
    s_cbranch_scc1 G1_one_30
    s_waitcnt lgkmcnt(2)
    v_mfma_f32_16x16x32_bf16 v[8:11], v[192:195], v[52:55], 0
    ds_read_b128 v[48:51], v108 offset:12288
    v_mfma_f32_16x16x32_bf16 v[12:15], v[196:199], v[52:55], 0
    v_mfma_f32_16x16x32_bf16 v[16:19], v[192:195], v[56:59], 0
    ds_read_b128 v[52:55], v108 offset:12544
    v_mul_f32 v92, v24, v24
    v_fma_f32 v92, v92, v86, v82
    v_mfma_f32_16x16x32_bf16 v[20:23], v[196:199], v[56:59], 0
    s_mov_b32 s52, 0xa000
    buffer_load_dwordx4 a[80:83], v6, s[32:35], s52 offen offset:0 sc1
    v_mfma_f32_16x16x32_bf16 v[8:11], v[200:203], v[60:63], v[8:11]
SCB_e14:
PAD_110:
    s_cbranch_execz PAD_111
    ds_read_b128 v[56:59], v108 offset:16384
    v_mul_f32 v92, v92, v24
    v_mfma_f32_16x16x32_bf16 v[12:15], v[204:207], v[60:63], v[12:15]
    v_exp_f32 v92, v92
    v_mfma_f32_16x16x32_bf16 v[16:19], v[200:203], v[64:67], v[16:19]
    ds_read_b128 v[60:63], v108 offset:16640
    v_mul_f32 v93, v25, v25
    v_fma_f32 v92, v92, v90, v90
    v_mfma_f32_16x16x32_bf16 v[20:23], v[204:207], v[64:67], v[20:23]
    buffer_load_dwordx4 a[84:87], v6, s[32:35], s52 offen offset:1024 sc1
    s_waitcnt lgkmcnt(2)
    v_mfma_f32_16x16x32_bf16 v[8:11], v[208:211], v[40:43], v[8:11]
    ds_read_b128 v[64:67], v108 offset:20480
    v_fma_f32 v93, v93, v86, v82
    v_mfma_f32_16x16x32_bf16 v[12:15], v[212:215], v[40:43], v[12:15]
    v_rcp_f32 v92, v92
    v_mfma_f32_16x16x32_bf16 v[16:19], v[208:211], v[44:47], v[16:19]
    ds_read_b128 v[40:43], v108 offset:20736
    v_mul_f32 v93, v93, v25
    v_mul_f32 v24, v24, v92
    v_mfma_f32_16x16x32_bf16 v[20:23], v[212:215], v[44:47], v[20:23]
    buffer_load_dwordx4 a[88:91], v6, s[32:35], s52 offen offset:2048 sc1
    v_mfma_f32_16x16x32_bf16 v[8:11], v[216:219], v[48:51], v[8:11]
    ds_read_b128 v[44:47], v108 offset:24576
    v_exp_f32 v93, v93
    v_mfma_f32_16x16x32_bf16 v[12:15], v[220:223], v[48:51], v[12:15]
    v_mul_f32 v94, v26, v26
    v_fma_f32 v93, v93, v90, v90
    v_mfma_f32_16x16x32_bf16 v[16:19], v[216:219], v[52:55], v[16:19]
    ds_read_b128 v[48:51], v108 offset:24832
    v_fma_f32 v94, v94, v86, v82
    v_mfma_f32_16x16x32_bf16 v[20:23], v[220:223], v[52:55], v[20:23]
    s_waitcnt lgkmcnt(2)
    v_mfma_f32_16x16x32_bf16 v[8:11], v[224:227], v[56:59], v[8:11]
    ds_read_b128 v[52:55], v108 offset:28672
    v_rcp_f32 v93, v93
    v_mfma_f32_16x16x32_bf16 v[12:15], v[228:231], v[56:59], v[12:15]
PAD_111:
    s_cbranch_execz PAD_112
    buffer_load_dwordx4 a[92:95], v6, s[32:35], s52 offen offset:3072 sc1
    v_mul_f32 v94, v94, v26
    v_mfma_f32_16x16x32_bf16 v[16:19], v[224:227], v[60:63], v[16:19]
    ds_read_b128 v[56:59], v108 offset:28928
    v_mul_f32 v25, v25, v93
    v_mfma_f32_16x16x32_bf16 v[20:23], v[228:231], v[60:63], v[20:23]
    v_exp_f32 v94, v94
    v_mfma_f32_16x16x32_bf16 v[8:11], v[232:235], v[64:67], v[8:11]
    ds_read_b128 v[60:63], v108 offset:32768
    v_add_u32 v24, s15, v24
    v_and_or_b32 v24, v24, v3, s16
    v_mfma_f32_16x16x32_bf16 v[12:15], v[236:239], v[64:67], v[12:15]
    s_mov_b32 s52, 0xb000
    buffer_load_dwordx4 a[96:99], v6, s[32:35], s52 offen offset:0 sc1
    v_mfma_f32_16x16x32_bf16 v[16:19], v[232:235], v[40:43], v[16:19]
    ds_read_b128 v[64:67], v108 offset:33024
    v_cvt_pk_bf16_f32 v100, v24, v25
    v_mul_f32 v95, v27, v27
    v_mfma_f32_16x16x32_bf16 v[20:23], v[236:239], v[40:43], v[20:23]
    v_fma_f32 v94, v94, v90, v90
    s_waitcnt lgkmcnt(2)
    v_mfma_f32_16x16x32_bf16 v[8:11], v[240:243], v[44:47], v[8:11]
    ds_read_b128 v[40:43], v108 offset:36864
    v_fma_f32 v95, v95, v86, v82
    v_mfma_f32_16x16x32_bf16 v[12:15], v[244:247], v[44:47], v[12:15]
    buffer_load_dwordx4 a[100:103], v6, s[32:35], s52 offen offset:1024 sc1
    v_mfma_f32_16x16x32_bf16 v[16:19], v[240:243], v[48:51], v[16:19]
    ds_read_b128 v[44:47], v108 offset:37120
    v_rcp_f32 v94, v94
    v_mfma_f32_16x16x32_bf16 v[20:23], v[244:247], v[48:51], v[20:23]
    v_mul_f32 v95, v95, v27
    v_mul_f32 v26, v26, v94
    v_mfma_f32_16x16x32_bf16 v[8:11], v[248:251], v[52:55], v[8:11]
    ds_read_b128 v[48:51], v108 offset:40960
    v_exp_f32 v95, v95
    v_mfma_f32_16x16x32_bf16 v[12:15], v[252:255], v[52:55], v[12:15]
PAD_112:
    s_cbranch_execz PAD_113
    buffer_load_dwordx4 a[104:107], v6, s[32:35], s52 offen offset:2048 sc1
    v_mul_f32 v92, v28, v28
    v_mfma_f32_16x16x32_bf16 v[16:19], v[248:251], v[56:59], v[16:19]
    ds_read_b128 v[52:55], v108 offset:41216
    v_fma_f32 v95, v95, v90, v90
    v_fma_f32 v92, v92, v86, v82
    v_mfma_f32_16x16x32_bf16 v[20:23], v[252:255], v[56:59], v[20:23]
    s_waitcnt lgkmcnt(2)
    v_mfma_f32_16x16x32_bf16 v[8:11], a[160:163], v[60:63], v[8:11]
    ds_read_b128 v[56:59], v108 offset:45056
    v_rcp_f32 v95, v95
    v_mfma_f32_16x16x32_bf16 v[12:15], a[164:167], v[60:63], v[12:15]
    buffer_load_dwordx4 a[108:111], v6, s[32:35], s52 offen offset:3072 sc1
    v_mul_f32 v92, v92, v28
    v_mfma_f32_16x16x32_bf16 v[16:19], a[160:163], v[64:67], v[16:19]
    ds_read_b128 v[60:63], v108 offset:45312
    v_mul_f32 v27, v27, v95
    v_mfma_f32_16x16x32_bf16 v[20:23], a[164:167], v[64:67], v[20:23]
    v_exp_f32 v92, v92
    v_mfma_f32_16x16x32_bf16 v[8:11], a[168:171], v[40:43], v[8:11]
    ds_read_b128 v[64:67], v108 offset:49152
    v_cvt_pk_bf16_f32 v101, v26, v27
    v_or_b32 v100, s63, v100
    v_mfma_f32_16x16x32_bf16 v[12:15], a[172:175], v[40:43], v[12:15]
    s_mov_b32 s52, 0xc000
    buffer_load_dwordx4 a[112:115], v6, s[32:35], s52 offen offset:0 sc1
    v_mfma_f32_16x16x32_bf16 v[16:19], a[168:171], v[44:47], v[16:19]
    ds_read_b128 v[40:43], v108 offset:49408
    v_mul_f32 v93, v29, v29
    v_fma_f32 v92, v92, v90, v90
    v_mfma_f32_16x16x32_bf16 v[20:23], a[172:175], v[44:47], v[20:23]
    v_fma_f32 v93, v93, v86, v82
    s_waitcnt lgkmcnt(2)
    v_mfma_f32_16x16x32_bf16 v[8:11], a[176:179], v[48:51], v[8:11]
    ds_read_b128 v[44:47], v108 offset:53248
    v_rcp_f32 v92, v92
    v_mfma_f32_16x16x32_bf16 v[12:15], a[180:183], v[48:51], v[12:15]
PAD_113:
    s_cbranch_execz SCB_ret
    buffer_load_dwordx4 a[116:119], v6, s[32:35], s52 offen offset:1024 sc1
    v_mul_f32 v93, v93, v29
    v_mfma_f32_16x16x32_bf16 v[16:19], a[176:179], v[52:55], v[16:19]
    ds_read_b128 v[48:51], v108 offset:53504
    v_mul_f32 v28, v28, v92
    v_mfma_f32_16x16x32_bf16 v[20:23], a[180:183], v[52:55], v[20:23]
    v_exp_f32 v93, v93
    v_mfma_f32_16x16x32_bf16 v[8:11], a[184:187], v[56:59], v[8:11]
    ds_read_b128 v[52:55], v108 offset:57344
    v_mul_f32 v94, v30, v30
    v_fma_f32 v93, v93, v90, v90
    v_mfma_f32_16x16x32_bf16 v[12:15], a[188:191], v[56:59], v[12:15]
    buffer_load_dwordx4 a[120:123], v6, s[32:35], s52 offen offset:2048 sc1
    v_fma_f32 v94, v94, v86, v82
    v_mfma_f32_16x16x32_bf16 v[16:19], a[184:187], v[60:63], v[16:19]
    ds_read_b128 v[56:59], v108 offset:57600
    v_rcp_f32 v93, v93
    v_mfma_f32_16x16x32_bf16 v[20:23], a[188:191], v[60:63], v[20:23]
    v_mul_f32 v94, v94, v30
    s_waitcnt lgkmcnt(2)
    v_mfma_f32_16x16x32_bf16 v[8:11], a[192:195], v[64:67], v[8:11]
    ds_read_b128 v[60:63], v108 offset:61440
    v_mul_f32 v29, v29, v93
    v_mfma_f32_16x16x32_bf16 v[12:15], a[196:199], v[64:67], v[12:15]
    buffer_load_dwordx4 a[124:127], v6, s[32:35], s52 offen offset:3072 sc1
    v_mfma_f32_16x16x32_bf16 v[16:19], a[192:195], v[40:43], v[16:19]
    ds_read_b128 v[64:67], v108 offset:61696
    v_exp_f32 v94, v94
    v_mfma_f32_16x16x32_bf16 v[20:23], a[196:199], v[40:43], v[20:23]
    v_cvt_pk_bf16_f32 v102, v28, v29
    v_mul_f32 v95, v31, v31
    v_mfma_f32_16x16x32_bf16 v[8:11], a[200:203], v[44:47], v[8:11]
    ds_read_b128 v[40:43], v110 offset:24576
    v_fma_f32 v94, v94, v90, v90
    v_fma_f32 v95, v95, v86, v82
    v_mfma_f32_16x16x32_bf16 v[12:15], a[204:207], v[44:47], v[12:15]
SCB_e26:
PAD_114:
    s_cbranch_execz PAD_115
    s_mov_b32 s52, 0xd000
    buffer_load_dwordx4 a[128:131], v6, s[32:35], s52 offen offset:0 sc1
    v_mfma_f32_16x16x32_bf16 v[16:19], a[200:203], v[48:51], v[16:19]
    ds_read_b128 v[44:47], v110 offset:24832
    v_rcp_f32 v94, v94
    v_mfma_f32_16x16x32_bf16 v[20:23], a[204:207], v[48:51], v[20:23]
    v_mul_f32 v95, v95, v31
    s_waitcnt lgkmcnt(2)
    v_mfma_f32_16x16x32_bf16 v[8:11], a[208:211], v[52:55], v[8:11]
    ds_read_b128 v[48:51], v110 offset:28672
    v_mul_f32 v30, v30, v94
    v_mfma_f32_16x16x32_bf16 v[12:15], a[212:215], v[52:55], v[12:15]
    buffer_load_dwordx4 a[132:135], v6, s[32:35], s52 offen offset:1024 sc1
    v_mfma_f32_16x16x32_bf16 v[16:19], a[208:211], v[56:59], v[16:19]
    ds_read_b128 v[52:55], v110 offset:28928
    v_exp_f32 v95, v95
    v_mfma_f32_16x16x32_bf16 v[20:23], a[212:215], v[56:59], v[20:23]
    v_mul_f32 v92, v32, v32
    v_fma_f32 v95, v95, v90, v90
    v_mfma_f32_16x16x32_bf16 v[8:11], a[216:219], v[60:63], v[8:11]
    ds_read_b128 v[56:59], v110 offset:32768
    v_fma_f32 v92, v92, v87, v83
    v_mfma_f32_16x16x32_bf16 v[12:15], a[220:223], v[60:63], v[12:15]
    buffer_load_dwordx4 a[136:139], v6, s[32:35], s52 offen offset:2048 sc1
    v_mfma_f32_16x16x32_bf16 v[16:19], a[216:219], v[64:67], v[16:19]
    ds_read_b128 v[60:63], v110 offset:33024
    v_rcp_f32 v95, v95
    v_mfma_f32_16x16x32_bf16 v[20:23], a[220:223], v[64:67], v[20:23]
    v_mul_f32 v92, v92, v32
    s_waitcnt lgkmcnt(2)
    v_mfma_f32_16x16x32_bf16 v[8:11], a[224:227], v[40:43], v[8:11]
    ds_read_b128 v[64:67], v110 offset:36864
    v_mul_f32 v31, v31, v95
    v_mfma_f32_16x16x32_bf16 v[12:15], a[228:231], v[40:43], v[12:15]
    buffer_load_dwordx4 a[140:143], v6, s[32:35], s52 offen offset:3072 sc1
    v_mfma_f32_16x16x32_bf16 v[16:19], a[224:227], v[44:47], v[16:19]
    ds_read_b128 v[40:43], v110 offset:37120
PAD_115:
    s_cbranch_execz PAD_116
    v_exp_f32 v92, v92
    v_mfma_f32_16x16x32_bf16 v[20:23], a[228:231], v[44:47], v[20:23]
    v_cvt_pk_bf16_f32 v103, v30, v31
    buffer_store_dwordx4 v[100:103], v109, s[32:35], s58 offen offset:512 sc1
    v_mfma_f32_16x16x32_bf16 v[8:11], a[232:235], v[48:51], v[8:11]
    ds_read_b128 v[44:47], v108 offset:512
    v_mul_f32 v93, v33, v33
    v_fma_f32 v92, v92, v91, v91
    v_mfma_f32_16x16x32_bf16 v[12:15], a[236:239], v[48:51], v[12:15]
    v_fma_f32 v93, v93, v87, v83
    v_mfma_f32_16x16x32_bf16 v[16:19], a[232:235], v[52:55], v[16:19]
    ds_read_b128 v[48:51], v108 offset:768
    v_rcp_f32 v92, v92
    v_mfma_f32_16x16x32_bf16 v[20:23], a[236:239], v[52:55], v[20:23]
    v_mul_f32 v93, v93, v33
    s_waitcnt lgkmcnt(2)
    v_mfma_f32_16x16x32_bf16 v[8:11], a[240:243], v[56:59], v[8:11]
    ds_read_b128 v[52:55], v108 offset:4608
    v_mul_f32 v32, v32, v92
    v_mfma_f32_16x16x32_bf16 v[12:15], a[244:247], v[56:59], v[12:15]
    v_exp_f32 v93, v93
    v_mfma_f32_16x16x32_bf16 v[16:19], a[240:243], v[60:63], v[16:19]
    ds_read_b128 v[56:59], v108 offset:4864
    v_mul_f32 v94, v34, v34
    v_fma_f32 v93, v93, v91, v91
    v_mfma_f32_16x16x32_bf16 v[20:23], a[244:247], v[60:63], v[20:23]
    v_fma_f32 v94, v94, v87, v83
    v_mfma_f32_16x16x32_bf16 v[8:11], a[248:251], v[64:67], v[8:11]
    ds_read_b128 v[60:63], v108 offset:8704
    v_rcp_f32 v93, v93
    v_mfma_f32_16x16x32_bf16 v[12:15], a[252:255], v[64:67], v[12:15]
    v_mul_f32 v94, v94, v34
    v_mul_f32 v33, v33, v93
    v_mfma_f32_16x16x32_bf16 v[16:19], a[248:251], v[40:43], v[16:19]
    ds_read_b128 v[64:67], v108 offset:8960
    v_exp_f32 v94, v94
    v_mfma_f32_16x16x32_bf16 v[20:23], a[252:255], v[40:43], v[20:23]
PAD_116:
    s_cbranch_execz SCB_ret
    v_add_u32 v32, s15, v32
    v_and_or_b32 v32, v32, v3, s16
    v_cndmask_b32 v68, 0, v69, s[8:9]
    v_cndmask_b32 v70, 0, v69, s[10:11]
    v_cndmask_b32 v72, 0, v71, s[8:9]
    v_cndmask_b32 v74, 0, v71, s[10:11]
    v_mfma_f32_16x16x32_bf16 v[8:11], v[76:79], v[68:71], v[8:11]
    v_cvt_pk_bf16_f32 v104, v32, v33
    v_mul_f32 v95, v35, v35
    v_mfma_f32_16x16x32_bf16 v[12:15], v[76:79], v[70:73], v[12:15]
    v_fma_f32 v94, v94, v91, v91
    v_fma_f32 v95, v95, v87, v83
    v_mfma_f32_16x16x32_bf16 v[16:19], v[76:79], v[72:75], v[16:19]
    v_rcp_f32 v94, v94
    v_mfma_f32_16x16x32_bf16 v[20:23], v[76:79], v[74:77], v[20:23]
    v_mul_f32 v95, v95, v35
    v_mul_f32 v34, v34, v94
    v_exp_f32 v95, v95
    v_mul_f32 v92, v36, v36
    v_fma_f32 v95, v95, v91, v91
    v_fma_f32 v92, v92, v87, v83
    v_rcp_f32 v95, v95
    v_mul_f32 v92, v92, v36
    v_mul_f32 v35, v35, v95
    v_exp_f32 v92, v92
    v_cvt_pk_bf16_f32 v105, v34, v35
    v_or_b32 v104, s63, v104
    v_mul_f32 v93, v37, v37
    v_fma_f32 v92, v92, v91, v91
    v_fma_f32 v93, v93, v87, v83
    v_rcp_f32 v92, v92
    v_mul_f32 v93, v93, v37
    v_mul_f32 v36, v36, v92
    v_exp_f32 v93, v93
    v_mul_f32 v94, v38, v38
    v_fma_f32 v93, v93, v91, v91
    v_fma_f32 v94, v94, v87, v83
    v_rcp_f32 v93, v93
    v_mul_f32 v94, v94, v38
    v_mul_f32 v37, v37, v93
    v_exp_f32 v94, v94
    v_cvt_pk_bf16_f32 v106, v36, v37
    v_mul_f32 v95, v39, v39
SCB_e38:
PAD_117:
    s_cbranch_execz PAD_118
    v_fma_f32 v94, v94, v91, v91
    v_fma_f32 v95, v95, v87, v83
    v_rcp_f32 v94, v94
    v_mul_f32 v95, v95, v39
    v_mul_f32 v38, v38, v94
    v_exp_f32 v95, v95
    s_nop 0
    v_fma_f32 v95, v95, v91, v91
    v_rcp_f32 v95, v95
    s_nop 0
    v_mul_f32 v39, v39, v95
    v_cvt_pk_bf16_f32 v107, v38, v39
    buffer_store_dwordx4 v[104:107], v109, s[32:35], s58 offen offset:768 sc1
    s_waitcnt lgkmcnt(2)
    v_mfma_f32_16x16x32_bf16 v[24:27], v[192:195], v[44:47], 0
    ds_read_b128 v[40:43], v108 offset:12800
    v_mfma_f32_16x16x32_bf16 v[28:31], v[196:199], v[44:47], 0
    v_mfma_f32_16x16x32_bf16 v[32:35], v[192:195], v[48:51], 0
    ds_read_b128 v[44:47], v108 offset:13056
    v_mul_f32 v92, v8, v8
    v_fma_f32 v92, v92, v84, v80
    v_mfma_f32_16x16x32_bf16 v[36:39], v[196:199], v[48:51], 0
    v_mul_f32 v92, v92, v8
    v_mfma_f32_16x16x32_bf16 v[24:27], v[200:203], v[52:55], v[24:27]
    ds_read_b128 v[48:51], v108 offset:16896
    v_exp_f32 v92, v92
    v_mfma_f32_16x16x32_bf16 v[28:31], v[204:207], v[52:55], v[28:31]
    v_mul_f32 v93, v9, v9
    v_fma_f32 v92, v92, v88, v88
    v_mfma_f32_16x16x32_bf16 v[32:35], v[200:203], v[56:59], v[32:35]
    ds_read_b128 v[52:55], v108 offset:17152
    v_fma_f32 v93, v93, v84, v80
    v_mfma_f32_16x16x32_bf16 v[36:39], v[204:207], v[56:59], v[36:39]
    s_waitcnt lgkmcnt(2)
    v_mfma_f32_16x16x32_bf16 v[24:27], v[208:211], v[60:63], v[24:27]
    ds_read_b128 v[56:59], v108 offset:20992
    v_rcp_f32 v92, v92
    v_mfma_f32_16x16x32_bf16 v[28:31], v[212:215], v[60:63], v[28:31]
    v_mul_f32 v93, v93, v9
    v_mul_f32 v8, v8, v92
PAD_118:
    s_cbranch_execz PAD_119
    v_mfma_f32_16x16x32_bf16 v[32:35], v[208:211], v[64:67], v[32:35]
    ds_read_b128 v[60:63], v108 offset:21248
    v_exp_f32 v93, v93
    v_mfma_f32_16x16x32_bf16 v[36:39], v[212:215], v[64:67], v[36:39]
    v_mul_f32 v94, v10, v10
    v_fma_f32 v93, v93, v88, v88
    v_mfma_f32_16x16x32_bf16 v[24:27], v[216:219], v[40:43], v[24:27]
    ds_read_b128 v[64:67], v108 offset:25088
    v_fma_f32 v94, v94, v84, v80
    v_mfma_f32_16x16x32_bf16 v[28:31], v[220:223], v[40:43], v[28:31]
    v_rcp_f32 v93, v93
    v_mfma_f32_16x16x32_bf16 v[32:35], v[216:219], v[44:47], v[32:35]
    ds_read_b128 v[40:43], v108 offset:25344
    v_mul_f32 v94, v94, v10
    v_mul_f32 v9, v9, v93
    v_mfma_f32_16x16x32_bf16 v[36:39], v[220:223], v[44:47], v[36:39]
    s_waitcnt lgkmcnt(2)
    v_mfma_f32_16x16x32_bf16 v[24:27], v[224:227], v[48:51], v[24:27]
    ds_read_b128 v[44:47], v108 offset:29184
    v_exp_f32 v94, v94
    v_mfma_f32_16x16x32_bf16 v[28:31], v[228:231], v[48:51], v[28:31]
    v_add_u32 v8, s15, v8
    v_and_or_b32 v8, v8, v3, s16
    v_mfma_f32_16x16x32_bf16 v[32:35], v[224:227], v[52:55], v[32:35]
    ds_read_b128 v[48:51], v108 offset:29440
    v_cvt_pk_bf16_f32 v100, v8, v9
    v_mul_f32 v95, v11, v11
    v_mfma_f32_16x16x32_bf16 v[36:39], v[228:231], v[52:55], v[36:39]
    v_fma_f32 v94, v94, v88, v88
    v_fma_f32 v95, v95, v84, v80
    v_mfma_f32_16x16x32_bf16 v[24:27], v[232:235], v[56:59], v[24:27]
    ds_read_b128 v[52:55], v108 offset:33280
    v_rcp_f32 v94, v94
    v_mfma_f32_16x16x32_bf16 v[28:31], v[236:239], v[56:59], v[28:31]
    v_mul_f32 v95, v95, v11
    v_mul_f32 v10, v10, v94
    v_mfma_f32_16x16x32_bf16 v[32:35], v[232:235], v[60:63], v[32:35]
    ds_read_b128 v[56:59], v108 offset:33536
PAD_119:
    s_cbranch_execz PAD_120
    v_exp_f32 v95, v95
    v_mfma_f32_16x16x32_bf16 v[36:39], v[236:239], v[60:63], v[36:39]
    v_mul_f32 v92, v12, v12
    s_waitcnt lgkmcnt(2)
    v_mfma_f32_16x16x32_bf16 v[24:27], v[240:243], v[64:67], v[24:27]
    ds_read_b128 v[60:63], v108 offset:37376
    v_fma_f32 v95, v95, v88, v88
    v_fma_f32 v92, v92, v84, v80
    v_mfma_f32_16x16x32_bf16 v[28:31], v[244:247], v[64:67], v[28:31]
    v_rcp_f32 v95, v95
    v_mfma_f32_16x16x32_bf16 v[32:35], v[240:243], v[40:43], v[32:35]
    ds_read_b128 v[64:67], v108 offset:37632
    v_mul_f32 v92, v92, v12
    v_mul_f32 v11, v11, v95
    v_mfma_f32_16x16x32_bf16 v[36:39], v[244:247], v[40:43], v[36:39]
    v_exp_f32 v92, v92
    v_mfma_f32_16x16x32_bf16 v[24:27], v[248:251], v[44:47], v[24:27]
    ds_read_b128 v[40:43], v108 offset:41472
    v_cvt_pk_bf16_f32 v101, v10, v11
    v_or_b32 v100, s63, v100
    v_mfma_f32_16x16x32_bf16 v[28:31], v[252:255], v[44:47], v[28:31]
    v_mul_f32 v93, v13, v13
    v_fma_f32 v92, v92, v88, v88
    v_mfma_f32_16x16x32_bf16 v[32:35], v[248:251], v[48:51], v[32:35]
    ds_read_b128 v[44:47], v108 offset:41728
    v_fma_f32 v93, v93, v84, v80
    v_mfma_f32_16x16x32_bf16 v[36:39], v[252:255], v[48:51], v[36:39]
    s_waitcnt lgkmcnt(2)
    v_mfma_f32_16x16x32_bf16 v[24:27], a[160:163], v[52:55], v[24:27]
    ds_read_b128 v[48:51], v108 offset:45568
    v_rcp_f32 v92, v92
    v_mfma_f32_16x16x32_bf16 v[28:31], a[164:167], v[52:55], v[28:31]
    v_mul_f32 v93, v93, v13
    v_mul_f32 v12, v12, v92
    v_mfma_f32_16x16x32_bf16 v[32:35], a[160:163], v[56:59], v[32:35]
    ds_read_b128 v[52:55], v108 offset:45824
    v_exp_f32 v93, v93
    v_mfma_f32_16x16x32_bf16 v[36:39], a[164:167], v[56:59], v[36:39]
PAD_120:
    s_cbranch_execz SCB_ret
    v_mul_f32 v94, v14, v14
    v_fma_f32 v93, v93, v88, v88
    v_mfma_f32_16x16x32_bf16 v[24:27], a[168:171], v[60:63], v[24:27]
    ds_read_b128 v[56:59], v108 offset:49664
    v_fma_f32 v94, v94, v84, v80
    v_mfma_f32_16x16x32_bf16 v[28:31], a[172:175], v[60:63], v[28:31]
    v_rcp_f32 v93, v93
    v_mfma_f32_16x16x32_bf16 v[32:35], a[168:171], v[64:67], v[32:35]
    ds_read_b128 v[60:63], v108 offset:49920
    v_mul_f32 v94, v94, v14
    v_mul_f32 v13, v13, v93
    v_mfma_f32_16x16x32_bf16 v[36:39], a[172:175], v[64:67], v[36:39]
    s_waitcnt vmcnt(19)
    v_or_b32 v4, v4, v5
    s_nop 0
    v_readfirstlane_b32 s49, v4
    s_nop 3
    s_cmp_lg_u32 s49, 0
    s_cbranch_scc1 flg_retry_33
flg_32:
    s_waitcnt lgkmcnt(2)
    v_mfma_f32_16x16x32_bf16 v[24:27], a[176:179], v[40:43], v[24:27]
    ds_read_b128 v[64:67], v108 offset:53760
    v_exp_f32 v94, v94
    v_mfma_f32_16x16x32_bf16 v[28:31], a[180:183], v[40:43], v[28:31]
    s_mov_b32 s48, 0x0
    buffer_load_dwordx4 v[192:195], v7, s[32:35], s48 offen offset:0 sc1
    v_mfma_f32_16x16x32_bf16 v[32:35], a[176:179], v[44:47], v[32:35]
    ds_read_b128 v[40:43], v108 offset:54016
    v_cvt_pk_bf16_f32 v102, v12, v13
    v_mul_f32 v95, v15, v15
    v_mfma_f32_16x16x32_bf16 v[36:39], a[180:183], v[44:47], v[36:39]
    v_fma_f32 v94, v94, v88, v88
    v_fma_f32 v95, v95, v84, v80
    v_mfma_f32_16x16x32_bf16 v[24:27], a[184:187], v[48:51], v[24:27]
    ds_read_b128 v[44:47], v108 offset:57856
    v_rcp_f32 v94, v94
    v_mfma_f32_16x16x32_bf16 v[28:31], a[188:191], v[48:51], v[28:31]
    buffer_load_dwordx4 v[196:199], v7, s[32:35], s48 offen offset:256 sc1
    v_mul_f32 v95, v95, v15
    v_mfma_f32_16x16x32_bf16 v[32:35], a[184:187], v[52:55], v[32:35]
SCB_e3:
PAD_121:
    s_cbranch_execz PAD_122
    ds_read_b128 v[48:51], v108 offset:58112
    v_mul_f32 v14, v14, v94
    v_mfma_f32_16x16x32_bf16 v[36:39], a[188:191], v[52:55], v[36:39]
    s_waitcnt lgkmcnt(2)
    v_mfma_f32_16x16x32_bf16 v[24:27], a[192:195], v[56:59], v[24:27]
    ds_read_b128 v[52:55], v108 offset:61952
    v_exp_f32 v95, v95
    v_mfma_f32_16x16x32_bf16 v[28:31], a[196:199], v[56:59], v[28:31]
    buffer_load_dwordx4 v[200:203], v7, s[32:35], s48 offen offset:512 sc1
    v_mul_f32 v92, v16, v16
    v_mfma_f32_16x16x32_bf16 v[32:35], a[192:195], v[60:63], v[32:35]
    ds_read_b128 v[56:59], v108 offset:62208
    v_fma_f32 v95, v95, v88, v88
    v_fma_f32 v92, v92, v85, v81
    v_mfma_f32_16x16x32_bf16 v[36:39], a[196:199], v[60:63], v[36:39]
    v_rcp_f32 v95, v95
    v_mfma_f32_16x16x32_bf16 v[24:27], a[200:203], v[64:67], v[24:27]
    ds_read_b128 v[60:63], v110 offset:25088
    v_mul_f32 v92, v92, v16
    v_mul_f32 v15, v15, v95
    v_mfma_f32_16x16x32_bf16 v[28:31], a[204:207], v[64:67], v[28:31]
    buffer_load_dwordx4 v[204:207], v7, s[32:35], s48 offen offset:768 sc1
    v_mfma_f32_16x16x32_bf16 v[32:35], a[200:203], v[40:43], v[32:35]
    ds_read_b128 v[64:67], v110 offset:25344
    v_exp_f32 v92, v92
    v_mfma_f32_16x16x32_bf16 v[36:39], a[204:207], v[40:43], v[36:39]
    v_cvt_pk_bf16_f32 v103, v14, v15
    s_waitcnt lgkmcnt(2)
    v_mfma_f32_16x16x32_bf16 v[24:27], a[208:211], v[44:47], v[24:27]
    ds_read_b128 v[40:43], v110 offset:29184
    buffer_store_dwordx4 v[100:103], v109, s[32:35], s59 offen offset:0 sc1
    v_mul_f32 v93, v17, v17
    v_mfma_f32_16x16x32_bf16 v[28:31], a[212:215], v[44:47], v[28:31]
    s_mov_b32 s48, 0x1000
    buffer_load_dwordx4 v[208:211], v7, s[32:35], s48 offen offset:0 sc1
    v_mfma_f32_16x16x32_bf16 v[32:35], a[208:211], v[48:51], v[32:35]
    ds_read_b128 v[44:47], v110 offset:29440
PAD_122:
    s_cbranch_execz PAD_123
    v_fma_f32 v92, v92, v89, v89
    v_fma_f32 v93, v93, v85, v81
    v_mfma_f32_16x16x32_bf16 v[36:39], a[212:215], v[48:51], v[36:39]
    v_rcp_f32 v92, v92
    v_mfma_f32_16x16x32_bf16 v[24:27], a[216:219], v[52:55], v[24:27]
    ds_read_b128 v[48:51], v110 offset:33280
    v_mul_f32 v93, v93, v17
    v_mul_f32 v16, v16, v92
    v_mfma_f32_16x16x32_bf16 v[28:31], a[220:223], v[52:55], v[28:31]
    buffer_load_dwordx4 v[212:215], v7, s[32:35], s48 offen offset:256 sc1
    v_mfma_f32_16x16x32_bf16 v[32:35], a[216:219], v[56:59], v[32:35]
    ds_read_b128 v[52:55], v110 offset:33536
    v_exp_f32 v93, v93
    v_mfma_f32_16x16x32_bf16 v[36:39], a[220:223], v[56:59], v[36:39]
    v_mul_f32 v94, v18, v18
    s_waitcnt lgkmcnt(2)
    v_mfma_f32_16x16x32_bf16 v[24:27], a[224:227], v[60:63], v[24:27]
    ds_read_b128 v[56:59], v110 offset:37376
    v_fma_f32 v93, v93, v89, v89
    v_fma_f32 v94, v94, v85, v81
    v_mfma_f32_16x16x32_bf16 v[28:31], a[228:231], v[60:63], v[28:31]
    buffer_load_dwordx4 v[216:219], v7, s[32:35], s48 offen offset:512 sc1
    v_mfma_f32_16x16x32_bf16 v[32:35], a[224:227], v[64:67], v[32:35]
    ds_read_b128 v[60:63], v110 offset:37632
    v_rcp_f32 v93, v93
    v_mfma_f32_16x16x32_bf16 v[36:39], a[228:231], v[64:67], v[36:39]
    v_mul_f32 v94, v94, v18
    v_mul_f32 v17, v17, v93
    v_mfma_f32_16x16x32_bf16 v[24:27], a[232:235], v[40:43], v[24:27]
    v_exp_f32 v94, v94
    v_add_u32 v16, s15, v16
    v_mfma_f32_16x16x32_bf16 v[28:31], a[236:239], v[40:43], v[28:31]
    buffer_load_dwordx4 v[220:223], v7, s[32:35], s48 offen offset:768 sc1
    v_and_or_b32 v16, v16, v3, s16
    v_mfma_f32_16x16x32_bf16 v[32:35], a[232:235], v[44:47], v[32:35]
    v_cvt_pk_bf16_f32 v104, v16, v17
    v_mul_f32 v95, v19, v19
PAD_123:
    s_cbranch_execz PAD_124
    v_fma_f32 v94, v94, v89, v89
    v_mfma_f32_16x16x32_bf16 v[36:39], a[236:239], v[44:47], v[36:39]
    v_fma_f32 v95, v95, v85, v81
    s_waitcnt lgkmcnt(0)
    v_mfma_f32_16x16x32_bf16 v[24:27], a[240:243], v[48:51], v[24:27]
    v_rcp_f32 v94, v94
    v_mul_f32 v95, v95, v19
    v_mfma_f32_16x16x32_bf16 v[28:31], a[244:247], v[48:51], v[28:31]
    s_mov_b32 s48, 0x2000
    buffer_load_dwordx4 v[224:227], v7, s[32:35], s48 offen offset:0 sc1
    v_mfma_f32_16x16x32_bf16 v[32:35], a[240:243], v[52:55], v[32:35]
    v_mul_f32 v18, v18, v94
    v_exp_f32 v95, v95
    v_mfma_f32_16x16x32_bf16 v[36:39], a[244:247], v[52:55], v[36:39]
    v_mul_f32 v92, v20, v20
    v_fma_f32 v95, v95, v89, v89
    v_mfma_f32_16x16x32_bf16 v[24:27], a[248:251], v[56:59], v[24:27]
    v_fma_f32 v92, v92, v85, v81
    v_rcp_f32 v95, v95
    v_mfma_f32_16x16x32_bf16 v[28:31], a[252:255], v[56:59], v[28:31]
    buffer_load_dwordx4 v[228:231], v7, s[32:35], s48 offen offset:256 sc1
    v_mul_f32 v92, v92, v20
    v_mfma_f32_16x16x32_bf16 v[32:35], a[248:251], v[60:63], v[32:35]
    v_mul_f32 v19, v19, v95
    v_exp_f32 v92, v92
    v_mfma_f32_16x16x32_bf16 v[36:39], a[252:255], v[60:63], v[36:39]
    v_cvt_pk_bf16_f32 v105, v18, v19
    v_or_b32 v104, s63, v104
    v_cndmask_b32 v68, 0, v73, s[8:9]
    v_cndmask_b32 v70, 0, v73, s[10:11]
    v_cndmask_b32 v72, 0, v75, s[8:9]
    v_cndmask_b32 v74, 0, v75, s[10:11]
    v_mfma_f32_16x16x32_bf16 v[24:27], v[76:79], v[68:71], v[24:27]
    v_mul_f32 v93, v21, v21
    v_fma_f32 v92, v92, v89, v89
    v_mfma_f32_16x16x32_bf16 v[28:31], v[76:79], v[70:73], v[28:31]
    v_fma_f32 v93, v93, v85, v81
    v_mfma_f32_16x16x32_bf16 v[32:35], v[76:79], v[72:75], v[32:35]
PAD_124:
    s_cbranch_execz SCB_ret
    v_rcp_f32 v92, v92
    v_mfma_f32_16x16x32_bf16 v[36:39], v[76:79], v[74:77], v[36:39]
    v_mul_f32 v93, v93, v21
    v_mul_f32 v20, v20, v92
    buffer_load_dwordx4 v[232:235], v7, s[32:35], s48 offen offset:512 sc1
    v_exp_f32 v93, v93
    v_mul_f32 v94, v22, v22
    v_fma_f32 v93, v93, v89, v89
    v_fma_f32 v94, v94, v85, v81
    v_rcp_f32 v93, v93
    v_mul_f32 v94, v94, v22
    v_mul_f32 v21, v21, v93
    v_exp_f32 v94, v94
    v_cvt_pk_bf16_f32 v106, v20, v21
    v_mul_f32 v95, v23, v23
    v_fma_f32 v94, v94, v89, v89
    v_fma_f32 v95, v95, v85, v81
    v_rcp_f32 v94, v94
    v_mul_f32 v95, v95, v23
    v_mul_f32 v22, v22, v94
    v_exp_f32 v95, v95
    s_nop 0
    v_fma_f32 v95, v95, v89, v89
    v_rcp_f32 v95, v95
    s_nop 0
    v_mul_f32 v23, v23, v95
    v_cvt_pk_bf16_f32 v107, v22, v23
    buffer_store_dwordx4 v[104:107], v109, s[32:35], s59 offen offset:256 sc1
    s_cmp_lg_u32 s63, 0
    s_cbranch_scc1 park_34
    s_barrier
park_34:
    v_pk_mul_f32 v[92:93], v[24:25], v[24:25]
    v_pk_mul_f32 v[94:95], v[26:27], v[26:27]
    v_pk_mul_f32 v[96:97], v[28:29], v[28:29]
    v_pk_mul_f32 v[98:99], v[30:31], v[30:31]
    v_pk_fma_f32 v[92:93], v[92:93], v[86:87], v[82:83] op_sel:[0,0,0] op_sel_hi:[1,0,0]
    v_pk_fma_f32 v[94:95], v[94:95], v[86:87], v[82:83] op_sel:[0,0,0] op_sel_hi:[1,0,0]
    v_pk_fma_f32 v[96:97], v[96:97], v[86:87], v[82:83] op_sel:[0,0,0] op_sel_hi:[1,0,0]
    v_pk_fma_f32 v[98:99], v[98:99], v[86:87], v[82:83] op_sel:[0,0,0] op_sel_hi:[1,0,0]
    v_pk_mul_f32 v[92:93], v[92:93], v[24:25]
    v_pk_mul_f32 v[94:95], v[94:95], v[26:27]
    v_pk_mul_f32 v[96:97], v[96:97], v[28:29]
SCB_e15:
PAD_125:
    s_cbranch_execz PAD_126
    v_pk_mul_f32 v[98:99], v[98:99], v[30:31]
    v_exp_f32 v92, v92
    s_mov_b32 s48, 0x2000
    buffer_load_dwordx4 v[236:239], v7, s[32:35], s48 offen offset:768 sc1
    v_exp_f32 v93, v93
    v_exp_f32 v94, v94
    v_exp_f32 v95, v95
    v_exp_f32 v96, v96
    v_exp_f32 v97, v97
    v_exp_f32 v98, v98
    v_exp_f32 v99, v99
    v_pk_fma_f32 v[92:93], v[92:93], v[90:91], v[90:91] op_sel:[0,0,0] op_sel_hi:[1,0,0]
    v_pk_fma_f32 v[94:95], v[94:95], v[90:91], v[90:91] op_sel:[0,0,0] op_sel_hi:[1,0,0]
    v_pk_fma_f32 v[96:97], v[96:97], v[90:91], v[90:91] op_sel:[0,0,0] op_sel_hi:[1,0,0]
    v_pk_fma_f32 v[98:99], v[98:99], v[90:91], v[90:91] op_sel:[0,0,0] op_sel_hi:[1,0,0]
    v_rcp_f32 v92, v92
    s_mov_b32 s48, 0x3000
    buffer_load_dwordx4 v[240:243], v7, s[32:35], s48 offen offset:0 sc1
    v_rcp_f32 v93, v93
    v_rcp_f32 v94, v94
    v_rcp_f32 v95, v95
    v_rcp_f32 v96, v96
    v_rcp_f32 v97, v97
    v_rcp_f32 v98, v98
    v_rcp_f32 v99, v99
    v_pk_mul_f32 v[24:25], v[24:25], v[92:93]
    v_pk_mul_f32 v[26:27], v[26:27], v[94:95]
    v_pk_mul_f32 v[28:29], v[28:29], v[96:97]
    v_pk_mul_f32 v[30:31], v[30:31], v[98:99]
    v_add_u32 v24, s15, v24
    v_and_or_b32 v24, v24, v3, s16
    buffer_load_dwordx4 v[244:247], v7, s[32:35], s48 offen offset:256 sc1
    v_cvt_pk_bf16_f32 v100, v24, v25
    v_cvt_pk_bf16_f32 v101, v26, v27
    v_or_b32 v100, s63, v100
    v_cvt_pk_bf16_f32 v102, v28, v29
    v_cvt_pk_bf16_f32 v103, v30, v31
    buffer_store_dwordx4 v[100:103], v109, s[32:35], s59 offen offset:512 sc1
    v_pk_mul_f32 v[92:93], v[32:33], v[32:33]
    v_pk_mul_f32 v[94:95], v[34:35], v[34:35]
PAD_126:
    s_cbranch_execz PAD_127
    v_pk_mul_f32 v[96:97], v[36:37], v[36:37]
    v_pk_mul_f32 v[98:99], v[38:39], v[38:39]
    v_pk_fma_f32 v[92:93], v[92:93], v[86:87], v[82:83] op_sel:[0,1,1] op_sel_hi:[1,1,1]
    v_pk_fma_f32 v[94:95], v[94:95], v[86:87], v[82:83] op_sel:[0,1,1] op_sel_hi:[1,1,1]
    v_pk_fma_f32 v[96:97], v[96:97], v[86:87], v[82:83] op_sel:[0,1,1] op_sel_hi:[1,1,1]
    v_pk_fma_f32 v[98:99], v[98:99], v[86:87], v[82:83] op_sel:[0,1,1] op_sel_hi:[1,1,1]
    v_pk_mul_f32 v[92:93], v[92:93], v[32:33]
    v_pk_mul_f32 v[94:95], v[94:95], v[34:35]
    v_pk_mul_f32 v[96:97], v[96:97], v[36:37]
    v_pk_mul_f32 v[98:99], v[98:99], v[38:39]
    buffer_load_dwordx4 v[248:251], v7, s[32:35], s48 offen offset:512 sc1
    v_exp_f32 v92, v92
    v_exp_f32 v93, v93
    v_exp_f32 v94, v94
    v_exp_f32 v95, v95
    v_exp_f32 v96, v96
    v_exp_f32 v97, v97
    v_exp_f32 v98, v98
    v_exp_f32 v99, v99
    v_pk_fma_f32 v[92:93], v[92:93], v[90:91], v[90:91] op_sel:[0,1,1] op_sel_hi:[1,1,1]
    v_pk_fma_f32 v[94:95], v[94:95], v[90:91], v[90:91] op_sel:[0,1,1] op_sel_hi:[1,1,1]
    v_pk_fma_f32 v[96:97], v[96:97], v[90:91], v[90:91] op_sel:[0,1,1] op_sel_hi:[1,1,1]
    v_pk_fma_f32 v[98:99], v[98:99], v[90:91], v[90:91] op_sel:[0,1,1] op_sel_hi:[1,1,1]
    buffer_load_dwordx4 v[252:255], v7, s[32:35], s48 offen offset:768 sc1
    v_rcp_f32 v92, v92
    v_rcp_f32 v93, v93
    v_rcp_f32 v94, v94
    v_rcp_f32 v95, v95
    v_rcp_f32 v96, v96
    v_rcp_f32 v97, v97
    v_rcp_f32 v98, v98
    v_rcp_f32 v99, v99
    v_pk_mul_f32 v[32:33], v[32:33], v[92:93]
    v_pk_mul_f32 v[34:35], v[34:35], v[94:95]
    v_pk_mul_f32 v[36:37], v[36:37], v[96:97]
    v_pk_mul_f32 v[38:39], v[38:39], v[98:99]
    v_add_u32 v32, s15, v32
    v_and_or_b32 v32, v32, v3, s16
    v_cvt_pk_bf16_f32 v104, v32, v33
    v_cvt_pk_bf16_f32 v105, v34, v35
PAD_127:
    s_cbranch_execz SCB_ret
    v_or_b32 v104, s63, v104
    v_cvt_pk_bf16_f32 v106, v36, v37
    v_cvt_pk_bf16_f32 v107, v38, v39
    buffer_store_dwordx4 v[104:107], v109, s[32:35], s59 offen offset:768 sc1
    s_branch G1_end_31
G1_one_30:
    v_pk_mul_f32 v[92:93], v[24:25], v[24:25]
    v_pk_mul_f32 v[94:95], v[26:27], v[26:27]
    v_pk_mul_f32 v[96:97], v[28:29], v[28:29]
    v_pk_mul_f32 v[98:99], v[30:31], v[30:31]
    v_pk_fma_f32 v[92:93], v[92:93], v[86:87], v[82:83] op_sel:[0,0,0] op_sel_hi:[1,0,0]
    v_pk_fma_f32 v[94:95], v[94:95], v[86:87], v[82:83] op_sel:[0,0,0] op_sel_hi:[1,0,0]
    v_pk_fma_f32 v[96:97], v[96:97], v[86:87], v[82:83] op_sel:[0,0,0] op_sel_hi:[1,0,0]
    v_pk_fma_f32 v[98:99], v[98:99], v[86:87], v[82:83] op_sel:[0,0,0] op_sel_hi:[1,0,0]
    v_pk_mul_f32 v[92:93], v[92:93], v[24:25]
    v_pk_mul_f32 v[94:95], v[94:95], v[26:27]
    v_pk_mul_f32 v[96:97], v[96:97], v[28:29]
    v_pk_mul_f32 v[98:99], v[98:99], v[30:31]
    v_exp_f32 v92, v92
    v_exp_f32 v93, v93
    v_exp_f32 v94, v94
    v_exp_f32 v95, v95
    v_exp_f32 v96, v96
    v_exp_f32 v97, v97
    v_exp_f32 v98, v98
    v_exp_f32 v99, v99
    v_pk_fma_f32 v[92:93], v[92:93], v[90:91], v[90:91] op_sel:[0,0,0] op_sel_hi:[1,0,0]
    v_pk_fma_f32 v[94:95], v[94:95], v[90:91], v[90:91] op_sel:[0,0,0] op_sel_hi:[1,0,0]
    v_pk_fma_f32 v[96:97], v[96:97], v[90:91], v[90:91] op_sel:[0,0,0] op_sel_hi:[1,0,0]
    v_pk_fma_f32 v[98:99], v[98:99], v[90:91], v[90:91] op_sel:[0,0,0] op_sel_hi:[1,0,0]
    v_rcp_f32 v92, v92
    v_rcp_f32 v93, v93
    v_rcp_f32 v94, v94
    v_rcp_f32 v95, v95
    v_rcp_f32 v96, v96
    v_rcp_f32 v97, v97
    v_rcp_f32 v98, v98
    v_rcp_f32 v99, v99
    v_pk_mul_f32 v[24:25], v[24:25], v[92:93]
    v_pk_mul_f32 v[26:27], v[26:27], v[94:95]
    v_pk_mul_f32 v[28:29], v[28:29], v[96:97]
    v_pk_mul_f32 v[30:31], v[30:31], v[98:99]
SCB_e27:
PAD_128:
    s_cbranch_execz PAD_129
    v_add_u32 v24, s15, v24
    v_and_or_b32 v24, v24, v3, s16
    v_cvt_pk_bf16_f32 v100, v24, v25
    v_cvt_pk_bf16_f32 v101, v26, v27
    v_or_b32 v100, s63, v100
    v_cvt_pk_bf16_f32 v102, v28, v29
    v_cvt_pk_bf16_f32 v103, v30, v31
    buffer_store_dwordx4 v[100:103], v109, s[32:35], s58 offen offset:512 sc1
    v_pk_mul_f32 v[92:93], v[32:33], v[32:33]
    v_pk_mul_f32 v[94:95], v[34:35], v[34:35]
    v_pk_mul_f32 v[96:97], v[36:37], v[36:37]
    v_pk_mul_f32 v[98:99], v[38:39], v[38:39]
    v_pk_fma_f32 v[92:93], v[92:93], v[86:87], v[82:83] op_sel:[0,1,1] op_sel_hi:[1,1,1]
    v_pk_fma_f32 v[94:95], v[94:95], v[86:87], v[82:83] op_sel:[0,1,1] op_sel_hi:[1,1,1]
    v_pk_fma_f32 v[96:97], v[96:97], v[86:87], v[82:83] op_sel:[0,1,1] op_sel_hi:[1,1,1]
    v_pk_fma_f32 v[98:99], v[98:99], v[86:87], v[82:83] op_sel:[0,1,1] op_sel_hi:[1,1,1]
    v_pk_mul_f32 v[92:93], v[92:93], v[32:33]
    v_pk_mul_f32 v[94:95], v[94:95], v[34:35]
    v_pk_mul_f32 v[96:97], v[96:97], v[36:37]
    v_pk_mul_f32 v[98:99], v[98:99], v[38:39]
    v_exp_f32 v92, v92
    v_exp_f32 v93, v93
    v_exp_f32 v94, v94
    v_exp_f32 v95, v95
    v_exp_f32 v96, v96
    v_exp_f32 v97, v97
    v_exp_f32 v98, v98
    v_exp_f32 v99, v99
    v_pk_fma_f32 v[92:93], v[92:93], v[90:91], v[90:91] op_sel:[0,1,1] op_sel_hi:[1,1,1]
    v_pk_fma_f32 v[94:95], v[94:95], v[90:91], v[90:91] op_sel:[0,1,1] op_sel_hi:[1,1,1]
    v_pk_fma_f32 v[96:97], v[96:97], v[90:91], v[90:91] op_sel:[0,1,1] op_sel_hi:[1,1,1]
    v_pk_fma_f32 v[98:99], v[98:99], v[90:91], v[90:91] op_sel:[0,1,1] op_sel_hi:[1,1,1]
    v_rcp_f32 v92, v92
    v_rcp_f32 v93, v93
    v_rcp_f32 v94, v94
    v_rcp_f32 v95, v95
    v_rcp_f32 v96, v96
    v_rcp_f32 v97, v97
    v_rcp_f32 v98, v98
    v_rcp_f32 v99, v99
PAD_129:
    s_cbranch_execz PAD_130
    v_pk_mul_f32 v[32:33], v[32:33], v[92:93]
    v_pk_mul_f32 v[34:35], v[34:35], v[94:95]
    v_pk_mul_f32 v[36:37], v[36:37], v[96:97]
    v_pk_mul_f32 v[38:39], v[38:39], v[98:99]
    v_add_u32 v32, s15, v32
    v_and_or_b32 v32, v32, v3, s16
    v_cvt_pk_bf16_f32 v104, v32, v33
    v_cvt_pk_bf16_f32 v105, v34, v35
    v_or_b32 v104, s63, v104
    v_cvt_pk_bf16_f32 v106, v36, v37
    v_cvt_pk_bf16_f32 v107, v38, v39
    buffer_store_dwordx4 v[104:107], v109, s[32:35], s58 offen offset:768 sc1
    s_add_u32 s48, s26, s63
    s_cmp_eq_u32 s48, 4
    s_cbranch_scc1 G2_low
    s_lshl_b32 s5, s63, 1
    s_sub_u32 s5, s5, s26
    s_add_u32 s5, s5, 3
    s_lshl_b32 s5, s5, 8
    s_add_u32 s5, s5, s2
    s_sub_u32 s5, s5, 128
    s_cmp_ge_u32 s5, 128
    s_cbranch_scc1 prep_35
    s_and_b32 s4, s2, 7
    s_lshl_b32 s4, s4, 2
    s_bfe_u32 s5, s2, 0x20003
    s_add_u32 s5, s5, s4
    s_sub_u32 s4, 115, s5
    s_sub_u32 s5, s5, 8
    s_cmp_lt_u32 s5, 12
    s_cselect_b32 s4, s4, -1
    s_sub_u32 s5, s2, 160
    s_cselect_b32 s4, s4, s5
    s_cmp_lt_i32 s4, 0
    s_cbranch_scc1 prep_35
    v_bfe_u32 v88, v1, 4, 1
    v_bfe_u32 v89, v1, 2, 2
    s_mov_b32 s52, 0xa000
    buffer_load_dwordx4 a[80:83], v6, s[32:35], s52 offen offset:0 sc1
    v_lshl_add_u32 v88, v88, 3, v89
    v_mul_u32_u24 v88, 1344, v88
    v_lshrrev_b32 v90, 5, v1
PAD_130:
    s_cbranch_execz PAD_131
    v_mul_u32_u24 v89, 640, v90
    buffer_load_dwordx4 a[84:87], v6, s[32:35], s52 offen offset:1024 sc1
    v_add_u32 v88, v88, v89
    v_add_u32 v88, 81920, v88
    v_and_b32 v89, 3, v1
    v_lshl_add_u32 v91, v89, 4, v88
    buffer_load_dwordx4 a[88:91], v6, s[32:35], s52 offen offset:2048 sc1
    v_lshl_add_u32 v92, v89, 3, v88
    v_mul_u32_u24 v90, 1146368, v90
    v_add_u32 v90, v90, v2
    s_lshr_b32 s5, s4, 1
    buffer_load_dwordx4 a[92:95], v6, s[32:35], s52 offen offset:3072 sc1
    s_mul_i32 s5, s5, 5120
    s_and_b32 s4, s4, 1
    s_lshl_b32 s4, s4, 9
    s_add_u32 s5, s5, s4
    s_mov_b32 s52, 0xb000
    buffer_load_dwordx4 a[96:99], v6, s[32:35], s52 offen offset:0 sc1
    ds_read_b64_tr_b16 v[8:9], v91 offset:0
    ds_read_b64_tr_b16 v[10:11], v91 offset:5376
    ds_read_b64_tr_b16 v[12:13], v91 offset:8
    ds_read_b64_tr_b16 v[14:15], v91 offset:5384
    buffer_load_dwordx4 a[100:103], v6, s[32:35], s52 offen offset:1024 sc1
    ds_read_b64_tr_b16 v[16:17], v91 offset:64
    ds_read_b64_tr_b16 v[18:19], v91 offset:5440
    ds_read_b64_tr_b16 v[20:21], v91 offset:72
    ds_read_b64_tr_b16 v[22:23], v91 offset:5448
    buffer_load_dwordx4 a[104:107], v6, s[32:35], s52 offen offset:2048 sc1
    ds_read_b64_tr_b16 v[24:25], v92 offset:128
    ds_read_b64_tr_b16 v[26:27], v92 offset:5504
    s_add_u32 s6, s5, 0x94c000
    s_add_u32 s7, s6, 4096
    buffer_load_dwordx4 a[108:111], v6, s[32:35], s52 offen offset:3072 sc1
    s_waitcnt lgkmcnt(8)
    buffer_store_dwordx4 v[8:11], v90, s[32:35], s6 offen offset:0 sc1
    s_waitcnt lgkmcnt(6)
PAD_131:
    s_cbranch_execz SCB_ret
    buffer_store_dwordx4 v[12:15], v90, s[32:35], s6 offen offset:1024 sc1
    s_waitcnt lgkmcnt(4)
    buffer_store_dwordx4 v[16:19], v90, s[32:35], s6 offen offset:2048 sc1
    s_waitcnt lgkmcnt(2)
    buffer_store_dwordx4 v[20:23], v90, s[32:35], s6 offen offset:3072 sc1
    s_mov_b32 s52, 0xc000
    buffer_load_dwordx4 a[112:115], v6, s[32:35], s52 offen offset:0 sc1
    s_waitcnt lgkmcnt(0)
    buffer_store_dwordx4 v[24:27], v90, s[32:35], s7 offen offset:0 sc1
    ds_read_b64_tr_b16 v[28:29], v91 offset:160
    ds_read_b64_tr_b16 v[30:31], v91 offset:5536
    ds_read_b64_tr_b16 v[32:33], v91 offset:168
    buffer_load_dwordx4 a[116:119], v6, s[32:35], s52 offen offset:1024 sc1
    ds_read_b64_tr_b16 v[34:35], v91 offset:5544
    ds_read_b64_tr_b16 v[36:37], v91 offset:224
    ds_read_b64_tr_b16 v[38:39], v91 offset:5600
    ds_read_b64_tr_b16 v[40:41], v91 offset:232
    buffer_load_dwordx4 a[120:123], v6, s[32:35], s52 offen offset:2048 sc1
    ds_read_b64_tr_b16 v[42:43], v91 offset:5608
    ds_read_b64_tr_b16 v[44:45], v92 offset:288
    ds_read_b64_tr_b16 v[46:47], v92 offset:5664
    s_add_u32 s6, s5, 0x992000
    buffer_load_dwordx4 a[124:127], v6, s[32:35], s52 offen offset:3072 sc1
    s_add_u32 s7, s6, 4096
    s_waitcnt lgkmcnt(8)
    buffer_store_dwordx4 v[28:31], v90, s[32:35], s6 offen offset:0 sc1
    s_waitcnt lgkmcnt(6)
    buffer_store_dwordx4 v[32:35], v90, s[32:35], s6 offen offset:1024 sc1
    s_waitcnt lgkmcnt(4)
    buffer_store_dwordx4 v[36:39], v90, s[32:35], s6 offen offset:2048 sc1
    s_mov_b32 s52, 0xd000
    buffer_load_dwordx4 a[128:131], v6, s[32:35], s52 offen offset:0 sc1
    s_waitcnt lgkmcnt(2)
    buffer_store_dwordx4 v[40:43], v90, s[32:35], s6 offen offset:3072 sc1
    s_waitcnt lgkmcnt(0)
    buffer_store_dwordx4 v[44:47], v90, s[32:35], s7 offen offset:0 sc1
SCB_e39:
PAD_132:
    s_cbranch_execz PAD_133
    ds_read_b64_tr_b16 v[48:49], v91 offset:320
    ds_read_b64_tr_b16 v[50:51], v91 offset:5696
    buffer_load_dwordx4 a[132:135], v6, s[32:35], s52 offen offset:1024 sc1
    ds_read_b64_tr_b16 v[52:53], v91 offset:328
    ds_read_b64_tr_b16 v[54:55], v91 offset:5704
    ds_read_b64_tr_b16 v[56:57], v91 offset:384
    ds_read_b64_tr_b16 v[58:59], v91 offset:5760
    buffer_load_dwordx4 a[136:139], v6, s[32:35], s52 offen offset:2048 sc1
    ds_read_b64_tr_b16 v[60:61], v91 offset:392
    ds_read_b64_tr_b16 v[62:63], v91 offset:5768
    ds_read_b64_tr_b16 v[64:65], v92 offset:448
    ds_read_b64_tr_b16 v[66:67], v92 offset:5824
    buffer_load_dwordx4 a[140:143], v6, s[32:35], s52 offen offset:3072 sc1
    s_add_u32 s6, s5, 0x9d8000
    s_add_u32 s7, s6, 4096
    s_waitcnt lgkmcnt(8)
    buffer_store_dwordx4 v[48:51], v90, s[32:35], s6 offen offset:0 sc1
    s_waitcnt lgkmcnt(6)
    buffer_store_dwordx4 v[52:55], v90, s[32:35], s6 offen offset:1024 sc1
    s_waitcnt lgkmcnt(4)
    buffer_store_dwordx4 v[56:59], v90, s[32:35], s6 offen offset:2048 sc1
    s_waitcnt lgkmcnt(2)
    buffer_store_dwordx4 v[60:63], v90, s[32:35], s6 offen offset:3072 sc1
    s_waitcnt lgkmcnt(0)
    buffer_store_dwordx4 v[64:67], v90, s[32:35], s7 offen offset:0 sc1
    ds_read_b64_tr_b16 v[68:69], v91 offset:480
    ds_read_b64_tr_b16 v[70:71], v91 offset:5856
    ds_read_b64_tr_b16 v[72:73], v91 offset:488
    ds_read_b64_tr_b16 v[74:75], v91 offset:5864
    ds_read_b64_tr_b16 v[76:77], v91 offset:544
    ds_read_b64_tr_b16 v[78:79], v91 offset:5920
    ds_read_b64_tr_b16 v[80:81], v91 offset:552
    ds_read_b64_tr_b16 v[82:83], v91 offset:5928
    ds_read_b64_tr_b16 v[84:85], v92 offset:608
PAD_133:
    s_cbranch_execz PAD_134
    ds_read_b64_tr_b16 v[86:87], v92 offset:5984
    s_add_u32 s6, s5, 0xa1e000
    s_add_u32 s7, s6, 4096
    s_waitcnt lgkmcnt(8)
    buffer_store_dwordx4 v[68:71], v90, s[32:35], s6 offen offset:0 sc1
    s_waitcnt lgkmcnt(6)
    buffer_store_dwordx4 v[72:75], v90, s[32:35], s6 offen offset:1024 sc1
    s_waitcnt lgkmcnt(4)
    buffer_store_dwordx4 v[76:79], v90, s[32:35], s6 offen offset:2048 sc1
    s_waitcnt lgkmcnt(2)
    buffer_store_dwordx4 v[80:83], v90, s[32:35], s6 offen offset:3072 sc1
    s_waitcnt lgkmcnt(0)
    buffer_store_dwordx4 v[84:87], v90, s[32:35], s7 offen offset:0 sc1
    s_branch prep_36
prep_35:
    s_mov_b32 s52, 0xa000
    buffer_load_dwordx4 a[80:83], v6, s[32:35], s52 offen offset:0 sc1
    s_sleep 1
    buffer_load_dwordx4 a[84:87], v6, s[32:35], s52 offen offset:1024 sc1
    s_sleep 1
    buffer_load_dwordx4 a[88:91], v6, s[32:35], s52 offen offset:2048 sc1
    s_sleep 1
    buffer_load_dwordx4 a[92:95], v6, s[32:35], s52 offen offset:3072 sc1
    s_sleep 1
    s_mov_b32 s52, 0xb000
    buffer_load_dwordx4 a[96:99], v6, s[32:35], s52 offen offset:0 sc1
    s_sleep 1
    buffer_load_dwordx4 a[100:103], v6, s[32:35], s52 offen offset:1024 sc1
    s_sleep 1
    buffer_load_dwordx4 a[104:107], v6, s[32:35], s52 offen offset:2048 sc1
    s_sleep 1
    buffer_load_dwordx4 a[108:111], v6, s[32:35], s52 offen offset:3072 sc1
    s_sleep 1
    s_mov_b32 s52, 0xc000
    buffer_load_dwordx4 a[112:115], v6, s[32:35], s52 offen offset:0 sc1
    s_sleep 1
    buffer_load_dwordx4 a[116:119], v6, s[32:35], s52 offen offset:1024 sc1
    s_sleep 1
    buffer_load_dwordx4 a[120:123], v6, s[32:35], s52 offen offset:2048 sc1
    s_sleep 1
    buffer_load_dwordx4 a[124:127], v6, s[32:35], s52 offen offset:3072 sc1
PAD_134:
    s_cbranch_execz PAD_135
    s_sleep 1
    s_mov_b32 s52, 0xd000
    buffer_load_dwordx4 a[128:131], v6, s[32:35], s52 offen offset:0 sc1
    s_sleep 1
    buffer_load_dwordx4 a[132:135], v6, s[32:35], s52 offen offset:1024 sc1
    s_sleep 1
    buffer_load_dwordx4 a[136:139], v6, s[32:35], s52 offen offset:2048 sc1
    s_sleep 1
    buffer_load_dwordx4 a[140:143], v6, s[32:35], s52 offen offset:3072 sc1
    s_sleep 1
prep_36:
    s_waitcnt lgkmcnt(0)
    s_cmp_lg_u32 s63, 0
    s_cbranch_scc1 park_37
    s_barrier
park_37:
    s_waitcnt vmcnt(19)
    v_or_b32 v4, v4, v5
    s_nop 0
    v_readfirstlane_b32 s49, v4
    s_nop 3
    s_cmp_lg_u32 s49, 0
    s_cbranch_scc1 flg_retry_39
flg_38:
    s_mov_b32 s48, 0x3000
    s_waitcnt vmcnt(0)
spin_40:
    s_sub_u32 s55, s55, 1
    s_cbranch_scc1 spin_40_out
    buffer_load_dword v192, v7, s[32:35], s48 offen offset:768 sc1
    s_waitcnt vmcnt(0)
    v_and_b32 v192, 1, v192
    v_cmp_ne_u32 vcc, s63, v192
    s_nop 3
    s_cbranch_vccz spin_40_ok
    s_sleep 2
    s_branch spin_40
spin_40_out:
    s_mov_b32 s55, 0
spin_40_ok:
    s_mov_b32 s48, 0x0
    buffer_load_dwordx4 v[192:195], v7, s[32:35], s48 offen offset:0 sc1
    buffer_load_dwordx4 v[196:199], v7, s[32:35], s48 offen offset:256 sc1
    buffer_load_dwordx4 v[200:203], v7, s[32:35], s48 offen offset:512 sc1
    buffer_load_dwordx4 v[204:207], v7, s[32:35], s48 offen offset:768 sc1
    s_mov_b32 s48, 0x1000
    buffer_load_dwordx4 v[208:211], v7, s[32:35], s48 offen offset:0 sc1
    buffer_load_dwordx4 v[212:215], v7, s[32:35], s48 offen offset:256 sc1
    buffer_load_dwordx4 v[216:219], v7, s[32:35], s48 offen offset:512 sc1
    buffer_load_dwordx4 v[220:223], v7, s[32:35], s48 offen offset:768 sc1
    s_mov_b32 s48, 0x2000
PAD_135:
    s_cbranch_execz SCB_ret
    buffer_load_dwordx4 v[224:227], v7, s[32:35], s48 offen offset:0 sc1
    buffer_load_dwordx4 v[228:231], v7, s[32:35], s48 offen offset:256 sc1
    buffer_load_dwordx4 v[232:235], v7, s[32:35], s48 offen offset:512 sc1
    buffer_load_dwordx4 v[236:239], v7, s[32:35], s48 offen offset:768 sc1
    s_mov_b32 s48, 0x3000
    buffer_load_dwordx4 v[240:243], v7, s[32:35], s48 offen offset:0 sc1
    buffer_load_dwordx4 v[244:247], v7, s[32:35], s48 offen offset:256 sc1
    buffer_load_dwordx4 v[248:251], v7, s[32:35], s48 offen offset:512 sc1
    buffer_load_dwordx4 v[252:255], v7, s[32:35], s48 offen offset:768 sc1
G1_end_31:
    s_cmp_eq_u32 s63, 1
    s_cbranch_scc1 L_final
    s_waitcnt vmcnt(13)
    v_bitop3_b32 v4, v192, v196, v200 bitop3:0xfe
    s_waitcnt vmcnt(12)
    v_bitop3_b32 v4, v4, v204, 1 bitop3:0xa8
    v_cmp_ne_u32 vcc, 0, v4
    s_nop 3
    s_cbranch_vccnz G2_retry_42
G2_retry_42_ok:
    v_mfma_f32_16x16x32_bf16 v[8:11], v[112:115], v[192:195], 0
    v_mfma_f32_16x16x32_bf16 v[24:27], v[116:119], v[192:195], 0
    v_mfma_f32_16x16x32_bf16 v[40:43], v[120:123], v[192:195], 0
    v_mfma_f32_16x16x32_bf16 v[56:59], v[124:127], v[192:195], 0
    v_mfma_f32_16x16x32_bf16 v[72:75], v[128:131], v[192:195], 0
    v_mfma_f32_16x16x32_bf16 v[12:15], v[112:115], v[196:199], 0
    v_mfma_f32_16x16x32_bf16 v[28:31], v[116:119], v[196:199], 0
    v_mfma_f32_16x16x32_bf16 v[44:47], v[120:123], v[196:199], 0
    v_mfma_f32_16x16x32_bf16 v[60:63], v[124:127], v[196:199], 0
    v_mfma_f32_16x16x32_bf16 v[76:79], v[128:131], v[196:199], 0
    v_mfma_f32_16x16x32_bf16 v[16:19], v[112:115], v[200:203], 0
    v_mfma_f32_16x16x32_bf16 v[32:35], v[116:119], v[200:203], 0
    v_mfma_f32_16x16x32_bf16 v[48:51], v[120:123], v[200:203], 0
    v_mfma_f32_16x16x32_bf16 v[64:67], v[124:127], v[200:203], 0
    v_mfma_f32_16x16x32_bf16 v[80:83], v[128:131], v[200:203], 0
    v_mfma_f32_16x16x32_bf16 v[20:23], v[112:115], v[204:207], 0
    s_waitcnt vmcnt(9)
    v_bitop3_b32 v4, v208, v212, v216 bitop3:0xfe
SCB_e4:
PAD_136:
    s_cbranch_execz PAD_137
    v_mfma_f32_16x16x32_bf16 v[36:39], v[116:119], v[204:207], 0
    s_waitcnt vmcnt(8)
    v_bitop3_b32 v4, v4, v220, 1 bitop3:0xa8
    v_mfma_f32_16x16x32_bf16 v[52:55], v[120:123], v[204:207], 0
    v_cmp_ne_u32 vcc, 0, v4
    v_mfma_f32_16x16x32_bf16 v[68:71], v[124:127], v[204:207], 0
    v_mfma_f32_16x16x32_bf16 v[84:87], v[128:131], v[204:207], 0
    s_mov_b32 s48, 0x4000
    buffer_load_dwordx4 v[112:115], v7, s[32:35], s48 offen offset:0 sc1
    buffer_load_dwordx4 v[116:119], v7, s[32:35], s48 offen offset:256 sc1
    s_cbranch_vccnz G2_retry_43
G2_retry_43_ok:
    v_mfma_f32_16x16x32_bf16 v[8:11], v[132:135], v[208:211], v[8:11]
    v_mfma_f32_16x16x32_bf16 v[24:27], v[136:139], v[208:211], v[24:27]
    v_mfma_f32_16x16x32_bf16 v[40:43], v[140:143], v[208:211], v[40:43]
    v_mfma_f32_16x16x32_bf16 v[56:59], v[144:147], v[208:211], v[56:59]
    v_mfma_f32_16x16x32_bf16 v[72:75], v[148:151], v[208:211], v[72:75]
    v_mfma_f32_16x16x32_bf16 v[12:15], v[132:135], v[212:215], v[12:15]
    s_mov_b32 s48, 0x4000
    buffer_load_dwordx4 v[120:123], v7, s[32:35], s48 offen offset:512 sc1
    v_mfma_f32_16x16x32_bf16 v[28:31], v[136:139], v[212:215], v[28:31]
    v_mfma_f32_16x16x32_bf16 v[44:47], v[140:143], v[212:215], v[44:47]
    v_mfma_f32_16x16x32_bf16 v[60:63], v[144:147], v[212:215], v[60:63]
    v_mfma_f32_16x16x32_bf16 v[76:79], v[148:151], v[212:215], v[76:79]
    v_mfma_f32_16x16x32_bf16 v[16:19], v[132:135], v[216:219], v[16:19]
    buffer_load_dwordx4 v[124:127], v7, s[32:35], s48 offen offset:768 sc1
    v_mfma_f32_16x16x32_bf16 v[32:35], v[136:139], v[216:219], v[32:35]
    v_mfma_f32_16x16x32_bf16 v[48:51], v[140:143], v[216:219], v[48:51]
    v_mfma_f32_16x16x32_bf16 v[64:67], v[144:147], v[216:219], v[64:67]
    v_mfma_f32_16x16x32_bf16 v[80:83], v[148:151], v[216:219], v[80:83]
    v_mfma_f32_16x16x32_bf16 v[20:23], v[132:135], v[220:223], v[20:23]
    s_waitcnt vmcnt(9)
    v_bitop3_b32 v4, v224, v228, v232 bitop3:0xfe
    v_mfma_f32_16x16x32_bf16 v[36:39], v[136:139], v[220:223], v[36:39]
PAD_137:
    s_cbranch_execz PAD_138
    s_waitcnt vmcnt(8)
    v_bitop3_b32 v4, v4, v236, 1 bitop3:0xa8
    s_mov_b32 s48, 0x5000
    buffer_load_dwordx4 v[192:195], v7, s[32:35], s48 offen offset:0 sc1
    v_mfma_f32_16x16x32_bf16 v[52:55], v[140:143], v[220:223], v[52:55]
    v_cmp_ne_u32 vcc, 0, v4
    v_mfma_f32_16x16x32_bf16 v[68:71], v[144:147], v[220:223], v[68:71]
    v_mfma_f32_16x16x32_bf16 v[84:87], v[148:151], v[220:223], v[84:87]
    s_nop 1
    s_cbranch_vccnz G2_retry_44
G2_retry_44_ok:
    v_mfma_f32_16x16x32_bf16 v[8:11], v[152:155], v[224:227], v[8:11]
    v_mfma_f32_16x16x32_bf16 v[24:27], v[156:159], v[224:227], v[24:27]
    s_mov_b32 s48, 0x5000
    buffer_load_dwordx4 v[196:199], v7, s[32:35], s48 offen offset:256 sc1
    v_mfma_f32_16x16x32_bf16 v[40:43], v[160:163], v[224:227], v[40:43]
    v_mfma_f32_16x16x32_bf16 v[56:59], v[164:167], v[224:227], v[56:59]
    v_mfma_f32_16x16x32_bf16 v[72:75], v[168:171], v[224:227], v[72:75]
    v_mfma_f32_16x16x32_bf16 v[12:15], v[152:155], v[228:231], v[12:15]
    v_mfma_f32_16x16x32_bf16 v[28:31], v[156:159], v[228:231], v[28:31]
    v_mfma_f32_16x16x32_bf16 v[44:47], v[160:163], v[228:231], v[44:47]
    buffer_load_dwordx4 v[200:203], v7, s[32:35], s48 offen offset:512 sc1
    v_mfma_f32_16x16x32_bf16 v[60:63], v[164:167], v[228:231], v[60:63]
    v_mfma_f32_16x16x32_bf16 v[76:79], v[168:171], v[228:231], v[76:79]
    v_mfma_f32_16x16x32_bf16 v[16:19], v[152:155], v[232:235], v[16:19]
    v_mfma_f32_16x16x32_bf16 v[32:35], v[156:159], v[232:235], v[32:35]
    v_mfma_f32_16x16x32_bf16 v[48:51], v[160:163], v[232:235], v[48:51]
    buffer_load_dwordx4 v[204:207], v7, s[32:35], s48 offen offset:768 sc1
    v_mfma_f32_16x16x32_bf16 v[64:67], v[164:167], v[232:235], v[64:67]
    v_mfma_f32_16x16x32_bf16 v[80:83], v[168:171], v[232:235], v[80:83]
    v_mfma_f32_16x16x32_bf16 v[20:23], v[152:155], v[236:239], v[20:23]
    s_waitcnt vmcnt(9)
    v_bitop3_b32 v4, v240, v244, v248 bitop3:0xfe
    v_mfma_f32_16x16x32_bf16 v[36:39], v[156:159], v[236:239], v[36:39]
    s_waitcnt vmcnt(8)
    v_bitop3_b32 v4, v4, v252, 1 bitop3:0xa8
PAD_138:
    s_cbranch_execz PAD_139
    v_mfma_f32_16x16x32_bf16 v[52:55], v[160:163], v[236:239], v[52:55]
    v_cmp_ne_u32 vcc, 0, v4
    s_mov_b32 s48, 0x6000
    buffer_load_dwordx4 v[128:131], v7, s[32:35], s48 offen offset:0 sc1
    v_mfma_f32_16x16x32_bf16 v[68:71], v[164:167], v[236:239], v[68:71]
    v_mfma_f32_16x16x32_bf16 v[84:87], v[168:171], v[236:239], v[84:87]
    s_cbranch_vccnz G2_retry_45
G2_retry_45_ok:
    v_mfma_f32_16x16x32_bf16 v[8:11], v[172:175], v[240:243], v[8:11]
    v_mfma_f32_16x16x32_bf16 v[24:27], v[176:179], v[240:243], v[24:27]
    v_mfma_f32_16x16x32_bf16 v[40:43], v[180:183], v[240:243], v[40:43]
    v_mfma_f32_16x16x32_bf16 v[56:59], v[184:187], v[240:243], v[56:59]
    s_mov_b32 s48, 0x6000
    buffer_load_dwordx4 v[132:135], v7, s[32:35], s48 offen offset:256 sc1
    v_mfma_f32_16x16x32_bf16 v[72:75], v[188:191], v[240:243], v[72:75]
    v_mfma_f32_16x16x32_bf16 v[12:15], v[172:175], v[244:247], v[12:15]
    v_mfma_f32_16x16x32_bf16 v[28:31], v[176:179], v[244:247], v[28:31]
    v_mfma_f32_16x16x32_bf16 v[44:47], v[180:183], v[244:247], v[44:47]
    v_mfma_f32_16x16x32_bf16 v[60:63], v[184:187], v[244:247], v[60:63]
    buffer_load_dwordx4 v[136:139], v7, s[32:35], s48 offen offset:512 sc1
    v_mfma_f32_16x16x32_bf16 v[76:79], v[188:191], v[244:247], v[76:79]
    v_mfma_f32_16x16x32_bf16 v[16:19], v[172:175], v[248:251], v[16:19]
    v_mfma_f32_16x16x32_bf16 v[32:35], v[176:179], v[248:251], v[32:35]
    v_mfma_f32_16x16x32_bf16 v[48:51], v[180:183], v[248:251], v[48:51]
    v_mfma_f32_16x16x32_bf16 v[64:67], v[184:187], v[248:251], v[64:67]
    v_mfma_f32_16x16x32_bf16 v[80:83], v[188:191], v[248:251], v[80:83]
    buffer_load_dwordx4 v[140:143], v7, s[32:35], s48 offen offset:768 sc1
    v_mfma_f32_16x16x32_bf16 v[20:23], v[172:175], v[252:255], v[20:23]
    s_waitcnt vmcnt(9)
    v_bitop3_b32 v4, v112, v116, v120 bitop3:0xfe
    v_mfma_f32_16x16x32_bf16 v[36:39], v[176:179], v[252:255], v[36:39]
    s_waitcnt vmcnt(8)
    v_bitop3_b32 v4, v4, v124, 1 bitop3:0xa8
    v_mfma_f32_16x16x32_bf16 v[52:55], v[180:183], v[252:255], v[52:55]
PAD_139:
    s_cbranch_execz SCB_ret
    v_cmp_ne_u32 vcc, 0, v4
    v_mfma_f32_16x16x32_bf16 v[68:71], v[184:187], v[252:255], v[68:71]
    v_mfma_f32_16x16x32_bf16 v[84:87], v[188:191], v[252:255], v[84:87]
    s_mov_b32 s48, 0x7000
    buffer_load_dwordx4 v[208:211], v7, s[32:35], s48 offen offset:0 sc1
    s_cbranch_vccnz G2_retry_46
G2_retry_46_ok:
    v_mfma_f32_16x16x32_bf16 v[8:11], a[0:3], v[112:115], v[8:11]
    v_mfma_f32_16x16x32_bf16 v[24:27], a[4:7], v[112:115], v[24:27]
    v_mfma_f32_16x16x32_bf16 v[40:43], a[8:11], v[112:115], v[40:43]
    v_mfma_f32_16x16x32_bf16 v[56:59], a[12:15], v[112:115], v[56:59]
    v_mfma_f32_16x16x32_bf16 v[72:75], a[16:19], v[112:115], v[72:75]
    s_mov_b32 s48, 0x7000
    buffer_load_dwordx4 v[212:215], v7, s[32:35], s48 offen offset:256 sc1
    v_mfma_f32_16x16x32_bf16 v[12:15], a[0:3], v[116:119], v[12:15]
    v_mfma_f32_16x16x32_bf16 v[28:31], a[4:7], v[116:119], v[28:31]
    v_mfma_f32_16x16x32_bf16 v[44:47], a[8:11], v[116:119], v[44:47]
    v_mfma_f32_16x16x32_bf16 v[60:63], a[12:15], v[116:119], v[60:63]
    v_mfma_f32_16x16x32_bf16 v[76:79], a[16:19], v[116:119], v[76:79]
    v_mfma_f32_16x16x32_bf16 v[16:19], a[0:3], v[120:123], v[16:19]
    buffer_load_dwordx4 v[216:219], v7, s[32:35], s48 offen offset:512 sc1
    v_mfma_f32_16x16x32_bf16 v[32:35], a[4:7], v[120:123], v[32:35]
    v_mfma_f32_16x16x32_bf16 v[48:51], a[8:11], v[120:123], v[48:51]
    v_mfma_f32_16x16x32_bf16 v[64:67], a[12:15], v[120:123], v[64:67]
    v_mfma_f32_16x16x32_bf16 v[80:83], a[16:19], v[120:123], v[80:83]
    v_mfma_f32_16x16x32_bf16 v[20:23], a[0:3], v[124:127], v[20:23]
    s_waitcnt vmcnt(8)
    v_bitop3_b32 v4, v192, v196, v200 bitop3:0xfe
    buffer_load_dwordx4 v[220:223], v7, s[32:35], s48 offen offset:768 sc1
    v_mfma_f32_16x16x32_bf16 v[36:39], a[4:7], v[124:127], v[36:39]
    s_waitcnt vmcnt(8)
    v_bitop3_b32 v4, v4, v204, 1 bitop3:0xa8
    v_mfma_f32_16x16x32_bf16 v[52:55], a[8:11], v[124:127], v[52:55]
    v_cmp_ne_u32 vcc, 0, v4
    v_mfma_f32_16x16x32_bf16 v[68:71], a[12:15], v[124:127], v[68:71]
SCB_e16:
PAD_140:
    s_cbranch_execz PAD_141
    v_mfma_f32_16x16x32_bf16 v[84:87], a[16:19], v[124:127], v[84:87]
    s_nop 1
    s_cbranch_vccnz G2_retry_47
G2_retry_47_ok:
    v_mfma_f32_16x16x32_bf16 v[8:11], a[20:23], v[192:195], v[8:11]
    v_mfma_f32_16x16x32_bf16 v[24:27], a[24:27], v[192:195], v[24:27]
    s_mov_b32 s48, 0x8000
    buffer_load_dwordx4 v[144:147], v7, s[32:35], s48 offen offset:0 sc1
    v_mfma_f32_16x16x32_bf16 v[40:43], a[28:31], v[192:195], v[40:43]
    v_mfma_f32_16x16x32_bf16 v[56:59], a[32:35], v[192:195], v[56:59]
    v_mfma_f32_16x16x32_bf16 v[72:75], a[36:39], v[192:195], v[72:75]
    v_mfma_f32_16x16x32_bf16 v[12:15], a[20:23], v[196:199], v[12:15]
    v_mfma_f32_16x16x32_bf16 v[28:31], a[24:27], v[196:199], v[28:31]
    buffer_load_dwordx4 v[148:151], v7, s[32:35], s48 offen offset:256 sc1
    v_mfma_f32_16x16x32_bf16 v[44:47], a[28:31], v[196:199], v[44:47]
    v_mfma_f32_16x16x32_bf16 v[60:63], a[32:35], v[196:199], v[60:63]
    v_mfma_f32_16x16x32_bf16 v[76:79], a[36:39], v[196:199], v[76:79]
    v_mfma_f32_16x16x32_bf16 v[16:19], a[20:23], v[200:203], v[16:19]
    v_mfma_f32_16x16x32_bf16 v[32:35], a[24:27], v[200:203], v[32:35]
    buffer_load_dwordx4 v[152:155], v7, s[32:35], s48 offen offset:512 sc1
    v_mfma_f32_16x16x32_bf16 v[48:51], a[28:31], v[200:203], v[48:51]
    v_mfma_f32_16x16x32_bf16 v[64:67], a[32:35], v[200:203], v[64:67]
    v_mfma_f32_16x16x32_bf16 v[80:83], a[36:39], v[200:203], v[80:83]
    v_mfma_f32_16x16x32_bf16 v[20:23], a[20:23], v[204:207], v[20:23]
    s_waitcnt vmcnt(8)
    v_bitop3_b32 v4, v128, v132, v136 bitop3:0xfe
    v_mfma_f32_16x16x32_bf16 v[36:39], a[24:27], v[204:207], v[36:39]
    s_waitcnt vmcnt(7)
    v_bitop3_b32 v4, v4, v140, 1 bitop3:0xa8
    v_mfma_f32_16x16x32_bf16 v[52:55], a[28:31], v[204:207], v[52:55]
    v_cmp_ne_u32 vcc, 0, v4
    buffer_load_dwordx4 v[156:159], v7, s[32:35], s48 offen offset:768 sc1
    v_mfma_f32_16x16x32_bf16 v[68:71], a[32:35], v[204:207], v[68:71]
    v_mfma_f32_16x16x32_bf16 v[84:87], a[36:39], v[204:207], v[84:87]
    s_nop 0
    s_cbranch_vccnz G2_retry_48
G2_retry_48_ok:
PAD_141:
    s_cbranch_execz PAD_142
    v_mfma_f32_16x16x32_bf16 v[8:11], a[40:43], v[128:131], v[8:11]
    v_mfma_f32_16x16x32_bf16 v[24:27], a[44:47], v[128:131], v[24:27]
    v_mfma_f32_16x16x32_bf16 v[40:43], a[48:51], v[128:131], v[40:43]
    s_mov_b32 s48, 0x9000
    buffer_load_dwordx4 v[224:227], v7, s[32:35], s48 offen offset:0 sc1
    v_mfma_f32_16x16x32_bf16 v[56:59], a[52:55], v[128:131], v[56:59]
    v_mfma_f32_16x16x32_bf16 v[72:75], a[56:59], v[128:131], v[72:75]
    v_mfma_f32_16x16x32_bf16 v[12:15], a[40:43], v[132:135], v[12:15]
    v_mfma_f32_16x16x32_bf16 v[28:31], a[44:47], v[132:135], v[28:31]
    v_mfma_f32_16x16x32_bf16 v[44:47], a[48:51], v[132:135], v[44:47]
    v_mfma_f32_16x16x32_bf16 v[60:63], a[52:55], v[132:135], v[60:63]
    buffer_load_dwordx4 v[228:231], v7, s[32:35], s48 offen offset:256 sc1
    v_mfma_f32_16x16x32_bf16 v[76:79], a[56:59], v[132:135], v[76:79]
    v_mfma_f32_16x16x32_bf16 v[16:19], a[40:43], v[136:139], v[16:19]
    v_mfma_f32_16x16x32_bf16 v[32:35], a[44:47], v[136:139], v[32:35]
    v_mfma_f32_16x16x32_bf16 v[48:51], a[48:51], v[136:139], v[48:51]
    v_mfma_f32_16x16x32_bf16 v[64:67], a[52:55], v[136:139], v[64:67]
    buffer_load_dwordx4 v[232:235], v7, s[32:35], s48 offen offset:512 sc1
    v_mfma_f32_16x16x32_bf16 v[80:83], a[56:59], v[136:139], v[80:83]
    v_mfma_f32_16x16x32_bf16 v[20:23], a[40:43], v[140:143], v[20:23]
    s_waitcnt vmcnt(8)
    v_bitop3_b32 v4, v208, v212, v216 bitop3:0xfe
    v_mfma_f32_16x16x32_bf16 v[36:39], a[44:47], v[140:143], v[36:39]
    s_waitcnt vmcnt(7)
    v_bitop3_b32 v4, v4, v220, 1 bitop3:0xa8
    v_mfma_f32_16x16x32_bf16 v[52:55], a[48:51], v[140:143], v[52:55]
    v_cmp_ne_u32 vcc, 0, v4
    v_mfma_f32_16x16x32_bf16 v[68:71], a[52:55], v[140:143], v[68:71]
    v_mfma_f32_16x16x32_bf16 v[84:87], a[56:59], v[140:143], v[84:87]
    buffer_load_dwordx4 v[236:239], v7, s[32:35], s48 offen offset:768 sc1
    s_nop 0
    s_cbranch_vccnz G2_retry_49
G2_retry_49_ok:
    v_mfma_f32_16x16x32_bf16 v[8:11], a[60:63], v[208:211], v[8:11]
    v_mfma_f32_16x16x32_bf16 v[24:27], a[64:67], v[208:211], v[24:27]
PAD_142:
    s_cbranch_execz PAD_143
    v_mfma_f32_16x16x32_bf16 v[40:43], a[68:71], v[208:211], v[40:43]
    v_mfma_f32_16x16x32_bf16 v[56:59], a[72:75], v[208:211], v[56:59]
    v_mfma_f32_16x16x32_bf16 v[72:75], a[76:79], v[208:211], v[72:75]
    s_mov_b32 s48, 0xa000
    buffer_load_dwordx4 v[160:163], v7, s[32:35], s48 offen offset:0 sc1
    v_mfma_f32_16x16x32_bf16 v[12:15], a[60:63], v[212:215], v[12:15]
    v_mfma_f32_16x16x32_bf16 v[28:31], a[64:67], v[212:215], v[28:31]
    v_mfma_f32_16x16x32_bf16 v[44:47], a[68:71], v[212:215], v[44:47]
    v_mfma_f32_16x16x32_bf16 v[60:63], a[72:75], v[212:215], v[60:63]
    v_mfma_f32_16x16x32_bf16 v[76:79], a[76:79], v[212:215], v[76:79]
    buffer_load_dwordx4 v[164:167], v7, s[32:35], s48 offen offset:256 sc1
    v_mfma_f32_16x16x32_bf16 v[16:19], a[60:63], v[216:219], v[16:19]
    v_mfma_f32_16x16x32_bf16 v[32:35], a[64:67], v[216:219], v[32:35]
    v_mfma_f32_16x16x32_bf16 v[48:51], a[68:71], v[216:219], v[48:51]
    v_mfma_f32_16x16x32_bf16 v[64:67], a[72:75], v[216:219], v[64:67]
    v_mfma_f32_16x16x32_bf16 v[80:83], a[76:79], v[216:219], v[80:83]
    v_mfma_f32_16x16x32_bf16 v[20:23], a[60:63], v[220:223], v[20:23]
    s_waitcnt vmcnt(7)
    v_bitop3_b32 v4, v144, v148, v152 bitop3:0xfe
    buffer_load_dwordx4 v[168:171], v7, s[32:35], s48 offen offset:512 sc1
    v_mfma_f32_16x16x32_bf16 v[36:39], a[64:67], v[220:223], v[36:39]
    s_waitcnt vmcnt(7)
    v_bitop3_b32 v4, v4, v156, 1 bitop3:0xa8
    v_mfma_f32_16x16x32_bf16 v[52:55], a[68:71], v[220:223], v[52:55]
    v_cmp_ne_u32 vcc, 0, v4
    v_mfma_f32_16x16x32_bf16 v[68:71], a[72:75], v[220:223], v[68:71]
    v_mfma_f32_16x16x32_bf16 v[84:87], a[76:79], v[220:223], v[84:87]
    s_nop 1
    s_cbranch_vccnz G2_retry_50
G2_retry_50_ok:
    v_mfma_f32_16x16x32_bf16 v[8:11], a[80:83], v[144:147], v[8:11]
    s_mov_b32 s48, 0xa000
    buffer_load_dwordx4 v[172:175], v7, s[32:35], s48 offen offset:768 sc1
    v_mfma_f32_16x16x32_bf16 v[24:27], a[84:87], v[144:147], v[24:27]
    v_mfma_f32_16x16x32_bf16 v[40:43], a[88:91], v[144:147], v[40:43]
PAD_143:
    s_cbranch_execz SCB_ret
    v_mfma_f32_16x16x32_bf16 v[56:59], a[92:95], v[144:147], v[56:59]
    v_mfma_f32_16x16x32_bf16 v[72:75], a[96:99], v[144:147], v[72:75]
    v_mfma_f32_16x16x32_bf16 v[12:15], a[80:83], v[148:151], v[12:15]
    v_mfma_f32_16x16x32_bf16 v[28:31], a[84:87], v[148:151], v[28:31]
    s_mov_b32 s52, 0xe000
    buffer_load_dwordx4 a[0:3], v6, s[32:35], s52 offen offset:0 sc1
    v_mfma_f32_16x16x32_bf16 v[44:47], a[88:91], v[148:151], v[44:47]
    v_mfma_f32_16x16x32_bf16 v[60:63], a[92:95], v[148:151], v[60:63]
    v_mfma_f32_16x16x32_bf16 v[76:79], a[96:99], v[148:151], v[76:79]
    v_mfma_f32_16x16x32_bf16 v[16:19], a[80:83], v[152:155], v[16:19]
    v_mfma_f32_16x16x32_bf16 v[32:35], a[84:87], v[152:155], v[32:35]
    buffer_load_dwordx4 a[4:7], v6, s[32:35], s52 offen offset:1024 sc1
    v_mfma_f32_16x16x32_bf16 v[48:51], a[88:91], v[152:155], v[48:51]
    v_mfma_f32_16x16x32_bf16 v[64:67], a[92:95], v[152:155], v[64:67]
    v_mfma_f32_16x16x32_bf16 v[80:83], a[96:99], v[152:155], v[80:83]
    v_mfma_f32_16x16x32_bf16 v[20:23], a[80:83], v[156:159], v[20:23]
    s_waitcnt vmcnt(7)
    v_bitop3_b32 v4, v224, v228, v232 bitop3:0xfe
    v_mfma_f32_16x16x32_bf16 v[36:39], a[84:87], v[156:159], v[36:39]
    s_waitcnt vmcnt(6)
    v_bitop3_b32 v4, v4, v236, 1 bitop3:0xa8
    buffer_load_dwordx4 a[8:11], v6, s[32:35], s52 offen offset:2048 sc1
    v_mfma_f32_16x16x32_bf16 v[52:55], a[88:91], v[156:159], v[52:55]
    v_cmp_ne_u32 vcc, 0, v4
    v_mfma_f32_16x16x32_bf16 v[68:71], a[92:95], v[156:159], v[68:71]
    v_mfma_f32_16x16x32_bf16 v[84:87], a[96:99], v[156:159], v[84:87]
    s_nop 1
    s_cbranch_vccnz G2_retry_51
G2_retry_51_ok:
    v_mfma_f32_16x16x32_bf16 v[8:11], a[100:103], v[224:227], v[8:11]
    v_mfma_f32_16x16x32_bf16 v[24:27], a[104:107], v[224:227], v[24:27]
    v_mfma_f32_16x16x32_bf16 v[40:43], a[108:111], v[224:227], v[40:43]
    s_mov_b32 s52, 0xe000
    buffer_load_dwordx4 a[12:15], v6, s[32:35], s52 offen offset:3072 sc1
    v_mfma_f32_16x16x32_bf16 v[56:59], a[112:115], v[224:227], v[56:59]
SCB_e28:
PAD_144:
    s_cbranch_execz PAD_145
    v_mfma_f32_16x16x32_bf16 v[72:75], a[116:119], v[224:227], v[72:75]
    v_mfma_f32_16x16x32_bf16 v[12:15], a[100:103], v[228:231], v[12:15]
    v_mfma_f32_16x16x32_bf16 v[28:31], a[104:107], v[228:231], v[28:31]
    v_mfma_f32_16x16x32_bf16 v[44:47], a[108:111], v[228:231], v[44:47]
    s_mov_b32 s48, 0xb000
    buffer_load_dwordx4 v[176:179], v7, s[32:35], s48 offen offset:0 sc1
    v_mfma_f32_16x16x32_bf16 v[60:63], a[112:115], v[228:231], v[60:63]
    v_mfma_f32_16x16x32_bf16 v[76:79], a[116:119], v[228:231], v[76:79]
    buffer_load_dwordx4 v[180:183], v7, s[32:35], s48 offen offset:256 sc1
    buffer_load_dwordx4 v[184:187], v7, s[32:35], s48 offen offset:512 sc1
    buffer_load_dwordx4 v[188:191], v7, s[32:35], s48 offen offset:768 sc1
    v_mfma_f32_16x16x32_bf16 v[16:19], a[100:103], v[232:235], v[16:19]
    v_mfma_f32_16x16x32_bf16 v[32:35], a[104:107], v[232:235], v[32:35]
    v_mfma_f32_16x16x32_bf16 v[48:51], a[108:111], v[232:235], v[48:51]
    v_mfma_f32_16x16x32_bf16 v[64:67], a[112:115], v[232:235], v[64:67]
    v_mfma_f32_16x16x32_bf16 v[80:83], a[116:119], v[232:235], v[80:83]
    v_mfma_f32_16x16x32_bf16 v[20:23], a[100:103], v[236:239], v[20:23]
    s_waitcnt vmcnt(9)
    v_bitop3_b32 v4, v160, v164, v168 bitop3:0xfe
    v_mfma_f32_16x16x32_bf16 v[36:39], a[104:107], v[236:239], v[36:39]
    s_waitcnt vmcnt(8)
    v_bitop3_b32 v4, v4, v172, 1 bitop3:0xa8
    v_mfma_f32_16x16x32_bf16 v[52:55], a[108:111], v[236:239], v[52:55]
    v_cmp_ne_u32 vcc, 0, v4
    v_mfma_f32_16x16x32_bf16 v[68:71], a[112:115], v[236:239], v[68:71]
    v_mfma_f32_16x16x32_bf16 v[84:87], a[116:119], v[236:239], v[84:87]
    s_nop 1
    s_cbranch_vccnz G2_retry_52
G2_retry_52_ok:
    v_mfma_f32_16x16x32_bf16 v[8:11], a[120:123], v[160:163], v[8:11]
    v_mfma_f32_16x16x32_bf16 v[24:27], a[124:127], v[160:163], v[24:27]
    v_mfma_f32_16x16x32_bf16 v[40:43], a[128:131], v[160:163], v[40:43]
    v_mfma_f32_16x16x32_bf16 v[56:59], a[132:135], v[160:163], v[56:59]
    v_mfma_f32_16x16x32_bf16 v[72:75], a[136:139], v[160:163], v[72:75]
    v_mfma_f32_16x16x32_bf16 v[12:15], a[120:123], v[164:167], v[12:15]
PAD_145:
    s_cbranch_execz PAD_146
    v_mfma_f32_16x16x32_bf16 v[28:31], a[124:127], v[164:167], v[28:31]
    v_mfma_f32_16x16x32_bf16 v[44:47], a[128:131], v[164:167], v[44:47]
    v_mfma_f32_16x16x32_bf16 v[60:63], a[132:135], v[164:167], v[60:63]
    v_mfma_f32_16x16x32_bf16 v[76:79], a[136:139], v[164:167], v[76:79]
    s_mov_b32 s52, 0xf000
    buffer_load_dwordx4 a[16:19], v6, s[32:35], s52 offen offset:0 sc1
    buffer_load_dwordx4 a[20:23], v6, s[32:35], s52 offen offset:1024 sc1
    buffer_load_dwordx4 a[24:27], v6, s[32:35], s52 offen offset:2048 sc1
    buffer_load_dwordx4 a[28:31], v6, s[32:35], s52 offen offset:3072 sc1
    s_mov_b32 s52, 0x10000
    buffer_load_dwordx4 a[32:35], v6, s[32:35], s52 offen offset:0 sc1
    s_mov_b32 s48, 0xc000
    buffer_load_dwordx4 v[240:243], v7, s[32:35], s48 offen offset:0 sc1
    buffer_load_dwordx4 v[244:247], v7, s[32:35], s48 offen offset:256 sc1
    buffer_load_dwordx4 v[248:251], v7, s[32:35], s48 offen offset:512 sc1
    buffer_load_dwordx4 v[252:255], v7, s[32:35], s48 offen offset:768 sc1
    v_mfma_f32_16x16x32_bf16 v[16:19], a[120:123], v[168:171], v[16:19]
    v_mfma_f32_16x16x32_bf16 v[32:35], a[124:127], v[168:171], v[32:35]
    v_mfma_f32_16x16x32_bf16 v[48:51], a[128:131], v[168:171], v[48:51]
    v_mfma_f32_16x16x32_bf16 v[64:67], a[132:135], v[168:171], v[64:67]
    v_mfma_f32_16x16x32_bf16 v[80:83], a[136:139], v[168:171], v[80:83]
    v_mfma_f32_16x16x32_bf16 v[20:23], a[120:123], v[172:175], v[20:23]
    s_waitcnt vmcnt(10)
    v_bitop3_b32 v4, v176, v180, v184 bitop3:0xfe
    v_mfma_f32_16x16x32_bf16 v[36:39], a[124:127], v[172:175], v[36:39]
    s_waitcnt vmcnt(9)
    v_bitop3_b32 v4, v4, v188, 1 bitop3:0xa8
    v_mfma_f32_16x16x32_bf16 v[52:55], a[128:131], v[172:175], v[52:55]
    v_cmp_ne_u32 vcc, 0, v4
    v_mfma_f32_16x16x32_bf16 v[68:71], a[132:135], v[172:175], v[68:71]
    v_mfma_f32_16x16x32_bf16 v[84:87], a[136:139], v[172:175], v[84:87]
    s_nop 1
    s_cbranch_vccnz G2_retry_53
G2_retry_53_ok:
    v_mfma_f32_16x16x32_bf16 v[8:11], a[140:143], v[176:179], v[8:11]
PAD_146:
    s_cbranch_execz SCB_ret
    v_mfma_f32_16x16x32_bf16 v[24:27], a[0:3], v[176:179], v[24:27]
    v_mfma_f32_16x16x32_bf16 v[40:43], a[4:7], v[176:179], v[40:43]
    v_mfma_f32_16x16x32_bf16 v[56:59], a[8:11], v[176:179], v[56:59]
    v_mfma_f32_16x16x32_bf16 v[72:75], a[12:15], v[176:179], v[72:75]
    v_mfma_f32_16x16x32_bf16 v[12:15], a[140:143], v[180:183], v[12:15]
    v_mfma_f32_16x16x32_bf16 v[28:31], a[0:3], v[180:183], v[28:31]
    v_mfma_f32_16x16x32_bf16 v[44:47], a[4:7], v[180:183], v[44:47]
    v_mfma_f32_16x16x32_bf16 v[60:63], a[8:11], v[180:183], v[60:63]
    v_mfma_f32_16x16x32_bf16 v[76:79], a[12:15], v[180:183], v[76:79]
    s_mov_b32 s52, 0x10000
    buffer_load_dwordx4 a[36:39], v6, s[32:35], s52 offen offset:1024 sc1
    buffer_load_dwordx4 a[40:43], v6, s[32:35], s52 offen offset:2048 sc1
    buffer_load_dwordx4 a[44:47], v6, s[32:35], s52 offen offset:3072 sc1
    s_mov_b32 s52, 0x11000
    buffer_load_dwordx4 a[48:51], v6, s[32:35], s52 offen offset:0 sc1
    buffer_load_dwordx4 a[52:55], v6, s[32:35], s52 offen offset:1024 sc1
    s_mov_b32 s48, 0xd000
    buffer_load_dwordx4 v[112:115], v7, s[32:35], s48 offen offset:0 sc1
    buffer_load_dwordx4 v[116:119], v7, s[32:35], s48 offen offset:256 sc1
    buffer_load_dwordx4 v[120:123], v7, s[32:35], s48 offen offset:512 sc1
    buffer_load_dwordx4 v[124:127], v7, s[32:35], s48 offen offset:768 sc1
    v_mfma_f32_16x16x32_bf16 v[16:19], a[140:143], v[184:187], v[16:19]
    v_lshrrev_b32 v4, 4, v1
    v_lshlrev_b32 v4, 4, v4
    s_mul_i32 s48, s28, 320
    s_add_u32 s48, s48, 0xb7e000
    buffer_load_dwordx4 v[88:91], v4, s[32:35], s48 offen offset:0 sc1
    buffer_load_dwordx4 v[92:95], v4, s[32:35], s48 offen offset:64 sc1
    buffer_load_dwordx4 v[96:99], v4, s[32:35], s48 offen offset:128 sc1
    buffer_load_dwordx4 v[100:103], v4, s[32:35], s48 offen offset:192 sc1
    buffer_load_dwordx4 v[104:107], v4, s[32:35], s48 offen offset:256 sc1
    v_mfma_f32_16x16x32_bf16 v[32:35], a[0:3], v[184:187], v[32:35]
    v_mfma_f32_16x16x32_bf16 v[48:51], a[4:7], v[184:187], v[48:51]
SCB_e40:
PAD_147:
    s_cbranch_execz PAD_148
    v_mfma_f32_16x16x32_bf16 v[64:67], a[8:11], v[184:187], v[64:67]
    v_mfma_f32_16x16x32_bf16 v[80:83], a[12:15], v[184:187], v[80:83]
    v_mfma_f32_16x16x32_bf16 v[20:23], a[140:143], v[188:191], v[20:23]
    s_waitcnt vmcnt(15)
    v_bitop3_b32 v4, v240, v244, v248 bitop3:0xfe
    v_mfma_f32_16x16x32_bf16 v[36:39], a[0:3], v[188:191], v[36:39]
    s_waitcnt vmcnt(14)
    v_bitop3_b32 v4, v4, v252, 1 bitop3:0xa8
    v_mfma_f32_16x16x32_bf16 v[52:55], a[4:7], v[188:191], v[52:55]
    v_cmp_ne_u32 vcc, 0, v4
    v_mfma_f32_16x16x32_bf16 v[68:71], a[8:11], v[188:191], v[68:71]
    v_mfma_f32_16x16x32_bf16 v[84:87], a[12:15], v[188:191], v[84:87]
    s_cmp_eq_u32 s26, 3
    s_cbranch_scc1 G2_skip_41
    s_cbranch_vccnz G2_retry_54
G2_retry_54_ok:
    v_mfma_f32_16x16x32_bf16 v[8:11], a[16:19], v[240:243], v[8:11]
    v_mfma_f32_16x16x32_bf16 v[24:27], a[20:23], v[240:243], v[24:27]
    v_mfma_f32_16x16x32_bf16 v[40:43], a[24:27], v[240:243], v[40:43]
    v_mfma_f32_16x16x32_bf16 v[56:59], a[28:31], v[240:243], v[56:59]
    v_mfma_f32_16x16x32_bf16 v[72:75], a[32:35], v[240:243], v[72:75]
    v_mfma_f32_16x16x32_bf16 v[12:15], a[16:19], v[244:247], v[12:15]
    v_mfma_f32_16x16x32_bf16 v[28:31], a[20:23], v[244:247], v[28:31]
    v_mfma_f32_16x16x32_bf16 v[44:47], a[24:27], v[244:247], v[44:47]
    v_mfma_f32_16x16x32_bf16 v[60:63], a[28:31], v[244:247], v[60:63]
    v_mfma_f32_16x16x32_bf16 v[76:79], a[32:35], v[244:247], v[76:79]
    v_mfma_f32_16x16x32_bf16 v[16:19], a[16:19], v[248:251], v[16:19]
    v_mfma_f32_16x16x32_bf16 v[32:35], a[20:23], v[248:251], v[32:35]
    v_mfma_f32_16x16x32_bf16 v[48:51], a[24:27], v[248:251], v[48:51]
    v_mfma_f32_16x16x32_bf16 v[64:67], a[28:31], v[248:251], v[64:67]
    v_mfma_f32_16x16x32_bf16 v[80:83], a[32:35], v[248:251], v[80:83]
    v_mfma_f32_16x16x32_bf16 v[20:23], a[16:19], v[252:255], v[20:23]
    s_waitcnt vmcnt(6)
    v_bitop3_b32 v4, v112, v116, v120 bitop3:0xfe
    v_mfma_f32_16x16x32_bf16 v[36:39], a[20:23], v[252:255], v[36:39]
    s_waitcnt vmcnt(5)
PAD_148:
    s_cbranch_execz PAD_149
    v_bitop3_b32 v4, v4, v124, 1 bitop3:0xa8
    v_mfma_f32_16x16x32_bf16 v[52:55], a[24:27], v[252:255], v[52:55]
    v_cmp_ne_u32 vcc, 0, v4
    v_mfma_f32_16x16x32_bf16 v[68:71], a[28:31], v[252:255], v[68:71]
    v_mfma_f32_16x16x32_bf16 v[84:87], a[32:35], v[252:255], v[84:87]
    s_nop 1
    s_cbranch_vccnz G2_retry_55
G2_retry_55_ok:
G2_skip_41:
    v_add_u32 v108, 81920, v2
    s_cmp_eq_u32 s26, 1
    s_cbranch_scc1 G2_red_57
    s_cmp_eq_u32 s26, 2
    s_cbranch_scc1 G2_red_58
    s_cmp_eq_u32 s26, 3
    s_cbranch_scc1 G2_red_59
G2_red_56:
    v_mfma_f32_16x16x32_bf16 v[56:59], a[48:51], v[112:115], v[56:59]
    v_mfma_f32_16x16x32_bf16 v[72:75], a[52:55], v[112:115], v[72:75]
    v_mfma_f32_16x16x32_bf16 v[12:15], a[36:39], v[116:119], v[12:15]
    v_mfma_f32_16x16x32_bf16 v[28:31], a[40:43], v[116:119], v[28:31]
    v_mfma_f32_16x16x32_bf16 v[44:47], a[44:47], v[116:119], v[44:47]
    s_nop 3
    ds_write_b128 v108, v[56:59] offset:37888
    v_mfma_f32_16x16x32_bf16 v[60:63], a[48:51], v[116:119], v[60:63]
    ds_write_b128 v108, v[72:75] offset:50176
    v_mfma_f32_16x16x32_bf16 v[76:79], a[52:55], v[116:119], v[76:79]
    ds_write_b128 v108, v[12:15] offset:5120
    v_mfma_f32_16x16x32_bf16 v[64:67], a[48:51], v[120:123], v[64:67]
    ds_write_b128 v108, v[28:31] offset:17408
    v_mfma_f32_16x16x32_bf16 v[80:83], a[52:55], v[120:123], v[80:83]
    ds_write_b128 v108, v[44:47] offset:29696
    v_mfma_f32_16x16x32_bf16 v[20:23], a[36:39], v[124:127], v[20:23]
    ds_write_b128 v108, v[60:63] offset:39936
    v_mfma_f32_16x16x32_bf16 v[36:39], a[40:43], v[124:127], v[36:39]
    ds_write_b128 v108, v[76:79] offset:52224
    v_mfma_f32_16x16x32_bf16 v[52:55], a[44:47], v[124:127], v[52:55]
    ds_write_b128 v108, v[64:67] offset:44032
    v_mfma_f32_16x16x32_bf16 v[68:71], a[48:51], v[124:127], v[68:71]
    ds_write_b128 v108, v[80:83] offset:56320
PAD_149:
    s_cbranch_execz PAD_150
    v_mfma_f32_16x16x32_bf16 v[84:87], a[52:55], v[124:127], v[84:87]
    ds_write_b128 v108, v[20:23] offset:11264
    v_mfma_f32_16x16x32_bf16 v[8:11], a[36:39], v[112:115], v[8:11]
    ds_write_b128 v108, v[36:39] offset:23552
    v_mfma_f32_16x16x32_bf16 v[24:27], a[40:43], v[112:115], v[24:27]
    ds_write_b128 v108, v[52:55] offset:35840
    v_mfma_f32_16x16x32_bf16 v[40:43], a[44:47], v[112:115], v[40:43]
    ds_write_b128 v108, v[68:71] offset:46080
    v_mfma_f32_16x16x32_bf16 v[16:19], a[36:39], v[120:123], v[16:19]
    ds_write_b128 v108, v[84:87] offset:58368
    v_mfma_f32_16x16x32_bf16 v[32:35], a[40:43], v[120:123], v[32:35]
    v_mfma_f32_16x16x32_bf16 v[48:51], a[44:47], v[120:123], v[48:51]
    v_lshrrev_b32 v192, 4, v1
    v_and_b32 v193, 15, v1
    v_lshlrev_b32 v110, 4, v193
    v_lshrrev_b32 v195, 1, v192
    v_lshl_add_u32 v195, v195, 10, v110
    v_and_b32 v194, 1, v192
    v_lshl_add_u32 v195, v194, 3, v195
    s_mul_i32 s48, s28, 10240
    v_add_u32 v195, s48, v195
    v_mul_u32_u24 v194, 16640, v192
    v_add_u32 v110, v194, v110
    s_mul_i32 s48, s28, 332800
    s_lshl_b32 s49, s27, 9
    s_add_u32 s48, s48, s49
    v_and_b32 v194, 7, v1
    v_lshlrev_b32 v111, 5, v194
    v_bfe_u32 v194, v1, 3, 1
    v_lshl_add_u32 v111, v194, 3, v111
    v_and_b32 v194, 1, v192
    v_lshl_add_u32 v111, v194, 2, v111
    v_add_u32 v111, 143360, v111
    s_cmp_eq_u32 s28, 0
    s_cselect_b32 s52, 16, 0
    v_cmp_gt_u32 vcc, s52, v1
    v_mov_b32 v194, 0xffff0000
    s_nop 0
    v_cndmask_b32 v109, -1, v194, vcc
    ds_read_b64 v[212:213], v195 offset:0
PAD_150:
    s_cbranch_execz SCB_ret
    ds_read_b64 v[214:215], v195 offset:512
    ds_read_b64 v[216:217], v195 offset:2048
    ds_read_b64 v[218:219], v195 offset:2560
    ds_read_b64 v[220:221], v195 offset:4096
    ds_read_b64 v[222:223], v195 offset:4608
    s_waitcnt vmcnt(4)
    v_pk_add_f32 v[8:9], v[8:9], v[88:89]
    v_pk_add_f32 v[10:11], v[10:11], v[90:91]
    v_pk_add_f32 v[16:17], v[16:17], v[88:89]
    v_pk_add_f32 v[18:19], v[18:19], v[90:91]
    s_waitcnt vmcnt(3)
    v_pk_add_f32 v[24:25], v[24:25], v[92:93]
    v_pk_add_f32 v[26:27], v[26:27], v[94:95]
    v_pk_add_f32 v[32:33], v[32:33], v[92:93]
    v_pk_add_f32 v[34:35], v[34:35], v[94:95]
    s_waitcnt vmcnt(2)
    v_pk_add_f32 v[40:41], v[40:41], v[96:97]
    v_pk_add_f32 v[42:43], v[42:43], v[98:99]
    v_pk_add_f32 v[48:49], v[48:49], v[96:97]
    v_pk_add_f32 v[50:51], v[50:51], v[98:99]
    s_waitcnt lgkmcnt(5)
    v_lshlrev_b32 v208, 16, v212
    v_and_b32 v209, 0xffff0000, v212
    v_pk_add_f32 v[8:9], v[8:9], v[208:209]
    v_lshlrev_b32 v210, 16, v213
    v_and_b32 v211, 0xffff0000, v213
    v_pk_add_f32 v[10:11], v[10:11], v[210:211]
    s_waitcnt lgkmcnt(4)
    v_lshlrev_b32 v208, 16, v214
    v_and_b32 v209, 0xffff0000, v214
    v_pk_add_f32 v[16:17], v[16:17], v[208:209]
    v_lshlrev_b32 v210, 16, v215
    v_and_b32 v211, 0xffff0000, v215
    v_pk_add_f32 v[18:19], v[18:19], v[210:211]
    s_waitcnt lgkmcnt(3)
    v_lshlrev_b32 v208, 16, v216
    v_and_b32 v209, 0xffff0000, v216
SCB_e5:
PAD_151:
    s_cbranch_execz PAD_152
    v_pk_add_f32 v[24:25], v[24:25], v[208:209]
    v_lshlrev_b32 v210, 16, v217
    v_and_b32 v211, 0xffff0000, v217
    v_pk_add_f32 v[26:27], v[26:27], v[210:211]
    s_waitcnt lgkmcnt(2)
    v_lshlrev_b32 v208, 16, v218
    v_and_b32 v209, 0xffff0000, v218
    v_pk_add_f32 v[32:33], v[32:33], v[208:209]
    v_lshlrev_b32 v210, 16, v219
    v_and_b32 v211, 0xffff0000, v219
    v_pk_add_f32 v[34:35], v[34:35], v[210:211]
    s_waitcnt lgkmcnt(1)
    v_lshlrev_b32 v208, 16, v220
    v_and_b32 v209, 0xffff0000, v220
    v_pk_add_f32 v[40:41], v[40:41], v[208:209]
    v_lshlrev_b32 v210, 16, v221
    v_and_b32 v211, 0xffff0000, v221
    v_pk_add_f32 v[42:43], v[42:43], v[210:211]
    s_waitcnt lgkmcnt(0)
    v_lshlrev_b32 v208, 16, v222
    v_and_b32 v209, 0xffff0000, v222
    v_pk_add_f32 v[48:49], v[48:49], v[208:209]
    v_lshlrev_b32 v210, 16, v223
    v_and_b32 v211, 0xffff0000, v223
    v_pk_add_f32 v[50:51], v[50:51], v[210:211]
    s_waitcnt lgkmcnt(0)
    s_barrier
    ds_read_b128 v[12:15], v108 offset:0
    ds_read_b128 v[20:23], v108 offset:1024
    ds_read_b128 v[28:31], v108 offset:2048
    ds_read_b128 v[36:39], v108 offset:6144
    ds_read_b128 v[44:47], v108 offset:7168
    ds_read_b128 v[52:55], v108 offset:8192
    ds_read_b128 v[56:59], v108 offset:12288
    ds_read_b128 v[60:63], v108 offset:13312
    ds_read_b128 v[64:67], v108 offset:14336
    ds_read_b128 v[68:71], v108 offset:18432
PAD_152:
    s_cbranch_execz PAD_153
    ds_read_b128 v[72:75], v108 offset:19456
    ds_read_b128 v[76:79], v108 offset:20480
    ds_read_b128 v[80:83], v108 offset:24576
    ds_read_b128 v[84:87], v108 offset:25600
    ds_read_b128 v[192:195], v108 offset:26624
    ds_read_b128 v[196:199], v108 offset:30720
    ds_read_b128 v[200:203], v108 offset:31744
    ds_read_b128 v[204:207], v108 offset:32768
    s_waitcnt lgkmcnt(15)
    v_pk_add_f32 v[8:9], v[8:9], v[12:13]
    v_pk_add_f32 v[20:21], v[20:21], v[28:29]
    v_pk_add_f32 v[10:11], v[10:11], v[14:15]
    v_pk_add_f32 v[22:23], v[22:23], v[30:31]
    v_pk_add_f32 v[8:9], v[8:9], v[20:21]
    v_pk_add_f32 v[10:11], v[10:11], v[22:23]
    v_add_u32 v8, 0x10000, v8
    v_and_b32 v8, v3, v8
    v_add_u32 v9, 0x10000, v9
    v_and_b32 v9, v3, v9
    v_cvt_pk_bf16_f32 v88, v8, v9
    v_cvt_pk_bf16_f32 v89, v10, v11
    s_waitcnt lgkmcnt(14)
    v_pk_add_f32 v[16:17], v[16:17], v[36:37]
    s_waitcnt lgkmcnt(12)
    v_pk_add_f32 v[44:45], v[44:45], v[52:53]
    v_pk_add_f32 v[18:19], v[18:19], v[38:39]
    v_pk_add_f32 v[46:47], v[46:47], v[54:55]
    v_pk_add_f32 v[16:17], v[16:17], v[44:45]
    v_pk_add_f32 v[18:19], v[18:19], v[46:47]
    v_cvt_pk_bf16_f32 v90, v16, v17
    v_cvt_pk_bf16_f32 v91, v18, v19
    s_add_u32 s50, s48, 0
    buffer_store_dwordx4 v[88:91], v110, s[32:35], s50 offen offset:0 sc1
    s_waitcnt lgkmcnt(11)
    v_pk_add_f32 v[24:25], v[24:25], v[56:57]
PAD_153:
    s_cbranch_execz PAD_154
    s_waitcnt lgkmcnt(9)
    v_pk_add_f32 v[60:61], v[60:61], v[64:65]
    v_pk_add_f32 v[26:27], v[26:27], v[58:59]
    v_pk_add_f32 v[62:63], v[62:63], v[66:67]
    v_pk_add_f32 v[24:25], v[24:25], v[60:61]
    v_pk_add_f32 v[26:27], v[26:27], v[62:63]
    v_add_u32 v24, 0x10000, v24
    v_and_b32 v24, v3, v24
    v_add_u32 v25, 0x10000, v25
    v_and_b32 v25, v3, v25
    v_cvt_pk_bf16_f32 v92, v24, v25
    v_cvt_pk_bf16_f32 v93, v26, v27
    s_waitcnt lgkmcnt(8)
    v_pk_add_f32 v[32:33], v[32:33], v[68:69]
    s_waitcnt lgkmcnt(6)
    v_pk_add_f32 v[72:73], v[72:73], v[76:77]
    v_pk_add_f32 v[34:35], v[34:35], v[70:71]
    v_pk_add_f32 v[74:75], v[74:75], v[78:79]
    v_pk_add_f32 v[32:33], v[32:33], v[72:73]
    v_pk_add_f32 v[34:35], v[34:35], v[74:75]
    v_cvt_pk_bf16_f32 v94, v32, v33
    v_cvt_pk_bf16_f32 v95, v34, v35
    s_add_u32 s50, s48, 66560
    buffer_store_dwordx4 v[92:95], v110, s[32:35], s50 offen offset:0 sc1
    s_waitcnt lgkmcnt(5)
    v_pk_add_f32 v[40:41], v[40:41], v[80:81]
    s_waitcnt lgkmcnt(3)
    v_pk_add_f32 v[84:85], v[84:85], v[192:193]
    v_pk_add_f32 v[42:43], v[42:43], v[82:83]
    v_pk_add_f32 v[86:87], v[86:87], v[194:195]
    v_pk_add_f32 v[40:41], v[40:41], v[84:85]
    v_pk_add_f32 v[42:43], v[42:43], v[86:87]
    v_add_u32 v40, 0x10000, v40
    v_and_b32 v40, v3, v40
    v_add_u32 v41, 0x10000, v41
    v_and_b32 v41, v3, v41
PAD_154:
    s_cbranch_execz SCB_ret
    v_cvt_pk_bf16_f32 v96, v40, v41
    v_cvt_pk_bf16_f32 v97, v42, v43
    s_waitcnt lgkmcnt(2)
    v_pk_add_f32 v[48:49], v[48:49], v[196:197]
    s_waitcnt lgkmcnt(0)
    v_pk_add_f32 v[200:201], v[200:201], v[204:205]
    v_pk_add_f32 v[50:51], v[50:51], v[198:199]
    v_pk_add_f32 v[202:203], v[202:203], v[206:207]
    v_pk_add_f32 v[48:49], v[48:49], v[200:201]
    v_pk_add_f32 v[50:51], v[50:51], v[202:203]
    v_cvt_pk_bf16_f32 v98, v48, v49
    v_cvt_pk_bf16_f32 v99, v50, v51
    s_add_u32 s50, s48, 133120
    buffer_store_dwordx4 v[96:99], v110, s[32:35], s50 offen offset:0 sc1
    v_and_b32 v14, v109, v88
    v_dot2_f32_bf16 v12, v14, v14, 0
    v_dot2_f32_bf16 v12, v89, v89, v12
    v_dot2_f32_bf16 v12, v92, v92, v12
    v_dot2_f32_bf16 v12, v93, v93, v12
    v_dot2_f32_bf16 v12, v96, v96, v12
    v_dot2_f32_bf16 v12, v97, v97, v12
    v_and_b32 v14, v109, v90
    v_dot2_f32_bf16 v13, v14, v14, 0
    v_dot2_f32_bf16 v13, v91, v91, v13
    v_dot2_f32_bf16 v13, v94, v94, v13
    v_dot2_f32_bf16 v13, v95, v95, v13
    v_dot2_f32_bf16 v13, v98, v98, v13
    v_dot2_f32_bf16 v13, v99, v99, v13
    s_nop 2
    v_permlane16_swap_b32 v12, v13
    v_add_f32 v12, v12, v13
    v_mov_b32 v13, v12
    s_nop 1
    v_permlane32_swap_b32 v12, v13
    v_add_f32 v12, v12, v13
    ds_write_b32 v111, v12 offset:0
    s_waitcnt lgkmcnt(0)
    s_barrier
SCB_e17:
PAD_155:
    s_cbranch_execz PAD_156
    s_branch G2_done_60
G2_red_57:
    v_mfma_f32_16x16x32_bf16 v[8:11], a[36:39], v[112:115], v[8:11]
    v_mfma_f32_16x16x32_bf16 v[24:27], a[40:43], v[112:115], v[24:27]
    v_mfma_f32_16x16x32_bf16 v[40:43], a[44:47], v[112:115], v[40:43]
    v_mfma_f32_16x16x32_bf16 v[56:59], a[48:51], v[112:115], v[56:59]
    v_mfma_f32_16x16x32_bf16 v[72:75], a[52:55], v[112:115], v[72:75]
    s_nop 3
    ds_write_b128 v108, v[8:11] offset:0
    v_mfma_f32_16x16x32_bf16 v[60:63], a[48:51], v[116:119], v[60:63]
    ds_write_b128 v108, v[24:27] offset:12288
    v_mfma_f32_16x16x32_bf16 v[76:79], a[52:55], v[116:119], v[76:79]
    ds_write_b128 v108, v[40:43] offset:24576
    v_mfma_f32_16x16x32_bf16 v[16:19], a[36:39], v[120:123], v[16:19]
    ds_write_b128 v108, v[56:59] offset:38912
    v_mfma_f32_16x16x32_bf16 v[32:35], a[40:43], v[120:123], v[32:35]
    ds_write_b128 v108, v[72:75] offset:51200
    v_mfma_f32_16x16x32_bf16 v[48:51], a[44:47], v[120:123], v[48:51]
    ds_write_b128 v108, v[60:63] offset:40960
    v_mfma_f32_16x16x32_bf16 v[64:67], a[48:51], v[120:123], v[64:67]
    ds_write_b128 v108, v[76:79] offset:53248
    v_mfma_f32_16x16x32_bf16 v[80:83], a[52:55], v[120:123], v[80:83]
    ds_write_b128 v108, v[16:19] offset:6144
    v_mfma_f32_16x16x32_bf16 v[68:71], a[48:51], v[124:127], v[68:71]
    ds_write_b128 v108, v[32:35] offset:18432
    v_mfma_f32_16x16x32_bf16 v[84:87], a[52:55], v[124:127], v[84:87]
    ds_write_b128 v108, v[48:51] offset:30720
    v_mfma_f32_16x16x32_bf16 v[12:15], a[36:39], v[116:119], v[12:15]
    ds_write_b128 v108, v[64:67] offset:45056
    v_mfma_f32_16x16x32_bf16 v[28:31], a[40:43], v[116:119], v[28:31]
    ds_write_b128 v108, v[80:83] offset:57344
    v_mfma_f32_16x16x32_bf16 v[44:47], a[44:47], v[116:119], v[44:47]
    ds_write_b128 v108, v[68:71] offset:47104
    v_mfma_f32_16x16x32_bf16 v[20:23], a[36:39], v[124:127], v[20:23]
PAD_156:
    s_cbranch_execz PAD_157
    ds_write_b128 v108, v[84:87] offset:59392
    v_mfma_f32_16x16x32_bf16 v[36:39], a[40:43], v[124:127], v[36:39]
    v_mfma_f32_16x16x32_bf16 v[52:55], a[44:47], v[124:127], v[52:55]
    v_lshrrev_b32 v192, 4, v1
    v_and_b32 v193, 15, v1
    v_lshlrev_b32 v110, 4, v193
    v_lshrrev_b32 v195, 1, v192
    v_lshl_add_u32 v195, v195, 10, v110
    v_and_b32 v194, 1, v192
    v_lshl_add_u32 v195, v194, 3, v195
    s_mul_i32 s48, s28, 10240
    v_add_u32 v195, s48, v195
    v_mul_u32_u24 v194, 16640, v192
    v_add_u32 v110, v194, v110
    s_mul_i32 s48, s28, 332800
    s_lshl_b32 s49, s27, 9
    s_add_u32 s48, s48, s49
    v_and_b32 v194, 7, v1
    v_lshlrev_b32 v111, 5, v194
    v_bfe_u32 v194, v1, 3, 1
    v_lshl_add_u32 v111, v194, 3, v111
    v_and_b32 v194, 1, v192
    v_lshl_add_u32 v111, v194, 2, v111
    v_add_u32 v111, 143360, v111
    s_cmp_eq_u32 s28, 0
    s_cselect_b32 s52, 16, 0
    v_cmp_gt_u32 vcc, s52, v1
    v_mov_b32 v194, 0xffff0000
    s_nop 0
    v_cndmask_b32 v109, -1, v194, vcc
    ds_read_b64 v[212:213], v195 offset:256
    ds_read_b64 v[214:215], v195 offset:768
    ds_read_b64 v[216:217], v195 offset:2304
    ds_read_b64 v[218:219], v195 offset:2816
    ds_read_b64 v[220:221], v195 offset:4352
    ds_read_b64 v[222:223], v195 offset:4864
    s_waitcnt vmcnt(4)
    v_pk_add_f32 v[12:13], v[12:13], v[88:89]
    v_pk_add_f32 v[14:15], v[14:15], v[90:91]
    v_pk_add_f32 v[20:21], v[20:21], v[88:89]
PAD_157:
    s_cbranch_execz SCB_ret
    v_pk_add_f32 v[22:23], v[22:23], v[90:91]
    s_waitcnt vmcnt(3)
    v_pk_add_f32 v[28:29], v[28:29], v[92:93]
    v_pk_add_f32 v[30:31], v[30:31], v[94:95]
    v_pk_add_f32 v[36:37], v[36:37], v[92:93]
    v_pk_add_f32 v[38:39], v[38:39], v[94:95]
    s_waitcnt vmcnt(2)
    v_pk_add_f32 v[44:45], v[44:45], v[96:97]
    v_pk_add_f32 v[46:47], v[46:47], v[98:99]
    v_pk_add_f32 v[52:53], v[52:53], v[96:97]
    v_pk_add_f32 v[54:55], v[54:55], v[98:99]
    s_waitcnt lgkmcnt(5)
    v_lshlrev_b32 v208, 16, v212
    v_and_b32 v209, 0xffff0000, v212
    v_pk_add_f32 v[12:13], v[12:13], v[208:209]
    v_lshlrev_b32 v210, 16, v213
    v_and_b32 v211, 0xffff0000, v213
    v_pk_add_f32 v[14:15], v[14:15], v[210:211]
    s_waitcnt lgkmcnt(4)
    v_lshlrev_b32 v208, 16, v214
    v_and_b32 v209, 0xffff0000, v214
    v_pk_add_f32 v[20:21], v[20:21], v[208:209]
    v_lshlrev_b32 v210, 16, v215
    v_and_b32 v211, 0xffff0000, v215
    v_pk_add_f32 v[22:23], v[22:23], v[210:211]
    s_waitcnt lgkmcnt(3)
    v_lshlrev_b32 v208, 16, v216
    v_and_b32 v209, 0xffff0000, v216
    v_pk_add_f32 v[28:29], v[28:29], v[208:209]
    v_lshlrev_b32 v210, 16, v217
    v_and_b32 v211, 0xffff0000, v217
    v_pk_add_f32 v[30:31], v[30:31], v[210:211]
    s_waitcnt lgkmcnt(2)
    v_lshlrev_b32 v208, 16, v218
    v_and_b32 v209, 0xffff0000, v218
    v_pk_add_f32 v[36:37], v[36:37], v[208:209]
    v_lshlrev_b32 v210, 16, v219
    v_and_b32 v211, 0xffff0000, v219
    v_pk_add_f32 v[38:39], v[38:39], v[210:211]
SCB_e29:
PAD_158:
    s_cbranch_execz PAD_159
    s_waitcnt lgkmcnt(1)
    v_lshlrev_b32 v208, 16, v220
    v_and_b32 v209, 0xffff0000, v220
    v_pk_add_f32 v[44:45], v[44:45], v[208:209]
    v_lshlrev_b32 v210, 16, v221
    v_and_b32 v211, 0xffff0000, v221
    v_pk_add_f32 v[46:47], v[46:47], v[210:211]
    s_waitcnt lgkmcnt(0)
    v_lshlrev_b32 v208, 16, v222
    v_and_b32 v209, 0xffff0000, v222
    v_pk_add_f32 v[52:53], v[52:53], v[208:209]
    v_lshlrev_b32 v210, 16, v223
    v_and_b32 v211, 0xffff0000, v223
    v_pk_add_f32 v[54:55], v[54:55], v[210:211]
    s_waitcnt lgkmcnt(0)
    s_barrier
    ds_read_b128 v[8:11], v108 offset:3072
    ds_read_b128 v[16:19], v108 offset:4096
    ds_read_b128 v[24:27], v108 offset:5120
    ds_read_b128 v[32:35], v108 offset:9216
    ds_read_b128 v[40:43], v108 offset:10240
    ds_read_b128 v[48:51], v108 offset:11264
    ds_read_b128 v[56:59], v108 offset:15360
    ds_read_b128 v[60:63], v108 offset:16384
    ds_read_b128 v[64:67], v108 offset:17408
    ds_read_b128 v[68:71], v108 offset:21504
    ds_read_b128 v[72:75], v108 offset:22528
    ds_read_b128 v[76:79], v108 offset:23552
    ds_read_b128 v[80:83], v108 offset:27648
    ds_read_b128 v[84:87], v108 offset:28672
    ds_read_b128 v[192:195], v108 offset:29696
    ds_read_b128 v[196:199], v108 offset:33792
    ds_read_b128 v[200:203], v108 offset:34816
    ds_read_b128 v[204:207], v108 offset:35840
    s_waitcnt lgkmcnt(15)
    v_pk_add_f32 v[12:13], v[12:13], v[8:9]
PAD_159:
    s_cbranch_execz PAD_160
    v_pk_add_f32 v[16:17], v[16:17], v[24:25]
    v_pk_add_f32 v[14:15], v[14:15], v[10:11]
    v_pk_add_f32 v[18:19], v[18:19], v[26:27]
    v_pk_add_f32 v[12:13], v[12:13], v[16:17]
    v_pk_add_f32 v[14:15], v[14:15], v[18:19]
    v_add_u32 v12, 0x10000, v12
    v_and_b32 v12, v3, v12
    v_add_u32 v13, 0x10000, v13
    v_and_b32 v13, v3, v13
    v_cvt_pk_bf16_f32 v88, v12, v13
    v_cvt_pk_bf16_f32 v89, v14, v15
    s_waitcnt lgkmcnt(14)
    v_pk_add_f32 v[20:21], v[20:21], v[32:33]
    s_waitcnt lgkmcnt(12)
    v_pk_add_f32 v[40:41], v[40:41], v[48:49]
    v_pk_add_f32 v[22:23], v[22:23], v[34:35]
    v_pk_add_f32 v[42:43], v[42:43], v[50:51]
    v_pk_add_f32 v[20:21], v[20:21], v[40:41]
    v_pk_add_f32 v[22:23], v[22:23], v[42:43]
    v_cvt_pk_bf16_f32 v90, v20, v21
    v_cvt_pk_bf16_f32 v91, v22, v23
    s_add_u32 s50, s48, 0
    buffer_store_dwordx4 v[88:91], v110, s[32:35], s50 offen offset:256 sc1
    s_waitcnt lgkmcnt(11)
    v_pk_add_f32 v[28:29], v[28:29], v[56:57]
    s_waitcnt lgkmcnt(9)
    v_pk_add_f32 v[60:61], v[60:61], v[64:65]
    v_pk_add_f32 v[30:31], v[30:31], v[58:59]
    v_pk_add_f32 v[62:63], v[62:63], v[66:67]
    v_pk_add_f32 v[28:29], v[28:29], v[60:61]
    v_pk_add_f32 v[30:31], v[30:31], v[62:63]
    v_add_u32 v28, 0x10000, v28
    v_and_b32 v28, v3, v28
    v_add_u32 v29, 0x10000, v29
    v_and_b32 v29, v3, v29
    v_cvt_pk_bf16_f32 v92, v28, v29
PAD_160:
    s_cbranch_execz PAD_161
    v_cvt_pk_bf16_f32 v93, v30, v31
    s_waitcnt lgkmcnt(8)
    v_pk_add_f32 v[36:37], v[36:37], v[68:69]
    s_waitcnt lgkmcnt(6)
    v_pk_add_f32 v[72:73], v[72:73], v[76:77]
    v_pk_add_f32 v[38:39], v[38:39], v[70:71]
    v_pk_add_f32 v[74:75], v[74:75], v[78:79]
    v_pk_add_f32 v[36:37], v[36:37], v[72:73]
    v_pk_add_f32 v[38:39], v[38:39], v[74:75]
    v_cvt_pk_bf16_f32 v94, v36, v37
    v_cvt_pk_bf16_f32 v95, v38, v39
    s_add_u32 s50, s48, 66560
    buffer_store_dwordx4 v[92:95], v110, s[32:35], s50 offen offset:256 sc1
    s_waitcnt lgkmcnt(5)
    v_pk_add_f32 v[44:45], v[44:45], v[80:81]
    s_waitcnt lgkmcnt(3)
    v_pk_add_f32 v[84:85], v[84:85], v[192:193]
    v_pk_add_f32 v[46:47], v[46:47], v[82:83]
    v_pk_add_f32 v[86:87], v[86:87], v[194:195]
    v_pk_add_f32 v[44:45], v[44:45], v[84:85]
    v_pk_add_f32 v[46:47], v[46:47], v[86:87]
    v_add_u32 v44, 0x10000, v44
    v_and_b32 v44, v3, v44
    v_add_u32 v45, 0x10000, v45
    v_and_b32 v45, v3, v45
    v_cvt_pk_bf16_f32 v96, v44, v45
    v_cvt_pk_bf16_f32 v97, v46, v47
    s_waitcnt lgkmcnt(2)
    v_pk_add_f32 v[52:53], v[52:53], v[196:197]
    s_waitcnt lgkmcnt(0)
    v_pk_add_f32 v[200:201], v[200:201], v[204:205]
    v_pk_add_f32 v[54:55], v[54:55], v[198:199]
    v_pk_add_f32 v[202:203], v[202:203], v[206:207]
    v_pk_add_f32 v[52:53], v[52:53], v[200:201]
    v_pk_add_f32 v[54:55], v[54:55], v[202:203]
PAD_161:
    s_cbranch_execz SCB_ret
    v_cvt_pk_bf16_f32 v98, v52, v53
    v_cvt_pk_bf16_f32 v99, v54, v55
    s_add_u32 s50, s48, 133120
    buffer_store_dwordx4 v[96:99], v110, s[32:35], s50 offen offset:256 sc1
    v_and_b32 v10, v109, v88
    v_dot2_f32_bf16 v8, v10, v10, 0
    v_dot2_f32_bf16 v8, v89, v89, v8
    v_dot2_f32_bf16 v8, v92, v92, v8
    v_dot2_f32_bf16 v8, v93, v93, v8
    v_dot2_f32_bf16 v8, v96, v96, v8
    v_dot2_f32_bf16 v8, v97, v97, v8
    v_and_b32 v10, v109, v90
    v_dot2_f32_bf16 v9, v10, v10, 0
    v_dot2_f32_bf16 v9, v91, v91, v9
    v_dot2_f32_bf16 v9, v94, v94, v9
    v_dot2_f32_bf16 v9, v95, v95, v9
    v_dot2_f32_bf16 v9, v98, v98, v9
    v_dot2_f32_bf16 v9, v99, v99, v9
    s_nop 2
    v_permlane16_swap_b32 v8, v9
    v_add_f32 v8, v8, v9
    v_mov_b32 v9, v8
    s_nop 1
    v_permlane32_swap_b32 v8, v9
    v_add_f32 v8, v8, v9
    ds_write_b32 v111, v8 offset:16
    s_waitcnt lgkmcnt(0)
    s_barrier
    s_branch G2_done_60
G2_red_58:
    v_mfma_f32_16x16x32_bf16 v[8:11], a[36:39], v[112:115], v[8:11]
    v_mfma_f32_16x16x32_bf16 v[24:27], a[40:43], v[112:115], v[24:27]
    v_mfma_f32_16x16x32_bf16 v[40:43], a[44:47], v[112:115], v[40:43]
    v_mfma_f32_16x16x32_bf16 v[12:15], a[36:39], v[116:119], v[12:15]
    v_mfma_f32_16x16x32_bf16 v[28:31], a[40:43], v[116:119], v[28:31]
    s_nop 3
    ds_write_b128 v108, v[8:11] offset:1024
    v_mfma_f32_16x16x32_bf16 v[44:47], a[44:47], v[116:119], v[44:47]
    ds_write_b128 v108, v[24:27] offset:13312
SCB_e41:
PAD_162:
    s_cbranch_execz PAD_163
    v_mfma_f32_16x16x32_bf16 v[60:63], a[48:51], v[116:119], v[60:63]
    ds_write_b128 v108, v[40:43] offset:25600
    v_mfma_f32_16x16x32_bf16 v[76:79], a[52:55], v[116:119], v[76:79]
    ds_write_b128 v108, v[12:15] offset:3072
    v_mfma_f32_16x16x32_bf16 v[16:19], a[36:39], v[120:123], v[16:19]
    ds_write_b128 v108, v[28:31] offset:15360
    v_mfma_f32_16x16x32_bf16 v[32:35], a[40:43], v[120:123], v[32:35]
    ds_write_b128 v108, v[44:47] offset:27648
    v_mfma_f32_16x16x32_bf16 v[48:51], a[44:47], v[120:123], v[48:51]
    ds_write_b128 v108, v[60:63] offset:41984
    v_mfma_f32_16x16x32_bf16 v[20:23], a[36:39], v[124:127], v[20:23]
    ds_write_b128 v108, v[76:79] offset:54272
    v_mfma_f32_16x16x32_bf16 v[36:39], a[40:43], v[124:127], v[36:39]
    ds_write_b128 v108, v[16:19] offset:7168
    v_mfma_f32_16x16x32_bf16 v[52:55], a[44:47], v[124:127], v[52:55]
    ds_write_b128 v108, v[32:35] offset:19456
    v_mfma_f32_16x16x32_bf16 v[68:71], a[48:51], v[124:127], v[68:71]
    ds_write_b128 v108, v[48:51] offset:31744
    v_mfma_f32_16x16x32_bf16 v[84:87], a[52:55], v[124:127], v[84:87]
    ds_write_b128 v108, v[20:23] offset:9216
    v_mfma_f32_16x16x32_bf16 v[56:59], a[48:51], v[112:115], v[56:59]
    ds_write_b128 v108, v[36:39] offset:21504
    v_mfma_f32_16x16x32_bf16 v[72:75], a[52:55], v[112:115], v[72:75]
    ds_write_b128 v108, v[52:55] offset:33792
    v_mfma_f32_16x16x32_bf16 v[64:67], a[48:51], v[120:123], v[64:67]
    ds_write_b128 v108, v[68:71] offset:48128
    v_mfma_f32_16x16x32_bf16 v[80:83], a[52:55], v[120:123], v[80:83]
    ds_write_b128 v108, v[84:87] offset:60416
    v_lshrrev_b32 v192, 4, v1
    v_and_b32 v193, 15, v1
    v_lshlrev_b32 v110, 4, v193
    v_lshrrev_b32 v195, 1, v192
    v_lshl_add_u32 v195, v195, 10, v110
    v_and_b32 v194, 1, v192
PAD_163:
    s_cbranch_execz PAD_164
    v_lshl_add_u32 v195, v194, 3, v195
    s_mul_i32 s48, s28, 10240
    v_add_u32 v195, s48, v195
    v_mul_u32_u24 v194, 16640, v192
    v_add_u32 v110, v194, v110
    s_mul_i32 s48, s28, 332800
    s_lshl_b32 s49, s27, 9
    s_add_u32 s48, s48, s49
    v_and_b32 v194, 7, v1
    v_lshlrev_b32 v111, 5, v194
    v_bfe_u32 v194, v1, 3, 1
    v_lshl_add_u32 v111, v194, 3, v111
    v_and_b32 v194, 1, v192
    v_lshl_add_u32 v111, v194, 2, v111
    v_add_u32 v111, 143360, v111
    s_cmp_eq_u32 s28, 0
    s_cselect_b32 s52, 16, 0
    v_cmp_gt_u32 vcc, s52, v1
    v_mov_b32 v194, 0xffff0000
    s_nop 0
    v_cndmask_b32 v109, -1, v194, vcc
    ds_read_b64 v[212:213], v195 offset:6144
    ds_read_b64 v[214:215], v195 offset:6656
    ds_read_b64 v[216:217], v195 offset:8192
    ds_read_b64 v[218:219], v195 offset:8704
    s_waitcnt vmcnt(1)
    v_pk_add_f32 v[56:57], v[56:57], v[100:101]
    v_pk_add_f32 v[58:59], v[58:59], v[102:103]
    v_pk_add_f32 v[64:65], v[64:65], v[100:101]
    v_pk_add_f32 v[66:67], v[66:67], v[102:103]
    s_waitcnt vmcnt(0)
    v_pk_add_f32 v[72:73], v[72:73], v[104:105]
    v_pk_add_f32 v[74:75], v[74:75], v[106:107]
    v_pk_add_f32 v[80:81], v[80:81], v[104:105]
    v_pk_add_f32 v[82:83], v[82:83], v[106:107]
    s_waitcnt lgkmcnt(3)
    v_lshlrev_b32 v208, 16, v212
    v_and_b32 v209, 0xffff0000, v212
    v_pk_add_f32 v[56:57], v[56:57], v[208:209]
    v_lshlrev_b32 v210, 16, v213
PAD_164:
    s_cbranch_execz PAD_165
    v_and_b32 v211, 0xffff0000, v213
    v_pk_add_f32 v[58:59], v[58:59], v[210:211]
    s_waitcnt lgkmcnt(2)
    v_lshlrev_b32 v208, 16, v214
    v_and_b32 v209, 0xffff0000, v214
    v_pk_add_f32 v[64:65], v[64:65], v[208:209]
    v_lshlrev_b32 v210, 16, v215
    v_and_b32 v211, 0xffff0000, v215
    v_pk_add_f32 v[66:67], v[66:67], v[210:211]
    s_waitcnt lgkmcnt(1)
    v_lshlrev_b32 v208, 16, v216
    v_and_b32 v209, 0xffff0000, v216
    v_pk_add_f32 v[72:73], v[72:73], v[208:209]
    v_lshlrev_b32 v210, 16, v217
    v_and_b32 v211, 0xffff0000, v217
    v_pk_add_f32 v[74:75], v[74:75], v[210:211]
    s_waitcnt lgkmcnt(0)
    v_lshlrev_b32 v208, 16, v218
    v_and_b32 v209, 0xffff0000, v218
    v_pk_add_f32 v[80:81], v[80:81], v[208:209]
    v_lshlrev_b32 v210, 16, v219
    v_and_b32 v211, 0xffff0000, v219
    v_pk_add_f32 v[82:83], v[82:83], v[210:211]
    s_waitcnt lgkmcnt(0)
    s_barrier
    ds_read_b128 v[8:11], v108 offset:36864
    ds_read_b128 v[12:15], v108 offset:37888
    ds_read_b128 v[16:19], v108 offset:38912
    ds_read_b128 v[20:23], v108 offset:43008
    ds_read_b128 v[24:27], v108 offset:44032
    ds_read_b128 v[28:31], v108 offset:45056
    ds_read_b128 v[32:35], v108 offset:49152
    ds_read_b128 v[36:39], v108 offset:50176
    ds_read_b128 v[40:43], v108 offset:51200
    ds_read_b128 v[44:47], v108 offset:55296
    ds_read_b128 v[48:51], v108 offset:56320
    ds_read_b128 v[52:55], v108 offset:57344
PAD_165:
    s_cbranch_execz SCB_ret
    s_waitcnt lgkmcnt(11)
    v_pk_add_f32 v[56:57], v[56:57], v[8:9]
    s_waitcnt lgkmcnt(9)
    v_pk_add_f32 v[12:13], v[12:13], v[16:17]
    v_pk_add_f32 v[58:59], v[58:59], v[10:11]
    v_pk_add_f32 v[14:15], v[14:15], v[18:19]
    v_pk_add_f32 v[56:57], v[56:57], v[12:13]
    v_pk_add_f32 v[58:59], v[58:59], v[14:15]
    v_add_u32 v56, 0x10000, v56
    v_and_b32 v56, v3, v56
    v_add_u32 v57, 0x10000, v57
    v_and_b32 v57, v3, v57
    v_cvt_pk_bf16_f32 v100, v56, v57
    v_cvt_pk_bf16_f32 v101, v58, v59
    s_waitcnt lgkmcnt(8)
    v_pk_add_f32 v[64:65], v[64:65], v[20:21]
    s_waitcnt lgkmcnt(6)
    v_pk_add_f32 v[24:25], v[24:25], v[28:29]
    v_pk_add_f32 v[66:67], v[66:67], v[22:23]
    v_pk_add_f32 v[26:27], v[26:27], v[30:31]
    v_pk_add_f32 v[64:65], v[64:65], v[24:25]
    v_pk_add_f32 v[66:67], v[66:67], v[26:27]
    v_cvt_pk_bf16_f32 v102, v64, v65
    v_cvt_pk_bf16_f32 v103, v66, v67
    s_add_u32 s50, s48, 199680
    buffer_store_dwordx4 v[100:103], v110, s[32:35], s50 offen offset:0 sc1
    s_waitcnt lgkmcnt(5)
    v_pk_add_f32 v[72:73], v[72:73], v[32:33]
    s_waitcnt lgkmcnt(3)
    v_pk_add_f32 v[36:37], v[36:37], v[40:41]
    v_pk_add_f32 v[74:75], v[74:75], v[34:35]
    v_pk_add_f32 v[38:39], v[38:39], v[42:43]
    v_pk_add_f32 v[72:73], v[72:73], v[36:37]
    v_pk_add_f32 v[74:75], v[74:75], v[38:39]
    v_add_u32 v72, 0x10000, v72
    v_and_b32 v72, v3, v72
SCB_e6:
PAD_166:
    s_cbranch_execz PAD_167
    v_add_u32 v73, 0x10000, v73
    v_and_b32 v73, v3, v73
    v_cvt_pk_bf16_f32 v104, v72, v73
    v_cvt_pk_bf16_f32 v105, v74, v75
    s_waitcnt lgkmcnt(2)
    v_pk_add_f32 v[80:81], v[80:81], v[44:45]
    s_waitcnt lgkmcnt(0)
    v_pk_add_f32 v[48:49], v[48:49], v[52:53]
    v_pk_add_f32 v[82:83], v[82:83], v[46:47]
    v_pk_add_f32 v[50:51], v[50:51], v[54:55]
    v_pk_add_f32 v[80:81], v[80:81], v[48:49]
    v_pk_add_f32 v[82:83], v[82:83], v[50:51]
    v_cvt_pk_bf16_f32 v106, v80, v81
    v_cvt_pk_bf16_f32 v107, v82, v83
    s_add_u32 s50, s48, 266240
    buffer_store_dwordx4 v[104:107], v110, s[32:35], s50 offen offset:0 sc1
    v_dot2_f32_bf16 v8, v100, v100, 0
    v_dot2_f32_bf16 v8, v101, v101, v8
    v_dot2_f32_bf16 v8, v104, v104, v8
    v_dot2_f32_bf16 v8, v105, v105, v8
    v_dot2_f32_bf16 v9, v102, v102, 0
    v_dot2_f32_bf16 v9, v103, v103, v9
    v_dot2_f32_bf16 v9, v106, v106, v9
    v_dot2_f32_bf16 v9, v107, v107, v9
    s_nop 2
    v_permlane16_swap_b32 v8, v9
    v_add_f32 v8, v8, v9
    v_mov_b32 v9, v8
    s_nop 1
    v_permlane32_swap_b32 v8, v9
    v_add_f32 v8, v8, v9
    ds_write_b32 v111, v8 offset:256
    s_waitcnt lgkmcnt(0)
    s_barrier
    s_branch G2_done_60
G2_red_59:
    ds_write_b128 v108, v[8:11] offset:2048
    ds_write_b128 v108, v[24:27] offset:14336
    ds_write_b128 v108, v[40:43] offset:26624
PAD_167:
    s_cbranch_execz PAD_168
    ds_write_b128 v108, v[56:59] offset:36864
    ds_write_b128 v108, v[72:75] offset:49152
    ds_write_b128 v108, v[12:15] offset:4096
    ds_write_b128 v108, v[28:31] offset:16384
    ds_write_b128 v108, v[44:47] offset:28672
    ds_write_b128 v108, v[16:19] offset:8192
    ds_write_b128 v108, v[32:35] offset:20480
    ds_write_b128 v108, v[48:51] offset:32768
    ds_write_b128 v108, v[64:67] offset:43008
    ds_write_b128 v108, v[80:83] offset:55296
    ds_write_b128 v108, v[20:23] offset:10240
    ds_write_b128 v108, v[36:39] offset:22528
    ds_write_b128 v108, v[52:55] offset:34816
    v_lshrrev_b32 v192, 4, v1
    v_and_b32 v193, 15, v1
    v_lshlrev_b32 v110, 4, v193
    v_lshrrev_b32 v195, 1, v192
    v_lshl_add_u32 v195, v195, 10, v110
    v_and_b32 v194, 1, v192
    v_lshl_add_u32 v195, v194, 3, v195
    s_mul_i32 s48, s28, 10240
    v_add_u32 v195, s48, v195
    v_mul_u32_u24 v194, 16640, v192
    v_add_u32 v110, v194, v110
    s_mul_i32 s48, s28, 332800
    s_lshl_b32 s49, s27, 9
    s_add_u32 s48, s48, s49
    v_and_b32 v194, 7, v1
    v_lshlrev_b32 v111, 5, v194
    v_bfe_u32 v194, v1, 3, 1
    v_lshl_add_u32 v111, v194, 3, v111
    v_and_b32 v194, 1, v192
    v_lshl_add_u32 v111, v194, 2, v111
    v_add_u32 v111, 143360, v111
    s_cmp_eq_u32 s28, 0
    s_cselect_b32 s52, 16, 0
    v_cmp_gt_u32 vcc, s52, v1
    v_mov_b32 v194, 0xffff0000
    s_nop 0
    v_cndmask_b32 v109, -1, v194, vcc
PAD_168:
    s_cbranch_execz PAD_169
    ds_read_b64 v[212:213], v195 offset:6400
    ds_read_b64 v[214:215], v195 offset:6912
    ds_read_b64 v[216:217], v195 offset:8448
    ds_read_b64 v[218:219], v195 offset:8960
    s_waitcnt vmcnt(1)
    v_pk_add_f32 v[60:61], v[60:61], v[100:101]
    v_pk_add_f32 v[62:63], v[62:63], v[102:103]
    v_pk_add_f32 v[68:69], v[68:69], v[100:101]
    v_pk_add_f32 v[70:71], v[70:71], v[102:103]
    s_waitcnt vmcnt(0)
    v_pk_add_f32 v[76:77], v[76:77], v[104:105]
    v_pk_add_f32 v[78:79], v[78:79], v[106:107]
    v_pk_add_f32 v[84:85], v[84:85], v[104:105]
    v_pk_add_f32 v[86:87], v[86:87], v[106:107]
    s_waitcnt lgkmcnt(3)
    v_lshlrev_b32 v208, 16, v212
    v_and_b32 v209, 0xffff0000, v212
    v_pk_add_f32 v[60:61], v[60:61], v[208:209]
    v_lshlrev_b32 v210, 16, v213
    v_and_b32 v211, 0xffff0000, v213
    v_pk_add_f32 v[62:63], v[62:63], v[210:211]
    s_waitcnt lgkmcnt(2)
    v_lshlrev_b32 v208, 16, v214
    v_and_b32 v209, 0xffff0000, v214
    v_pk_add_f32 v[68:69], v[68:69], v[208:209]
    v_lshlrev_b32 v210, 16, v215
    v_and_b32 v211, 0xffff0000, v215
    v_pk_add_f32 v[70:71], v[70:71], v[210:211]
    s_waitcnt lgkmcnt(1)
    v_lshlrev_b32 v208, 16, v216
    v_and_b32 v209, 0xffff0000, v216
    v_pk_add_f32 v[76:77], v[76:77], v[208:209]
    v_lshlrev_b32 v210, 16, v217
    v_and_b32 v211, 0xffff0000, v217
    v_pk_add_f32 v[78:79], v[78:79], v[210:211]
    s_waitcnt lgkmcnt(0)
    v_lshlrev_b32 v208, 16, v218
    v_and_b32 v209, 0xffff0000, v218
PAD_169:
    s_cbranch_execz SCB_ret
    v_pk_add_f32 v[84:85], v[84:85], v[208:209]
    v_lshlrev_b32 v210, 16, v219
    v_and_b32 v211, 0xffff0000, v219
    v_pk_add_f32 v[86:87], v[86:87], v[210:211]
    v_sub_u32 v4, 0, v1
    v_and_b32 v4, 0x40000000, v4
    v_mov_b32 v5, 0
    s_waitcnt lgkmcnt(0)
    s_barrier
    ds_read_b128 v[8:11], v108 offset:39936
    ds_read_b128 v[12:15], v108 offset:40960
    ds_read_b128 v[16:19], v108 offset:41984
    ds_read_b128 v[20:23], v108 offset:46080
    ds_read_b128 v[24:27], v108 offset:47104
    ds_read_b128 v[28:31], v108 offset:48128
    ds_read_b128 v[32:35], v108 offset:52224
    ds_read_b128 v[36:39], v108 offset:53248
    ds_read_b128 v[40:43], v108 offset:54272
    ds_read_b128 v[44:47], v108 offset:58368
    ds_read_b128 v[48:51], v108 offset:59392
    ds_read_b128 v[52:55], v108 offset:60416
    s_waitcnt lgkmcnt(11)
    v_pk_add_f32 v[60:61], v[60:61], v[8:9]
    s_waitcnt lgkmcnt(9)
    v_pk_add_f32 v[12:13], v[12:13], v[16:17]
    v_pk_add_f32 v[62:63], v[62:63], v[10:11]
    v_pk_add_f32 v[14:15], v[14:15], v[18:19]
    v_pk_add_f32 v[60:61], v[60:61], v[12:13]
    v_pk_add_f32 v[62:63], v[62:63], v[14:15]
    v_add_u32 v60, 0x10000, v60
    v_and_b32 v60, v3, v60
    v_add_u32 v61, 0x10000, v61
    v_and_b32 v61, v3, v61
    v_cvt_pk_bf16_f32 v100, v60, v61
    v_cvt_pk_bf16_f32 v101, v62, v63
    s_waitcnt lgkmcnt(8)
    v_pk_add_f32 v[68:69], v[68:69], v[20:21]
SCB_e18:
PAD_170:
    s_cbranch_execz PAD_171
    s_waitcnt lgkmcnt(6)
    v_pk_add_f32 v[24:25], v[24:25], v[28:29]
    v_pk_add_f32 v[70:71], v[70:71], v[22:23]
    v_pk_add_f32 v[26:27], v[26:27], v[30:31]
    v_pk_add_f32 v[68:69], v[68:69], v[24:25]
    v_pk_add_f32 v[70:71], v[70:71], v[26:27]
    v_cvt_pk_bf16_f32 v102, v68, v69
    v_cvt_pk_bf16_f32 v103, v70, v71
    s_add_u32 s50, s48, 199680
    buffer_store_dwordx4 v[100:103], v110, s[32:35], s50 offen offset:256 sc1
    s_waitcnt lgkmcnt(5)
    v_pk_add_f32 v[76:77], v[76:77], v[32:33]
    s_waitcnt lgkmcnt(3)
    v_pk_add_f32 v[36:37], v[36:37], v[40:41]
    v_pk_add_f32 v[78:79], v[78:79], v[34:35]
    v_pk_add_f32 v[38:39], v[38:39], v[42:43]
    v_pk_add_f32 v[76:77], v[76:77], v[36:37]
    v_pk_add_f32 v[78:79], v[78:79], v[38:39]
    v_add_u32 v76, 0x10000, v76
    v_and_b32 v76, v3, v76
    v_add_u32 v77, 0x10000, v77
    v_and_b32 v77, v3, v77
    v_cvt_pk_bf16_f32 v104, v76, v77
    v_cvt_pk_bf16_f32 v105, v78, v79
    s_waitcnt lgkmcnt(2)
    v_pk_add_f32 v[84:85], v[84:85], v[44:45]
    s_waitcnt lgkmcnt(0)
    v_pk_add_f32 v[48:49], v[48:49], v[52:53]
    v_pk_add_f32 v[86:87], v[86:87], v[46:47]
    v_pk_add_f32 v[50:51], v[50:51], v[54:55]
    v_pk_add_f32 v[84:85], v[84:85], v[48:49]
    v_pk_add_f32 v[86:87], v[86:87], v[50:51]
    v_cvt_pk_bf16_f32 v106, v84, v85
    v_cvt_pk_bf16_f32 v107, v86, v87
    s_add_u32 s50, s48, 266240
PAD_171:
    s_cbranch_execz PAD_172
    buffer_store_dwordx4 v[104:107], v110, s[32:35], s50 offen offset:256 sc1
    v_dot2_f32_bf16 v8, v100, v100, 0
    v_dot2_f32_bf16 v8, v101, v101, v8
    v_dot2_f32_bf16 v8, v104, v104, v8
    v_dot2_f32_bf16 v8, v105, v105, v8
    v_dot2_f32_bf16 v9, v102, v102, 0
    v_dot2_f32_bf16 v9, v103, v103, v9
    v_dot2_f32_bf16 v9, v106, v106, v9
    v_dot2_f32_bf16 v9, v107, v107, v9
    s_nop 2
    v_permlane16_swap_b32 v8, v9
    v_add_f32 v8, v8, v9
    v_mov_b32 v9, v8
    s_nop 1
    v_permlane32_swap_b32 v8, v9
    v_add_f32 v8, v8, v9
    ds_write_b32 v111, v8 offset:272
    v_lshlrev_b32 v192, 5, v1
    v_and_b32 v192, 0xff, v192
    v_add_u32 v192, 143360, v192
    v_mov_b32 v194, 0x40000000
    v_cmp_gt_u32 vcc, 8, v1
    s_nop 1
    v_cndmask_b32 v193, v194, v2, vcc
    s_lshl_b32 s49, s27, 7
    s_lshl_b32 s50, s28, 12
    s_add_u32 s49, s49, s50
    s_add_u32 s49, s49, 0xc83000
    s_waitcnt lgkmcnt(0)
    s_barrier
    ds_read_b128 v[208:211], v192 offset:0
    ds_read_b128 v[212:215], v192 offset:16
    ds_read_b128 v[216:219], v192 offset:256
    ds_read_b128 v[220:223], v192 offset:272
    s_waitcnt lgkmcnt(1)
    v_pk_add_f32 v[208:209], v[208:209], v[216:217]
    v_cvt_pk_bf16_f32 v196, v208, v209
    v_pk_add_f32 v[210:211], v[210:211], v[218:219]
    v_cvt_pk_bf16_f32 v197, v210, v211
    s_waitcnt lgkmcnt(0)
    v_pk_add_f32 v[212:213], v[212:213], v[220:221]
PAD_172:
    s_cbranch_execz PAD_173
    v_cvt_pk_bf16_f32 v198, v212, v213
    v_pk_add_f32 v[214:215], v[214:215], v[222:223]
    v_cvt_pk_bf16_f32 v199, v214, v215
    buffer_store_dwordx4 v[196:199], v193, s[32:35], s49 offen sc1
    buffer_store_dword v5, v4, s[32:35], s18 offen sc1
G2_done_60:
    s_mov_b32 s63, 1
    s_mov_b32 s60, 0x10000
    s_mov_b32 s15, 0x0
    s_mov_b32 s16, 0x10000
    s_mov_b32 s17, 0x8
    s_mul_i32 s14, s28, 286720
    s_mul_i32 s48, s26, 71680
    s_add_u32 s14, s14, s48
    s_add_u32 s14, s14, 0x94c000
    s_waitcnt lgkmcnt(0)
    s_branch L_layer
L_final:
    v_lshrrev_b32 v4, 4, v1
    v_and_b32 v5, 15, v1
    v_lshlrev_b32 v5, 4, v5
    v_lshl_add_u32 v109, v4, 10, v5
    s_min_u32 s48, s26, 1
    s_add_u32 s48, s48, s26
    s_add_u32 s48, s48, 6
    s_lshl_b32 s48, s48, 12
    v_add_u32 v109, s48, v109
    s_mul_i32 s48, s26, 15360
    s_add_u32 s48, s48, 81920
    v_add_u32 v110, s48, v2
    ds_read_b128 a[232:235], v110 offset:0
    ds_read_b128 a[200:203], v109 offset:0
    ds_read_b128 a[204:207], v109 offset:256
    ds_read_b128 a[208:211], v109 offset:512
    ds_read_b128 a[212:215], v109 offset:768
    ds_read_b128 a[236:239], v110 offset:1024
    ds_read_b128 a[240:243], v110 offset:2048
    ds_read_b128 a[244:247], v110 offset:3072
    ds_read_b128 a[248:251], v110 offset:4096
    ds_read_b128 a[252:255], v110 offset:5120
    ds_read_b128 a[216:219], v109 offset:40960
PAD_173:
    s_cbranch_execz SCB_ret
    ds_read_b128 a[220:223], v109 offset:41216
    ds_read_b128 a[224:227], v109 offset:41472
    ds_read_b128 a[228:231], v109 offset:41728
    s_cmp_eq_u32 s26, 1
    s_cselect_b32 s48, 0x8000, 0
    v_add_u32 v108, s48, v109
    s_waitcnt lgkmcnt(12)
    v_mfma_f32_16x16x32_bf16 v[8:11], a[232:235], a[200:203], 0
    s_mov_b32 s52, 0xe000
    buffer_load_dwordx4 a[144:147], v6, s[32:35], s52 offen offset:0 sc1
    s_waitcnt lgkmcnt(11)
    v_mfma_f32_16x16x32_bf16 v[12:15], a[232:235], a[204:207], 0
    s_waitcnt lgkmcnt(10)
    v_mfma_f32_16x16x32_bf16 v[16:19], a[232:235], a[208:211], 0
    s_waitcnt lgkmcnt(9)
    v_mfma_f32_16x16x32_bf16 v[20:23], a[232:235], a[212:215], 0
    ds_read_b128 a[232:235], v110 offset:6144
    s_waitcnt lgkmcnt(9)
    v_mfma_f32_16x16x32_bf16 v[24:27], a[236:239], a[200:203], 0
    v_mfma_f32_16x16x32_bf16 v[28:31], a[236:239], a[204:207], 0
    buffer_load_dwordx4 a[148:151], v6, s[32:35], s52 offen offset:1024 sc1
    v_mfma_f32_16x16x32_bf16 v[32:35], a[236:239], a[208:211], 0
    v_mfma_f32_16x16x32_bf16 v[36:39], a[236:239], a[212:215], 0
    ds_read_b128 a[236:239], v110 offset:7168
    s_waitcnt lgkmcnt(9)
    v_mfma_f32_16x16x32_bf16 v[40:43], a[240:243], a[200:203], 0
    v_mfma_f32_16x16x32_bf16 v[44:47], a[240:243], a[204:207], 0
    v_mfma_f32_16x16x32_bf16 v[48:51], a[240:243], a[208:211], 0
    buffer_load_dwordx4 a[152:155], v6, s[32:35], s52 offen offset:2048 sc1
    v_mfma_f32_16x16x32_bf16 v[52:55], a[240:243], a[212:215], 0
    ds_read_b128 a[240:243], v110 offset:8192
    s_waitcnt lgkmcnt(9)
    v_mfma_f32_16x16x32_bf16 v[56:59], a[244:247], a[200:203], 0
    v_mfma_f32_16x16x32_bf16 v[60:63], a[244:247], a[204:207], 0
    v_mfma_f32_16x16x32_bf16 v[64:67], a[244:247], a[208:211], 0
    v_mfma_f32_16x16x32_bf16 v[68:71], a[244:247], a[212:215], 0
SCB_e30:
PAD_174:
    s_cbranch_execz PAD_175
    ds_read_b128 a[244:247], v110 offset:9216
    s_waitcnt lgkmcnt(9)
    v_mfma_f32_16x16x32_bf16 v[72:75], a[248:251], a[200:203], 0
    buffer_load_dwordx4 a[156:159], v6, s[32:35], s52 offen offset:3072 sc1
    v_mfma_f32_16x16x32_bf16 v[76:79], a[248:251], a[204:207], 0
    v_mfma_f32_16x16x32_bf16 v[80:83], a[248:251], a[208:211], 0
    v_mfma_f32_16x16x32_bf16 v[84:87], a[248:251], a[212:215], 0
    ds_read_b128 a[248:251], v110 offset:10240
    ds_read_b128 a[200:203], v108 offset:4096
    ds_read_b128 a[204:207], v108 offset:4352
    ds_read_b128 a[208:211], v108 offset:4608
    ds_read_b128 a[212:215], v108 offset:4864
    s_waitcnt lgkmcnt(12)
    v_mfma_f32_16x16x32_bf16 v[8:11], a[252:255], a[216:219], v[8:11]
    s_waitcnt lgkmcnt(11)
    v_mfma_f32_16x16x32_bf16 v[12:15], a[252:255], a[220:223], v[12:15]
    s_mov_b32 s52, 0xf000
    buffer_load_dwordx4 a[160:163], v6, s[32:35], s52 offen offset:0 sc1
    s_waitcnt lgkmcnt(10)
    v_mfma_f32_16x16x32_bf16 v[16:19], a[252:255], a[224:227], v[16:19]
    s_waitcnt lgkmcnt(9)
    v_mfma_f32_16x16x32_bf16 v[20:23], a[252:255], a[228:231], v[20:23]
    ds_read_b128 a[252:255], v110 offset:11264
    s_waitcnt lgkmcnt(9)
    v_mfma_f32_16x16x32_bf16 v[24:27], a[232:235], a[216:219], v[24:27]
    v_mfma_f32_16x16x32_bf16 v[28:31], a[232:235], a[220:223], v[28:31]
    v_mfma_f32_16x16x32_bf16 v[32:35], a[232:235], a[224:227], v[32:35]
    v_mfma_f32_16x16x32_bf16 v[36:39], a[232:235], a[228:231], v[36:39]
    buffer_load_dwordx4 a[164:167], v6, s[32:35], s52 offen offset:1024 sc1
    ds_read_b128 a[232:235], v110 offset:12288
    s_waitcnt lgkmcnt(9)
    v_mfma_f32_16x16x32_bf16 v[40:43], a[236:239], a[216:219], v[40:43]
    v_mfma_f32_16x16x32_bf16 v[44:47], a[236:239], a[220:223], v[44:47]
    v_mfma_f32_16x16x32_bf16 v[48:51], a[236:239], a[224:227], v[48:51]
    v_mfma_f32_16x16x32_bf16 v[52:55], a[236:239], a[228:231], v[52:55]
PAD_175:
    s_cbranch_execz PAD_176
    ds_read_b128 a[236:239], v110 offset:13312
    s_waitcnt lgkmcnt(9)
    v_mfma_f32_16x16x32_bf16 v[56:59], a[240:243], a[216:219], v[56:59]
    buffer_load_dwordx4 a[168:171], v6, s[32:35], s52 offen offset:2048 sc1
    v_mfma_f32_16x16x32_bf16 v[60:63], a[240:243], a[220:223], v[60:63]
    v_mfma_f32_16x16x32_bf16 v[64:67], a[240:243], a[224:227], v[64:67]
    v_mfma_f32_16x16x32_bf16 v[68:71], a[240:243], a[228:231], v[68:71]
    ds_read_b128 a[240:243], v110 offset:14336
    s_waitcnt lgkmcnt(9)
    v_mfma_f32_16x16x32_bf16 v[72:75], a[244:247], a[216:219], v[72:75]
    v_mfma_f32_16x16x32_bf16 v[76:79], a[244:247], a[220:223], v[76:79]
    buffer_load_dwordx4 a[172:175], v6, s[32:35], s52 offen offset:3072 sc1
    v_mfma_f32_16x16x32_bf16 v[80:83], a[244:247], a[224:227], v[80:83]
    v_mfma_f32_16x16x32_bf16 v[84:87], a[244:247], a[228:231], v[84:87]
    s_waitcnt lgkmcnt(7)
    v_mfma_f32_16x16x32_bf16 v[8:11], a[248:251], a[200:203], v[8:11]
    s_waitcnt lgkmcnt(6)
    v_mfma_f32_16x16x32_bf16 v[12:15], a[248:251], a[204:207], v[12:15]
    s_waitcnt lgkmcnt(5)
    v_mfma_f32_16x16x32_bf16 v[16:19], a[248:251], a[208:211], v[16:19]
    s_waitcnt lgkmcnt(4)
    v_mfma_f32_16x16x32_bf16 v[20:23], a[248:251], a[212:215], v[20:23]
    s_mov_b32 s48, 0x4000
    buffer_load_dwordx4 a[216:219], v7, s[32:35], s48 offen offset:0 sc1
    s_waitcnt lgkmcnt(3)
    v_mfma_f32_16x16x32_bf16 v[24:27], a[252:255], a[200:203], v[24:27]
    v_mfma_f32_16x16x32_bf16 v[28:31], a[252:255], a[204:207], v[28:31]
    v_mfma_f32_16x16x32_bf16 v[32:35], a[252:255], a[208:211], v[32:35]
    v_mfma_f32_16x16x32_bf16 v[36:39], a[252:255], a[212:215], v[36:39]
    s_waitcnt lgkmcnt(2)
    v_mfma_f32_16x16x32_bf16 v[40:43], a[232:235], a[200:203], v[40:43]
    buffer_load_dwordx4 a[220:223], v7, s[32:35], s48 offen offset:256 sc1
    v_mfma_f32_16x16x32_bf16 v[44:47], a[232:235], a[204:207], v[44:47]
    v_mfma_f32_16x16x32_bf16 v[48:51], a[232:235], a[208:211], v[48:51]
    v_mfma_f32_16x16x32_bf16 v[52:55], a[232:235], a[212:215], v[52:55]
    s_waitcnt lgkmcnt(1)
PAD_176:
    s_cbranch_execz SCB_ret
    v_mfma_f32_16x16x32_bf16 v[56:59], a[236:239], a[200:203], v[56:59]
    v_mfma_f32_16x16x32_bf16 v[60:63], a[236:239], a[204:207], v[60:63]
    v_mfma_f32_16x16x32_bf16 v[64:67], a[236:239], a[208:211], v[64:67]
    buffer_load_dwordx4 a[224:227], v7, s[32:35], s48 offen offset:512 sc1
    v_mfma_f32_16x16x32_bf16 v[68:71], a[236:239], a[212:215], v[68:71]
    s_waitcnt lgkmcnt(0)
    v_mfma_f32_16x16x32_bf16 v[72:75], a[240:243], a[200:203], v[72:75]
    v_mfma_f32_16x16x32_bf16 v[76:79], a[240:243], a[204:207], v[76:79]
    v_mfma_f32_16x16x32_bf16 v[80:83], a[240:243], a[208:211], v[80:83]
    v_mfma_f32_16x16x32_bf16 v[84:87], a[240:243], a[212:215], v[84:87]
    buffer_load_dwordx4 a[228:231], v7, s[32:35], s48 offen offset:768 sc1
    s_branch G2_h
G2_low:
    s_waitcnt vmcnt(3)
    v_lshrrev_b32 v4, 4, v1
    v_and_b32 v5, 15, v1
    v_lshlrev_b32 v5, 4, v5
    v_lshl_add_u32 v109, v4, 10, v5
    ds_read_b128 a[200:203], v109 offset:0
    ds_read_b128 a[204:207], v109 offset:256
    ds_read_b128 a[208:211], v109 offset:512
    ds_read_b128 a[212:215], v109 offset:768
    ds_read_b128 a[216:219], v109 offset:4096
    ds_read_b128 a[220:223], v109 offset:4352
    ds_read_b128 a[224:227], v109 offset:4608
    ds_read_b128 a[228:231], v109 offset:4864
    ds_read_b128 a[176:179], v109 offset:45056
    ds_read_b128 a[180:183], v109 offset:45312
    ds_read_b128 a[184:187], v109 offset:45568
    ds_read_b128 a[188:191], v109 offset:45824
    ds_read_b128 a[160:163], v109 offset:49152
    ds_read_b128 a[164:167], v109 offset:49408
    ds_read_b128 a[168:171], v109 offset:49664
    ds_read_b128 a[172:175], v109 offset:49920
    s_mov_b32 s52, 0xa000
    buffer_load_dwordx4 a[80:83], v6, s[32:35], s52 offen offset:0 sc1
SCB_e42:
PAD_177:
    s_cbranch_execz PAD_178
    v_lshrrev_b32 v254, 4, v1
    v_mul_u32_u24 v254, 40, v254
    v_cvt_f32_u32 v96, v254
    v_add_f32 v97, 0x41a00000, v96
    s_mul_i32 s49, s28, 80
    v_and_b32 v254, 15, v1
    v_add_u32 v254, s49, v254
    v_cvt_f32_u32 v99, v254
    v_and_b32 v255, 12, v1
    v_add_u32 v254, v254, v255
    v_cvt_f32_u32 v98, v254
    v_lshlrev_b32 v100, 4, v1
    v_lshlrev_b32 v254, 30, v1
    v_lshlrev_b32 v255, 31, v1
    v_xor_b32 v101, v254, v255
    v_lshrrev_b32 v254, 16, v254
    v_and_b32 v254, 0x8000, v254
    v_bfrev_b32 v102, 1
    v_and_or_b32 v101, v101, v102, v254
    v_alignbit_b32 v102, v102, v102, v100
    buffer_load_dwordx4 a[84:87], v6, s[32:35], s52 offen offset:1024 sc1
    v_or_b32 v103, 0x3d223d22, v255
    v_cmp_gt_u32 vcc, 16, v1
    v_add_f32 v254, 0x00000000, v98
    v_mul_f32 v254, 0xbacccccd, v254
    v_cos_f32 v244, v254
    v_sin_f32 v245, v254
    v_mul_f32 v225, v254, v96
    v_mul_f32 v227, v254, v97
    v_fract_f32 v225, v225
    v_fract_f32 v227, v227
    v_cos_f32 v224, v225
    v_cos_f32 v226, v227
    v_sin_f32 v225, v225
    v_sin_f32 v227, v227
    v_mul_f32 v224, 0x3d64f92e, v224
    v_mul_f32 v225, 0x3d64f92e, v225
    v_mul_f32 v226, 0x3d64f92e, v226
    v_mul_f32 v227, 0x3d64f92e, v227
    v_cvt_pk_bf16_f32 v88, v224, v225
    v_cvt_pk_bf16_f32 v89, v226, v227
    buffer_load_dwordx4 a[88:91], v6, s[32:35], s52 offen offset:2048 sc1
    v_alignbit_b32 v90, v88, v88, v100
    v_alignbit_b32 v91, v89, v89, v100
    v_xor_b32 v90, v101, v90
PAD_178:
    s_cbranch_execz PAD_179
    v_xor_b32 v91, v101, v91
    v_cndmask_b32 v88, v88, v103, vcc
    s_waitcnt lgkmcnt(15)
    s_nop 0
    v_mfma_f32_16x16x32_bf16 v[8:11], v[88:91], a[200:203], 0
    v_mul_f32 v254, v224, v245
    v_mul_f32 v255, v226, v245
    v_mul_f32 v224, v224, v244
    v_mul_f32 v226, v226, v244
    v_fma_f32 v224, -v225, v245, v224
    v_fma_f32 v226, -v227, v245, v226
    v_fma_f32 v225, v225, v244, v254
    s_waitcnt lgkmcnt(14)
    v_mfma_f32_16x16x32_bf16 v[12:15], v[88:91], a[204:207], 0
    v_fma_f32 v227, v227, v244, v255
    v_add_f32 v254, 0x40800000, v98
    v_mul_f32 v254, 0xbacccccd, v254
    v_cos_f32 v246, v254
    v_sin_f32 v247, v254
    v_mul_f32 v229, v254, v96
    buffer_load_dwordx4 a[92:95], v6, s[32:35], s52 offen offset:3072 sc1
    v_mul_f32 v231, v254, v97
    v_fract_f32 v229, v229
    s_waitcnt lgkmcnt(13)
    v_mfma_f32_16x16x32_bf16 v[16:19], v[88:91], a[208:211], 0
    v_fract_f32 v231, v231
    v_cos_f32 v228, v229
    v_cos_f32 v230, v231
    v_sin_f32 v229, v229
    v_sin_f32 v231, v231
    v_mul_f32 v228, 0x3d64f92e, v228
    v_mul_f32 v229, 0x3d64f92e, v229
    v_mul_f32 v230, 0x3d64f92e, v230
    s_waitcnt lgkmcnt(12)
    v_mfma_f32_16x16x32_bf16 v[20:23], v[88:91], a[212:215], 0
    v_mul_f32 v231, 0x3d64f92e, v231
    v_cvt_pk_bf16_f32 v92, v228, v229
    v_cvt_pk_bf16_f32 v93, v230, v231
    v_alignbit_b32 v94, v92, v92, v100
    v_alignbit_b32 v95, v93, v93, v100
    v_xor_b32 v94, v101, v94
    v_xor_b32 v95, v101, v95
    v_cndmask_b32 v92, v92, v103, vcc
    s_mov_b32 s52, 0xb000
PAD_179:
    s_cbranch_execz PAD_180
    buffer_load_dwordx4 a[96:99], v6, s[32:35], s52 offen offset:0 sc1
    v_mfma_f32_16x16x32_bf16 v[24:27], v[92:95], a[200:203], 0
    v_mul_f32 v254, v228, v247
    v_mul_f32 v255, v230, v247
    v_mul_f32 v228, v228, v246
    v_mul_f32 v230, v230, v246
    v_fma_f32 v228, -v229, v247, v228
    v_fma_f32 v230, -v231, v247, v230
    v_fma_f32 v229, v229, v246, v254
    v_mfma_f32_16x16x32_bf16 v[28:31], v[92:95], a[204:207], 0
    v_fma_f32 v231, v231, v246, v255
    v_add_f32 v254, 0x42000000, v98
    v_mul_f32 v254, 0xbacccccd, v254
    v_cos_f32 v248, v254
    v_sin_f32 v249, v254
    v_mul_f32 v233, v254, v96
    v_mul_f32 v235, v254, v97
    v_fract_f32 v233, v233
    v_mfma_f32_16x16x32_bf16 v[32:35], v[92:95], a[208:211], 0
    v_fract_f32 v235, v235
    v_cos_f32 v232, v233
    buffer_load_dwordx4 a[100:103], v6, s[32:35], s52 offen offset:1024 sc1
    v_cos_f32 v234, v235
    v_sin_f32 v233, v233
    v_sin_f32 v235, v235
    v_mul_f32 v232, 0x3d64f92e, v232
    v_mul_f32 v233, 0x3d64f92e, v233
    v_mul_f32 v234, 0x3d64f92e, v234
    v_mfma_f32_16x16x32_bf16 v[36:39], v[92:95], a[212:215], 0
    v_mul_f32 v235, 0x3d64f92e, v235
    v_cvt_pk_bf16_f32 v88, v232, v233
    v_cvt_pk_bf16_f32 v89, v234, v235
    v_alignbit_b32 v90, v88, v88, v100
    v_alignbit_b32 v91, v89, v89, v100
    v_xor_b32 v90, v101, v90
    v_xor_b32 v91, v101, v91
    v_cndmask_b32 v88, v88, v103, vcc
    s_nop 1
    v_mfma_f32_16x16x32_bf16 v[40:43], v[88:91], a[200:203], 0
    v_mul_f32 v254, v232, v249
    v_mul_f32 v255, v234, v249
    v_mul_f32 v232, v232, v248
PAD_180:
    s_cbranch_execz SCB_ret
    v_mul_f32 v234, v234, v248
    buffer_load_dwordx4 a[104:107], v6, s[32:35], s52 offen offset:2048 sc1
    v_fma_f32 v232, -v233, v249, v232
    v_fma_f32 v234, -v235, v249, v234
    v_fma_f32 v233, v233, v248, v254
    v_mfma_f32_16x16x32_bf16 v[44:47], v[88:91], a[204:207], 0
    v_fma_f32 v235, v235, v248, v255
    v_add_f32 v254, 0x42100000, v98
    v_mul_f32 v254, 0xbacccccd, v254
    v_cos_f32 v250, v254
    v_sin_f32 v251, v254
    v_mul_f32 v237, v254, v96
    v_mul_f32 v239, v254, v97
    v_fract_f32 v237, v237
    v_mfma_f32_16x16x32_bf16 v[48:51], v[88:91], a[208:211], 0
    v_fract_f32 v239, v239
    v_cos_f32 v236, v237
    v_cos_f32 v238, v239
    v_sin_f32 v237, v237
    v_sin_f32 v239, v239
    v_mul_f32 v236, 0x3d64f92e, v236
    v_mul_f32 v237, 0x3d64f92e, v237
    buffer_load_dwordx4 a[108:111], v6, s[32:35], s52 offen offset:3072 sc1
    v_mul_f32 v238, 0x3d64f92e, v238
    v_mfma_f32_16x16x32_bf16 v[52:55], v[88:91], a[212:215], 0
    v_mul_f32 v239, 0x3d64f92e, v239
    v_cvt_pk_bf16_f32 v92, v236, v237
    v_cvt_pk_bf16_f32 v93, v238, v239
    v_alignbit_b32 v94, v92, v92, v100
    v_alignbit_b32 v95, v93, v93, v100
    v_xor_b32 v94, v101, v94
    v_xor_b32 v95, v101, v95
    v_cndmask_b32 v92, v92, v103, vcc
    s_nop 1
    v_mfma_f32_16x16x32_bf16 v[56:59], v[92:95], a[200:203], 0
    v_mul_f32 v254, v236, v251
    v_mul_f32 v255, v238, v251
    v_mul_f32 v236, v236, v250
    v_mul_f32 v238, v238, v250
    v_fma_f32 v236, -v237, v251, v236
    v_fma_f32 v238, -v239, v251, v238
SCB_e7:
PAD_181:
    s_cbranch_execz PAD_182
    v_fma_f32 v237, v237, v250, v254
    v_mfma_f32_16x16x32_bf16 v[60:63], v[92:95], a[204:207], 0
    v_fma_f32 v239, v239, v250, v255
    s_mov_b32 s52, 0xc000
    buffer_load_dwordx4 a[112:115], v6, s[32:35], s52 offen offset:0 sc1
    v_add_f32 v254, 0x42800000, v99
    v_mul_f32 v254, 0xbacccccd, v254
    v_cos_f32 v252, v254
    v_sin_f32 v253, v254
    v_mul_f32 v241, v254, v96
    v_mul_f32 v243, v254, v97
    v_fract_f32 v241, v241
    v_mfma_f32_16x16x32_bf16 v[64:67], v[92:95], a[208:211], 0
    v_fract_f32 v243, v243
    v_cos_f32 v240, v241
    v_cos_f32 v242, v243
    v_sin_f32 v241, v241
    v_sin_f32 v243, v243
    v_mul_f32 v240, 0x3d64f92e, v240
    v_mul_f32 v241, 0x3d64f92e, v241
    v_mul_f32 v242, 0x3d64f92e, v242
    v_mfma_f32_16x16x32_bf16 v[68:71], v[92:95], a[212:215], 0
    v_mul_f32 v243, 0x3d64f92e, v243
    v_cvt_pk_bf16_f32 v88, v240, v241
    v_cvt_pk_bf16_f32 v89, v242, v243
    buffer_load_dwordx4 a[116:119], v6, s[32:35], s52 offen offset:1024 sc1
    v_alignbit_b32 v90, v88, v88, v100
    v_alignbit_b32 v91, v89, v89, v100
    v_xor_b32 v90, v101, v90
    v_xor_b32 v91, v101, v91
    v_cndmask_b32 v88, v88, v103, vcc
    s_nop 1
    v_mfma_f32_16x16x32_bf16 v[72:75], v[88:91], a[200:203], 0
    v_mul_f32 v254, v240, v253
    v_mul_f32 v255, v242, v253
    v_mul_f32 v240, v240, v252
    v_mfma_f32_16x16x32_bf16 v[76:79], v[88:91], a[204:207], 0
    v_mul_f32 v242, v242, v252
    v_fma_f32 v240, -v241, v253, v240
    v_fma_f32 v242, -v243, v253, v242
    v_fma_f32 v241, v241, v252, v254
PAD_182:
    s_cbranch_execz PAD_183
    v_mfma_f32_16x16x32_bf16 v[80:83], v[88:91], a[208:211], 0
    v_fma_f32 v243, v243, v252, v255
    v_cvt_pk_bf16_f32 v92, v224, v225
    v_cvt_pk_bf16_f32 v93, v226, v227
    v_mfma_f32_16x16x32_bf16 v[84:87], v[88:91], a[212:215], 0
    v_alignbit_b32 v94, v92, v92, v100
    buffer_load_dwordx4 a[120:123], v6, s[32:35], s52 offen offset:2048 sc1
    v_alignbit_b32 v95, v93, v93, v100
    v_xor_b32 v94, v101, v94
    v_xor_b32 v95, v101, v95
    ds_read_b128 a[200:203], v109 offset:8192
    ds_read_b128 a[204:207], v109 offset:8448
    ds_read_b128 a[208:211], v109 offset:8704
    ds_read_b128 a[212:215], v109 offset:8960
    s_waitcnt lgkmcnt(15)
    v_mfma_f32_16x16x32_bf16 v[8:11], v[92:95], a[216:219], v[8:11]
    v_xor_b32 v96, v102, v92
    v_xor_b32 v97, v102, v93
    s_waitcnt lgkmcnt(14)
    v_mfma_f32_16x16x32_bf16 v[12:15], v[92:95], a[220:223], v[12:15]
    v_xor_b32 v98, v102, v94
    v_xor_b32 v99, v102, v95
    s_waitcnt lgkmcnt(13)
    v_mfma_f32_16x16x32_bf16 v[16:19], v[92:95], a[224:227], v[16:19]
    v_mul_f32 v254, v224, v245
    v_mul_f32 v255, v226, v245
    s_waitcnt lgkmcnt(12)
    v_mfma_f32_16x16x32_bf16 v[20:23], v[92:95], a[228:231], v[20:23]
    v_mul_f32 v224, v224, v244
    v_mul_f32 v226, v226, v244
    v_fma_f32 v224, -v225, v245, v224
    buffer_load_dwordx4 a[124:127], v6, s[32:35], s52 offen offset:3072 sc1
    s_waitcnt lgkmcnt(11)
    v_mfma_f32_16x16x32_bf16 v[8:11], v[96:99], a[176:179], v[8:11]
    v_cvt_pk_bf16_f32 v88, v228, v229
    v_cvt_pk_bf16_f32 v89, v230, v231
    s_waitcnt lgkmcnt(10)
    v_mfma_f32_16x16x32_bf16 v[12:15], v[96:99], a[180:183], v[12:15]
    v_alignbit_b32 v90, v88, v88, v100
PAD_183:
    s_cbranch_execz PAD_184
    v_alignbit_b32 v91, v89, v89, v100
    s_waitcnt lgkmcnt(9)
    v_mfma_f32_16x16x32_bf16 v[16:19], v[96:99], a[184:187], v[16:19]
    v_xor_b32 v90, v101, v90
    v_xor_b32 v91, v101, v91
    s_waitcnt lgkmcnt(8)
    v_mfma_f32_16x16x32_bf16 v[20:23], v[96:99], a[188:191], v[20:23]
    v_fma_f32 v226, -v227, v245, v226
    v_fma_f32 v225, v225, v244, v254
    v_fma_f32 v227, v227, v244, v255
    v_mfma_f32_16x16x32_bf16 v[24:27], v[88:91], a[216:219], v[24:27]
    v_xor_b32 v96, v102, v88
    v_xor_b32 v97, v102, v89
    v_mfma_f32_16x16x32_bf16 v[28:31], v[88:91], a[220:223], v[28:31]
    v_xor_b32 v98, v102, v90
    v_xor_b32 v99, v102, v91
    v_mfma_f32_16x16x32_bf16 v[32:35], v[88:91], a[224:227], v[32:35]
    s_mov_b32 s52, 0xd000
    buffer_load_dwordx4 a[128:131], v6, s[32:35], s52 offen offset:0 sc1
    v_mul_f32 v254, v228, v247
    v_mul_f32 v255, v230, v247
    v_mfma_f32_16x16x32_bf16 v[36:39], v[88:91], a[228:231], v[36:39]
    v_mul_f32 v228, v228, v246
    v_mul_f32 v230, v230, v246
    v_fma_f32 v228, -v229, v247, v228
    v_mfma_f32_16x16x32_bf16 v[24:27], v[96:99], a[176:179], v[24:27]
    v_cvt_pk_bf16_f32 v92, v232, v233
    v_cvt_pk_bf16_f32 v93, v234, v235
    v_mfma_f32_16x16x32_bf16 v[28:31], v[96:99], a[180:183], v[28:31]
    v_alignbit_b32 v94, v92, v92, v100
    v_alignbit_b32 v95, v93, v93, v100
    v_mfma_f32_16x16x32_bf16 v[32:35], v[96:99], a[184:187], v[32:35]
    v_xor_b32 v94, v101, v94
    v_xor_b32 v95, v101, v95
    v_mfma_f32_16x16x32_bf16 v[36:39], v[96:99], a[188:191], v[36:39]
    v_fma_f32 v230, -v231, v247, v230
    v_fma_f32 v229, v229, v246, v254
    v_fma_f32 v231, v231, v246, v255
    v_mfma_f32_16x16x32_bf16 v[40:43], v[92:95], a[216:219], v[40:43]
PAD_184:
    s_cbranch_execz SCB_ret
    buffer_load_dwordx4 a[132:135], v6, s[32:35], s52 offen offset:1024 sc1
    v_xor_b32 v96, v102, v92
    v_xor_b32 v97, v102, v93
    v_mfma_f32_16x16x32_bf16 v[44:47], v[92:95], a[220:223], v[44:47]
    v_xor_b32 v98, v102, v94
    v_xor_b32 v99, v102, v95
    v_mfma_f32_16x16x32_bf16 v[48:51], v[92:95], a[224:227], v[48:51]
    v_mul_f32 v254, v232, v249
    v_mul_f32 v255, v234, v249
    v_mfma_f32_16x16x32_bf16 v[52:55], v[92:95], a[228:231], v[52:55]
    v_mul_f32 v232, v232, v248
    v_mul_f32 v234, v234, v248
    v_fma_f32 v232, -v233, v249, v232
    v_mfma_f32_16x16x32_bf16 v[40:43], v[96:99], a[176:179], v[40:43]
    v_cvt_pk_bf16_f32 v88, v236, v237
    v_cvt_pk_bf16_f32 v89, v238, v239
    v_mfma_f32_16x16x32_bf16 v[44:47], v[96:99], a[180:183], v[44:47]
    v_alignbit_b32 v90, v88, v88, v100
    v_alignbit_b32 v91, v89, v89, v100
    v_mfma_f32_16x16x32_bf16 v[48:51], v[96:99], a[184:187], v[48:51]
    v_xor_b32 v90, v101, v90
    buffer_load_dwordx4 a[136:139], v6, s[32:35], s52 offen offset:2048 sc1
    v_xor_b32 v91, v101, v91
    v_mfma_f32_16x16x32_bf16 v[52:55], v[96:99], a[188:191], v[52:55]
    v_fma_f32 v234, -v235, v249, v234
    v_fma_f32 v233, v233, v248, v254
    v_fma_f32 v235, v235, v248, v255
    v_mfma_f32_16x16x32_bf16 v[56:59], v[88:91], a[216:219], v[56:59]
    v_xor_b32 v96, v102, v88
    v_xor_b32 v97, v102, v89
    v_mfma_f32_16x16x32_bf16 v[60:63], v[88:91], a[220:223], v[60:63]
    v_xor_b32 v98, v102, v90
    v_xor_b32 v99, v102, v91
    v_mfma_f32_16x16x32_bf16 v[64:67], v[88:91], a[224:227], v[64:67]
    v_mul_f32 v254, v236, v251
    v_mul_f32 v255, v238, v251
    v_mfma_f32_16x16x32_bf16 v[68:71], v[88:91], a[228:231], v[68:71]
    v_mul_f32 v236, v236, v250
    v_mul_f32 v238, v238, v250
    v_fma_f32 v236, -v237, v251, v236
SCB_e19:
PAD_185:
    s_cbranch_execz PAD_186
    v_mfma_f32_16x16x32_bf16 v[56:59], v[96:99], a[176:179], v[56:59]
    v_cvt_pk_bf16_f32 v92, v240, v241
    buffer_load_dwordx4 a[140:143], v6, s[32:35], s52 offen offset:3072 sc1
    v_cvt_pk_bf16_f32 v93, v242, v243
    v_mfma_f32_16x16x32_bf16 v[60:63], v[96:99], a[180:183], v[60:63]
    v_alignbit_b32 v94, v92, v92, v100
    v_alignbit_b32 v95, v93, v93, v100
    v_mfma_f32_16x16x32_bf16 v[64:67], v[96:99], a[184:187], v[64:67]
    v_xor_b32 v94, v101, v94
    v_xor_b32 v95, v101, v95
    v_mfma_f32_16x16x32_bf16 v[68:71], v[96:99], a[188:191], v[68:71]
    v_fma_f32 v238, -v239, v251, v238
    v_fma_f32 v237, v237, v250, v254
    v_fma_f32 v239, v239, v250, v255
    v_mfma_f32_16x16x32_bf16 v[72:75], v[92:95], a[216:219], v[72:75]
    v_xor_b32 v96, v102, v92
    v_xor_b32 v97, v102, v93
    v_mfma_f32_16x16x32_bf16 v[76:79], v[92:95], a[220:223], v[76:79]
    v_xor_b32 v98, v102, v94
    v_xor_b32 v99, v102, v95
    v_mfma_f32_16x16x32_bf16 v[80:83], v[92:95], a[224:227], v[80:83]
    v_mul_f32 v254, v240, v253
    v_mul_f32 v255, v242, v253
    s_mov_b32 s52, 0xe000
    buffer_load_dwordx4 a[144:147], v6, s[32:35], s52 offen offset:0 sc1
    v_mfma_f32_16x16x32_bf16 v[84:87], v[92:95], a[228:231], v[84:87]
    v_mul_f32 v240, v240, v252
    v_mul_f32 v242, v242, v252
    v_fma_f32 v240, -v241, v253, v240
    v_mfma_f32_16x16x32_bf16 v[72:75], v[96:99], a[176:179], v[72:75]
    v_cvt_pk_bf16_f32 v88, v224, v225
    v_cvt_pk_bf16_f32 v89, v226, v227
    v_mfma_f32_16x16x32_bf16 v[76:79], v[96:99], a[180:183], v[76:79]
    v_alignbit_b32 v90, v88, v88, v100
    v_alignbit_b32 v91, v89, v89, v100
    v_mfma_f32_16x16x32_bf16 v[80:83], v[96:99], a[184:187], v[80:83]
    v_xor_b32 v90, v101, v90
PAD_186:
    s_cbranch_execz PAD_187
    v_xor_b32 v91, v101, v91
    v_mfma_f32_16x16x32_bf16 v[84:87], v[96:99], a[188:191], v[84:87]
    v_fma_f32 v242, -v243, v253, v242
    v_fma_f32 v241, v241, v252, v254
    v_fma_f32 v243, v243, v252, v255
    ds_read_b128 a[216:219], v109 offset:12288
    ds_read_b128 a[220:223], v109 offset:12544
    ds_read_b128 a[224:227], v109 offset:12800
    buffer_load_dwordx4 a[148:151], v6, s[32:35], s52 offen offset:1024 sc1
    ds_read_b128 a[228:231], v109 offset:13056
    ds_read_b128 a[176:179], v109 offset:53248
    ds_read_b128 a[180:183], v109 offset:53504
    ds_read_b128 a[184:187], v109 offset:53760
    ds_read_b128 a[188:191], v109 offset:54016
    s_waitcnt lgkmcnt(11)
    v_mfma_f32_16x16x32_bf16 v[8:11], v[88:91], a[200:203], v[8:11]
    v_xor_b32 v96, v102, v88
    v_xor_b32 v97, v102, v89
    s_waitcnt lgkmcnt(10)
    v_mfma_f32_16x16x32_bf16 v[12:15], v[88:91], a[204:207], v[12:15]
    v_xor_b32 v98, v102, v90
    v_xor_b32 v99, v102, v91
    s_waitcnt lgkmcnt(9)
    v_mfma_f32_16x16x32_bf16 v[16:19], v[88:91], a[208:211], v[16:19]
    v_mul_f32 v254, v224, v245
    v_mul_f32 v255, v226, v245
    s_waitcnt lgkmcnt(8)
    v_mfma_f32_16x16x32_bf16 v[20:23], v[88:91], a[212:215], v[20:23]
    v_mul_f32 v224, v224, v244
    v_mul_f32 v226, v226, v244
    v_fma_f32 v224, -v225, v245, v224
    v_mfma_f32_16x16x32_bf16 v[8:11], v[96:99], a[160:163], v[8:11]
    v_cvt_pk_bf16_f32 v92, v228, v229
    buffer_load_dwordx4 a[152:155], v6, s[32:35], s52 offen offset:2048 sc1
    v_cvt_pk_bf16_f32 v93, v230, v231
    v_mfma_f32_16x16x32_bf16 v[12:15], v[96:99], a[164:167], v[12:15]
    v_alignbit_b32 v94, v92, v92, v100
    v_alignbit_b32 v95, v93, v93, v100
PAD_187:
    s_cbranch_execz SCB_ret
    v_mfma_f32_16x16x32_bf16 v[16:19], v[96:99], a[168:171], v[16:19]
    v_xor_b32 v94, v101, v94
    v_xor_b32 v95, v101, v95
    v_mfma_f32_16x16x32_bf16 v[20:23], v[96:99], a[172:175], v[20:23]
    v_fma_f32 v226, -v227, v245, v226
    v_fma_f32 v225, v225, v244, v254
    v_fma_f32 v227, v227, v244, v255
    v_mfma_f32_16x16x32_bf16 v[24:27], v[92:95], a[200:203], v[24:27]
    v_xor_b32 v96, v102, v92
    v_xor_b32 v97, v102, v93
    v_mfma_f32_16x16x32_bf16 v[28:31], v[92:95], a[204:207], v[28:31]
    v_xor_b32 v98, v102, v94
    v_xor_b32 v99, v102, v95
    v_mfma_f32_16x16x32_bf16 v[32:35], v[92:95], a[208:211], v[32:35]
    v_mul_f32 v254, v228, v247
    v_mul_f32 v255, v230, v247
    buffer_load_dwordx4 a[156:159], v6, s[32:35], s52 offen offset:3072 sc1
    v_mfma_f32_16x16x32_bf16 v[36:39], v[92:95], a[212:215], v[36:39]
    v_mul_f32 v228, v228, v246
    v_mul_f32 v230, v230, v246
    v_fma_f32 v228, -v229, v247, v228
    v_mfma_f32_16x16x32_bf16 v[24:27], v[96:99], a[160:163], v[24:27]
    v_cvt_pk_bf16_f32 v88, v232, v233
    v_cvt_pk_bf16_f32 v89, v234, v235
    v_mfma_f32_16x16x32_bf16 v[28:31], v[96:99], a[164:167], v[28:31]
    v_alignbit_b32 v90, v88, v88, v100
    v_alignbit_b32 v91, v89, v89, v100
    v_mfma_f32_16x16x32_bf16 v[32:35], v[96:99], a[168:171], v[32:35]
    v_xor_b32 v90, v101, v90
    v_xor_b32 v91, v101, v91
    v_mfma_f32_16x16x32_bf16 v[36:39], v[96:99], a[172:175], v[36:39]
    v_fma_f32 v230, -v231, v247, v230
    v_fma_f32 v229, v229, v246, v254
    v_fma_f32 v231, v231, v246, v255
    v_mfma_f32_16x16x32_bf16 v[40:43], v[88:91], a[200:203], v[40:43]
    v_xor_b32 v96, v102, v88
    v_xor_b32 v97, v102, v89
    v_mfma_f32_16x16x32_bf16 v[44:47], v[88:91], a[204:207], v[44:47]
    v_xor_b32 v98, v102, v90
SCB_e31:
PAD_188:
    s_cbranch_execz PAD_189
    v_xor_b32 v99, v102, v91
    v_mfma_f32_16x16x32_bf16 v[48:51], v[88:91], a[208:211], v[48:51]
    v_mul_f32 v254, v232, v249
    v_mul_f32 v255, v234, v249
    v_mfma_f32_16x16x32_bf16 v[52:55], v[88:91], a[212:215], v[52:55]
    v_mul_f32 v232, v232, v248
    v_mul_f32 v234, v234, v248
    v_fma_f32 v232, -v233, v249, v232
    v_mfma_f32_16x16x32_bf16 v[40:43], v[96:99], a[160:163], v[40:43]
    v_cvt_pk_bf16_f32 v92, v236, v237
    v_cvt_pk_bf16_f32 v93, v238, v239
    v_mfma_f32_16x16x32_bf16 v[44:47], v[96:99], a[164:167], v[44:47]
    v_alignbit_b32 v94, v92, v92, v100
    v_alignbit_b32 v95, v93, v93, v100
    v_mfma_f32_16x16x32_bf16 v[48:51], v[96:99], a[168:171], v[48:51]
    v_xor_b32 v94, v101, v94
    v_xor_b32 v95, v101, v95
    v_mfma_f32_16x16x32_bf16 v[52:55], v[96:99], a[172:175], v[52:55]
    v_fma_f32 v234, -v235, v249, v234
    v_fma_f32 v233, v233, v248, v254
    v_fma_f32 v235, v235, v248, v255
    v_mfma_f32_16x16x32_bf16 v[56:59], v[92:95], a[200:203], v[56:59]
    v_xor_b32 v96, v102, v92
    v_xor_b32 v97, v102, v93
    v_mfma_f32_16x16x32_bf16 v[60:63], v[92:95], a[204:207], v[60:63]
    v_xor_b32 v98, v102, v94
    v_xor_b32 v99, v102, v95
    v_mfma_f32_16x16x32_bf16 v[64:67], v[92:95], a[208:211], v[64:67]
    v_mul_f32 v254, v236, v251
    v_mul_f32 v255, v238, v251
    v_mfma_f32_16x16x32_bf16 v[68:71], v[92:95], a[212:215], v[68:71]
    v_mul_f32 v236, v236, v250
    v_mul_f32 v238, v238, v250
    v_fma_f32 v236, -v237, v251, v236
    v_mfma_f32_16x16x32_bf16 v[56:59], v[96:99], a[160:163], v[56:59]
    v_cvt_pk_bf16_f32 v88, v240, v241
    v_cvt_pk_bf16_f32 v89, v242, v243
    v_mfma_f32_16x16x32_bf16 v[60:63], v[96:99], a[164:167], v[60:63]
    v_alignbit_b32 v90, v88, v88, v100
PAD_189:
    s_cbranch_execz PAD_190
    v_alignbit_b32 v91, v89, v89, v100
    v_mfma_f32_16x16x32_bf16 v[64:67], v[96:99], a[168:171], v[64:67]
    v_xor_b32 v90, v101, v90
    v_xor_b32 v91, v101, v91
    v_mfma_f32_16x16x32_bf16 v[68:71], v[96:99], a[172:175], v[68:71]
    v_fma_f32 v238, -v239, v251, v238
    v_fma_f32 v237, v237, v250, v254
    v_fma_f32 v239, v239, v250, v255
    v_mfma_f32_16x16x32_bf16 v[72:75], v[88:91], a[200:203], v[72:75]
    v_xor_b32 v96, v102, v88
    v_xor_b32 v97, v102, v89
    v_mfma_f32_16x16x32_bf16 v[76:79], v[88:91], a[204:207], v[76:79]
    v_xor_b32 v98, v102, v90
    v_xor_b32 v99, v102, v91
    v_mfma_f32_16x16x32_bf16 v[80:83], v[88:91], a[208:211], v[80:83]
    v_mul_f32 v254, v240, v253
    v_mul_f32 v255, v242, v253
    v_mfma_f32_16x16x32_bf16 v[84:87], v[88:91], a[212:215], v[84:87]
    v_mul_f32 v240, v240, v252
    v_mul_f32 v242, v242, v252
    v_fma_f32 v240, -v241, v253, v240
    v_mfma_f32_16x16x32_bf16 v[72:75], v[96:99], a[160:163], v[72:75]
    v_cvt_pk_bf16_f32 v92, v224, v225
    v_cvt_pk_bf16_f32 v93, v226, v227
    v_mfma_f32_16x16x32_bf16 v[76:79], v[96:99], a[164:167], v[76:79]
    v_alignbit_b32 v94, v92, v92, v100
    v_alignbit_b32 v95, v93, v93, v100
    v_mfma_f32_16x16x32_bf16 v[80:83], v[96:99], a[168:171], v[80:83]
    v_xor_b32 v94, v101, v94
    v_xor_b32 v95, v101, v95
    v_mfma_f32_16x16x32_bf16 v[84:87], v[96:99], a[172:175], v[84:87]
    v_fma_f32 v242, -v243, v253, v242
    v_fma_f32 v241, v241, v252, v254
    v_fma_f32 v243, v243, v252, v255
    ds_read_b128 a[200:203], v109 offset:16384
    ds_read_b128 a[204:207], v109 offset:16640
    ds_read_b128 a[208:211], v109 offset:16896
    ds_read_b128 a[212:215], v109 offset:17152
PAD_190:
    s_cbranch_execz PAD_191
    ds_read_b128 a[160:163], v109 offset:57344
    ds_read_b128 a[164:167], v109 offset:57600
    ds_read_b128 a[168:171], v109 offset:57856
    ds_read_b128 a[172:175], v109 offset:58112
    s_waitcnt lgkmcnt(15)
    v_mfma_f32_16x16x32_bf16 v[8:11], v[92:95], a[216:219], v[8:11]
    v_xor_b32 v96, v102, v92
    v_xor_b32 v97, v102, v93
    s_waitcnt lgkmcnt(14)
    v_mfma_f32_16x16x32_bf16 v[12:15], v[92:95], a[220:223], v[12:15]
    v_xor_b32 v98, v102, v94
    v_xor_b32 v99, v102, v95
    s_waitcnt lgkmcnt(13)
    v_mfma_f32_16x16x32_bf16 v[16:19], v[92:95], a[224:227], v[16:19]
    v_mul_f32 v254, v224, v245
    v_mul_f32 v255, v226, v245
    s_waitcnt lgkmcnt(12)
    v_mfma_f32_16x16x32_bf16 v[20:23], v[92:95], a[228:231], v[20:23]
    v_mul_f32 v224, v224, v244
    v_mul_f32 v226, v226, v244
    v_fma_f32 v224, -v225, v245, v224
    s_waitcnt lgkmcnt(11)
    v_mfma_f32_16x16x32_bf16 v[8:11], v[96:99], a[176:179], v[8:11]
    v_cvt_pk_bf16_f32 v88, v228, v229
    v_cvt_pk_bf16_f32 v89, v230, v231
    s_waitcnt lgkmcnt(10)
    v_mfma_f32_16x16x32_bf16 v[12:15], v[96:99], a[180:183], v[12:15]
    v_alignbit_b32 v90, v88, v88, v100
    v_alignbit_b32 v91, v89, v89, v100
    s_waitcnt lgkmcnt(9)
    v_mfma_f32_16x16x32_bf16 v[16:19], v[96:99], a[184:187], v[16:19]
    v_xor_b32 v90, v101, v90
    v_xor_b32 v91, v101, v91
    s_waitcnt lgkmcnt(8)
    v_mfma_f32_16x16x32_bf16 v[20:23], v[96:99], a[188:191], v[20:23]
    v_fma_f32 v226, -v227, v245, v226
    v_fma_f32 v225, v225, v244, v254
    v_fma_f32 v227, v227, v244, v255
    v_mfma_f32_16x16x32_bf16 v[24:27], v[88:91], a[216:219], v[24:27]
    v_xor_b32 v96, v102, v88
    v_xor_b32 v97, v102, v89
PAD_191:
    s_cbranch_execz SCB_ret
    v_mfma_f32_16x16x32_bf16 v[28:31], v[88:91], a[220:223], v[28:31]
    v_xor_b32 v98, v102, v90
    v_xor_b32 v99, v102, v91
    v_mfma_f32_16x16x32_bf16 v[32:35], v[88:91], a[224:227], v[32:35]
    v_mul_f32 v254, v228, v247
    v_mul_f32 v255, v230, v247
    v_mfma_f32_16x16x32_bf16 v[36:39], v[88:91], a[228:231], v[36:39]
    v_mul_f32 v228, v228, v246
    v_mul_f32 v230, v230, v246
    v_fma_f32 v228, -v229, v247, v228
    v_mfma_f32_16x16x32_bf16 v[24:27], v[96:99], a[176:179], v[24:27]
    v_cvt_pk_bf16_f32 v92, v232, v233
    v_cvt_pk_bf16_f32 v93, v234, v235
    v_mfma_f32_16x16x32_bf16 v[28:31], v[96:99], a[180:183], v[28:31]
    v_alignbit_b32 v94, v92, v92, v100
    v_alignbit_b32 v95, v93, v93, v100
    v_mfma_f32_16x16x32_bf16 v[32:35], v[96:99], a[184:187], v[32:35]
    s_mov_b32 s48, 0x0
    buffer_load_dwordx4 v[192:195], v7, s[32:35], s48 offen offset:0 sc1
    v_xor_b32 v94, v101, v94
    v_xor_b32 v95, v101, v95
    v_mfma_f32_16x16x32_bf16 v[36:39], v[96:99], a[188:191], v[36:39]
    v_fma_f32 v230, -v231, v247, v230
    v_fma_f32 v229, v229, v246, v254
    v_fma_f32 v231, v231, v246, v255
    v_mfma_f32_16x16x32_bf16 v[40:43], v[92:95], a[216:219], v[40:43]
    v_xor_b32 v96, v102, v92
    v_xor_b32 v97, v102, v93
    v_mfma_f32_16x16x32_bf16 v[44:47], v[92:95], a[220:223], v[44:47]
    v_xor_b32 v98, v102, v94
    v_xor_b32 v99, v102, v95
    v_mfma_f32_16x16x32_bf16 v[48:51], v[92:95], a[224:227], v[48:51]
    v_mul_f32 v254, v232, v249
    v_mul_f32 v255, v234, v249
    v_mfma_f32_16x16x32_bf16 v[52:55], v[92:95], a[228:231], v[52:55]
    v_mul_f32 v232, v232, v248
    v_mul_f32 v234, v234, v248
    v_fma_f32 v232, -v233, v249, v232
    v_mfma_f32_16x16x32_bf16 v[40:43], v[96:99], a[176:179], v[40:43]
    buffer_load_dwordx4 v[196:199], v7, s[32:35], s48 offen offset:256 sc1
SCB_e43:
PAD_192:
    s_cbranch_execz PAD_193
    v_cvt_pk_bf16_f32 v88, v236, v237
    v_cvt_pk_bf16_f32 v89, v238, v239
    v_mfma_f32_16x16x32_bf16 v[44:47], v[96:99], a[180:183], v[44:47]
    v_alignbit_b32 v90, v88, v88, v100
    v_alignbit_b32 v91, v89, v89, v100
    v_mfma_f32_16x16x32_bf16 v[48:51], v[96:99], a[184:187], v[48:51]
    v_xor_b32 v90, v101, v90
    v_xor_b32 v91, v101, v91
    v_mfma_f32_16x16x32_bf16 v[52:55], v[96:99], a[188:191], v[52:55]
    v_fma_f32 v234, -v235, v249, v234
    v_fma_f32 v233, v233, v248, v254
    v_fma_f32 v235, v235, v248, v255
    v_mfma_f32_16x16x32_bf16 v[56:59], v[88:91], a[216:219], v[56:59]
    v_xor_b32 v96, v102, v88
    v_xor_b32 v97, v102, v89
    v_mfma_f32_16x16x32_bf16 v[60:63], v[88:91], a[220:223], v[60:63]
    v_xor_b32 v98, v102, v90
    v_xor_b32 v99, v102, v91
    v_mfma_f32_16x16x32_bf16 v[64:67], v[88:91], a[224:227], v[64:67]
    v_mul_f32 v254, v236, v251
    buffer_load_dwordx4 v[200:203], v7, s[32:35], s48 offen offset:512 sc1
    v_mul_f32 v255, v238, v251
    v_mfma_f32_16x16x32_bf16 v[68:71], v[88:91], a[228:231], v[68:71]
    v_mul_f32 v236, v236, v250
    v_mul_f32 v238, v238, v250
    v_fma_f32 v236, -v237, v251, v236
    v_mfma_f32_16x16x32_bf16 v[56:59], v[96:99], a[176:179], v[56:59]
    v_cvt_pk_bf16_f32 v92, v240, v241
    v_cvt_pk_bf16_f32 v93, v242, v243
    v_mfma_f32_16x16x32_bf16 v[60:63], v[96:99], a[180:183], v[60:63]
    v_alignbit_b32 v94, v92, v92, v100
    v_alignbit_b32 v95, v93, v93, v100
    v_mfma_f32_16x16x32_bf16 v[64:67], v[96:99], a[184:187], v[64:67]
    v_xor_b32 v94, v101, v94
    v_xor_b32 v95, v101, v95
    v_mfma_f32_16x16x32_bf16 v[68:71], v[96:99], a[188:191], v[68:71]
    v_fma_f32 v238, -v239, v251, v238
    v_fma_f32 v237, v237, v250, v254
PAD_193:
    s_cbranch_execz PAD_194
    v_fma_f32 v239, v239, v250, v255
    v_mfma_f32_16x16x32_bf16 v[72:75], v[92:95], a[216:219], v[72:75]
    v_xor_b32 v96, v102, v92
    buffer_load_dwordx4 v[204:207], v7, s[32:35], s48 offen offset:768 sc1
    v_xor_b32 v97, v102, v93
    v_mfma_f32_16x16x32_bf16 v[76:79], v[92:95], a[220:223], v[76:79]
    v_xor_b32 v98, v102, v94
    v_xor_b32 v99, v102, v95
    v_mfma_f32_16x16x32_bf16 v[80:83], v[92:95], a[224:227], v[80:83]
    v_mul_f32 v254, v240, v253
    v_mul_f32 v255, v242, v253
    v_mfma_f32_16x16x32_bf16 v[84:87], v[92:95], a[228:231], v[84:87]
    v_mul_f32 v240, v240, v252
    v_mul_f32 v242, v242, v252
    v_fma_f32 v240, -v241, v253, v240
    v_mfma_f32_16x16x32_bf16 v[72:75], v[96:99], a[176:179], v[72:75]
    v_cvt_pk_bf16_f32 v88, v224, v225
    v_cvt_pk_bf16_f32 v89, v226, v227
    v_mfma_f32_16x16x32_bf16 v[76:79], v[96:99], a[180:183], v[76:79]
    v_alignbit_b32 v90, v88, v88, v100
    v_alignbit_b32 v91, v89, v89, v100
    v_mfma_f32_16x16x32_bf16 v[80:83], v[96:99], a[184:187], v[80:83]
    v_xor_b32 v90, v101, v90
    v_xor_b32 v91, v101, v91
    s_mov_b32 s48, 0x1000
    buffer_load_dwordx4 v[208:211], v7, s[32:35], s48 offen offset:0 sc1
    v_mfma_f32_16x16x32_bf16 v[84:87], v[96:99], a[188:191], v[84:87]
    v_fma_f32 v242, -v243, v253, v242
    v_fma_f32 v241, v241, v252, v254
    v_fma_f32 v243, v243, v252, v255
    ds_read_b128 a[216:219], v109 offset:20480
    ds_read_b128 a[220:223], v109 offset:20736
    ds_read_b128 a[224:227], v109 offset:20992
    ds_read_b128 a[228:231], v109 offset:21248
    ds_read_b128 a[176:179], v109 offset:61440
    ds_read_b128 a[180:183], v109 offset:61696
PAD_194:
    s_cbranch_execz PAD_195
    ds_read_b128 a[184:187], v109 offset:61952
    ds_read_b128 a[188:191], v109 offset:62208
    s_waitcnt lgkmcnt(15)
    v_mfma_f32_16x16x32_bf16 v[8:11], v[88:91], a[200:203], v[8:11]
    v_xor_b32 v96, v102, v88
    v_xor_b32 v97, v102, v89
    s_waitcnt lgkmcnt(14)
    v_mfma_f32_16x16x32_bf16 v[12:15], v[88:91], a[204:207], v[12:15]
    v_xor_b32 v98, v102, v90
    v_xor_b32 v99, v102, v91
    s_waitcnt lgkmcnt(13)
    v_mfma_f32_16x16x32_bf16 v[16:19], v[88:91], a[208:211], v[16:19]
    v_mul_f32 v254, v224, v245
    buffer_load_dwordx4 v[212:215], v7, s[32:35], s48 offen offset:256 sc1
    v_mul_f32 v255, v226, v245
    s_waitcnt lgkmcnt(12)
    v_mfma_f32_16x16x32_bf16 v[20:23], v[88:91], a[212:215], v[20:23]
    v_mul_f32 v224, v224, v244
    v_mul_f32 v226, v226, v244
    v_fma_f32 v224, -v225, v245, v224
    s_waitcnt lgkmcnt(11)
    v_mfma_f32_16x16x32_bf16 v[8:11], v[96:99], a[160:163], v[8:11]
    v_cvt_pk_bf16_f32 v92, v228, v229
    v_cvt_pk_bf16_f32 v93, v230, v231
    s_waitcnt lgkmcnt(10)
    v_mfma_f32_16x16x32_bf16 v[12:15], v[96:99], a[164:167], v[12:15]
    v_alignbit_b32 v94, v92, v92, v100
    v_alignbit_b32 v95, v93, v93, v100
    s_waitcnt lgkmcnt(9)
    v_mfma_f32_16x16x32_bf16 v[16:19], v[96:99], a[168:171], v[16:19]
    v_xor_b32 v94, v101, v94
    v_xor_b32 v95, v101, v95
    s_waitcnt lgkmcnt(8)
    v_mfma_f32_16x16x32_bf16 v[20:23], v[96:99], a[172:175], v[20:23]
    v_fma_f32 v226, -v227, v245, v226
    v_fma_f32 v225, v225, v244, v254
    v_fma_f32 v227, v227, v244, v255
    v_mfma_f32_16x16x32_bf16 v[24:27], v[92:95], a[200:203], v[24:27]
    v_xor_b32 v96, v102, v92
    buffer_load_dwordx4 v[216:219], v7, s[32:35], s48 offen offset:512 sc1
    v_xor_b32 v97, v102, v93
    v_mfma_f32_16x16x32_bf16 v[28:31], v[92:95], a[204:207], v[28:31]
PAD_195:
    s_cbranch_execz SCB_ret
    v_xor_b32 v98, v102, v94
    v_xor_b32 v99, v102, v95
    v_mfma_f32_16x16x32_bf16 v[32:35], v[92:95], a[208:211], v[32:35]
    v_mul_f32 v254, v228, v247
    v_mul_f32 v255, v230, v247
    v_mfma_f32_16x16x32_bf16 v[36:39], v[92:95], a[212:215], v[36:39]
    v_mul_f32 v228, v228, v246
    v_mul_f32 v230, v230, v246
    v_fma_f32 v228, -v229, v247, v228
    v_mfma_f32_16x16x32_bf16 v[24:27], v[96:99], a[160:163], v[24:27]
    v_cvt_pk_bf16_f32 v88, v232, v233
    v_cvt_pk_bf16_f32 v89, v234, v235
    v_mfma_f32_16x16x32_bf16 v[28:31], v[96:99], a[164:167], v[28:31]
    v_alignbit_b32 v90, v88, v88, v100
    v_alignbit_b32 v91, v89, v89, v100
    v_mfma_f32_16x16x32_bf16 v[32:35], v[96:99], a[168:171], v[32:35]
    v_xor_b32 v90, v101, v90
    v_xor_b32 v91, v101, v91
    buffer_load_dwordx4 v[220:223], v7, s[32:35], s48 offen offset:768 sc1
    v_mfma_f32_16x16x32_bf16 v[36:39], v[96:99], a[172:175], v[36:39]
    v_fma_f32 v230, -v231, v247, v230
    v_fma_f32 v229, v229, v246, v254
    v_fma_f32 v231, v231, v246, v255
    v_mfma_f32_16x16x32_bf16 v[40:43], v[88:91], a[200:203], v[40:43]
    v_xor_b32 v96, v102, v88
    v_xor_b32 v97, v102, v89
    v_mfma_f32_16x16x32_bf16 v[44:47], v[88:91], a[204:207], v[44:47]
    v_xor_b32 v98, v102, v90
    v_xor_b32 v99, v102, v91
    v_mfma_f32_16x16x32_bf16 v[48:51], v[88:91], a[208:211], v[48:51]
    v_mul_f32 v254, v232, v249
    v_mul_f32 v255, v234, v249
    v_mfma_f32_16x16x32_bf16 v[52:55], v[88:91], a[212:215], v[52:55]
    v_mul_f32 v232, v232, v248
    v_mul_f32 v234, v234, v248
    v_fma_f32 v232, -v233, v249, v232
    v_mfma_f32_16x16x32_bf16 v[40:43], v[96:99], a[160:163], v[40:43]
    v_cvt_pk_bf16_f32 v92, v236, v237
    v_cvt_pk_bf16_f32 v93, v238, v239
SCB_e8:
PAD_196:
    s_cbranch_execz PAD_197
    v_mfma_f32_16x16x32_bf16 v[44:47], v[96:99], a[164:167], v[44:47]
    v_alignbit_b32 v94, v92, v92, v100
    v_alignbit_b32 v95, v93, v93, v100
    v_mfma_f32_16x16x32_bf16 v[48:51], v[96:99], a[168:171], v[48:51]
    v_xor_b32 v94, v101, v94
    v_xor_b32 v95, v101, v95
    v_mfma_f32_16x16x32_bf16 v[52:55], v[96:99], a[172:175], v[52:55]
    v_fma_f32 v234, -v235, v249, v234
    v_fma_f32 v233, v233, v248, v254
    v_fma_f32 v235, v235, v248, v255
    v_mfma_f32_16x16x32_bf16 v[56:59], v[92:95], a[200:203], v[56:59]
    v_xor_b32 v96, v102, v92
    v_xor_b32 v97, v102, v93
    v_mfma_f32_16x16x32_bf16 v[60:63], v[92:95], a[204:207], v[60:63]
    v_xor_b32 v98, v102, v94
    v_xor_b32 v99, v102, v95
    v_mfma_f32_16x16x32_bf16 v[64:67], v[92:95], a[208:211], v[64:67]
    v_mul_f32 v254, v236, v251
    v_mul_f32 v255, v238, v251
    v_mfma_f32_16x16x32_bf16 v[68:71], v[92:95], a[212:215], v[68:71]
    v_mul_f32 v236, v236, v250
    v_mul_f32 v238, v238, v250
    v_fma_f32 v236, -v237, v251, v236
    v_mfma_f32_16x16x32_bf16 v[56:59], v[96:99], a[160:163], v[56:59]
    v_cvt_pk_bf16_f32 v88, v240, v241
    v_cvt_pk_bf16_f32 v89, v242, v243
    v_mfma_f32_16x16x32_bf16 v[60:63], v[96:99], a[164:167], v[60:63]
    v_alignbit_b32 v90, v88, v88, v100
    v_alignbit_b32 v91, v89, v89, v100
    v_mfma_f32_16x16x32_bf16 v[64:67], v[96:99], a[168:171], v[64:67]
    v_xor_b32 v90, v101, v90
    v_xor_b32 v91, v101, v91
    v_mfma_f32_16x16x32_bf16 v[68:71], v[96:99], a[172:175], v[68:71]
    v_fma_f32 v238, -v239, v251, v238
    v_fma_f32 v237, v237, v250, v254
    v_fma_f32 v239, v239, v250, v255
    v_mfma_f32_16x16x32_bf16 v[72:75], v[88:91], a[200:203], v[72:75]
    v_xor_b32 v96, v102, v88
PAD_197:
    s_cbranch_execz PAD_198
    v_xor_b32 v97, v102, v89
    v_mfma_f32_16x16x32_bf16 v[76:79], v[88:91], a[204:207], v[76:79]
    v_xor_b32 v98, v102, v90
    v_xor_b32 v99, v102, v91
    v_mfma_f32_16x16x32_bf16 v[80:83], v[88:91], a[208:211], v[80:83]
    v_mul_f32 v254, v240, v253
    v_mul_f32 v255, v242, v253
    v_mfma_f32_16x16x32_bf16 v[84:87], v[88:91], a[212:215], v[84:87]
    v_mul_f32 v240, v240, v252
    v_mul_f32 v242, v242, v252
    v_fma_f32 v240, -v241, v253, v240
    v_mfma_f32_16x16x32_bf16 v[72:75], v[96:99], a[160:163], v[72:75]
    v_cvt_pk_bf16_f32 v92, v224, v225
    v_cvt_pk_bf16_f32 v93, v226, v227
    v_mfma_f32_16x16x32_bf16 v[76:79], v[96:99], a[164:167], v[76:79]
    v_alignbit_b32 v94, v92, v92, v100
    v_alignbit_b32 v95, v93, v93, v100
    v_mfma_f32_16x16x32_bf16 v[80:83], v[96:99], a[168:171], v[80:83]
    v_xor_b32 v94, v101, v94
    v_xor_b32 v95, v101, v95
    v_mfma_f32_16x16x32_bf16 v[84:87], v[96:99], a[172:175], v[84:87]
    v_fma_f32 v242, -v243, v253, v242
    v_fma_f32 v241, v241, v252, v254
    v_fma_f32 v243, v243, v252, v255
    s_waitcnt lgkmcnt(7)
    v_mfma_f32_16x16x32_bf16 v[8:11], v[92:95], a[216:219], v[8:11]
    v_xor_b32 v96, v102, v92
    s_waitcnt lgkmcnt(6)
    v_mfma_f32_16x16x32_bf16 v[12:15], v[92:95], a[220:223], v[12:15]
    v_xor_b32 v97, v102, v93
    s_waitcnt lgkmcnt(5)
    v_mfma_f32_16x16x32_bf16 v[16:19], v[92:95], a[224:227], v[16:19]
    v_xor_b32 v98, v102, v94
    s_waitcnt lgkmcnt(4)
    v_mfma_f32_16x16x32_bf16 v[20:23], v[92:95], a[228:231], v[20:23]
    v_xor_b32 v99, v102, v95
    s_waitcnt lgkmcnt(3)
    s_nop 0
    v_mfma_f32_16x16x32_bf16 v[8:11], v[96:99], a[176:179], v[8:11]
    v_cvt_pk_bf16_f32 v88, v228, v229
    s_waitcnt lgkmcnt(2)
    v_mfma_f32_16x16x32_bf16 v[12:15], v[96:99], a[180:183], v[12:15]
PAD_198:
    s_cbranch_execz PAD_199
    v_cvt_pk_bf16_f32 v89, v230, v231
    v_alignbit_b32 v90, v88, v88, v100
    s_waitcnt lgkmcnt(1)
    v_mfma_f32_16x16x32_bf16 v[16:19], v[96:99], a[184:187], v[16:19]
    v_alignbit_b32 v91, v89, v89, v100
    s_waitcnt lgkmcnt(0)
    v_mfma_f32_16x16x32_bf16 v[20:23], v[96:99], a[188:191], v[20:23]
    v_xor_b32 v90, v101, v90
    v_xor_b32 v91, v101, v91
    s_nop 1
    v_mfma_f32_16x16x32_bf16 v[24:27], v[88:91], a[216:219], v[24:27]
    v_xor_b32 v96, v102, v88
    v_mfma_f32_16x16x32_bf16 v[28:31], v[88:91], a[220:223], v[28:31]
    v_xor_b32 v97, v102, v89
    v_mfma_f32_16x16x32_bf16 v[32:35], v[88:91], a[224:227], v[32:35]
    v_xor_b32 v98, v102, v90
    v_mfma_f32_16x16x32_bf16 v[36:39], v[88:91], a[228:231], v[36:39]
    v_xor_b32 v99, v102, v91
    s_nop 1
    v_mfma_f32_16x16x32_bf16 v[24:27], v[96:99], a[176:179], v[24:27]
    v_cvt_pk_bf16_f32 v92, v232, v233
    v_mfma_f32_16x16x32_bf16 v[28:31], v[96:99], a[180:183], v[28:31]
    v_cvt_pk_bf16_f32 v93, v234, v235
    v_alignbit_b32 v94, v92, v92, v100
    v_mfma_f32_16x16x32_bf16 v[32:35], v[96:99], a[184:187], v[32:35]
    v_alignbit_b32 v95, v93, v93, v100
    v_mfma_f32_16x16x32_bf16 v[36:39], v[96:99], a[188:191], v[36:39]
    v_xor_b32 v94, v101, v94
    v_xor_b32 v95, v101, v95
    s_nop 1
    v_mfma_f32_16x16x32_bf16 v[40:43], v[92:95], a[216:219], v[40:43]
    v_xor_b32 v96, v102, v92
    v_mfma_f32_16x16x32_bf16 v[44:47], v[92:95], a[220:223], v[44:47]
    v_xor_b32 v97, v102, v93
    v_mfma_f32_16x16x32_bf16 v[48:51], v[92:95], a[224:227], v[48:51]
    v_xor_b32 v98, v102, v94
    v_mfma_f32_16x16x32_bf16 v[52:55], v[92:95], a[228:231], v[52:55]
    v_xor_b32 v99, v102, v95
    s_nop 1
    v_mfma_f32_16x16x32_bf16 v[40:43], v[96:99], a[176:179], v[40:43]
PAD_199:
    s_cbranch_execz SCB_ret
    v_cvt_pk_bf16_f32 v88, v236, v237
    v_mfma_f32_16x16x32_bf16 v[44:47], v[96:99], a[180:183], v[44:47]
    v_cvt_pk_bf16_f32 v89, v238, v239
    v_alignbit_b32 v90, v88, v88, v100
    v_mfma_f32_16x16x32_bf16 v[48:51], v[96:99], a[184:187], v[48:51]
    v_alignbit_b32 v91, v89, v89, v100
    v_mfma_f32_16x16x32_bf16 v[52:55], v[96:99], a[188:191], v[52:55]
    v_xor_b32 v90, v101, v90
    v_xor_b32 v91, v101, v91
    s_nop 1
    v_mfma_f32_16x16x32_bf16 v[56:59], v[88:91], a[216:219], v[56:59]
    v_xor_b32 v96, v102, v88
    v_mfma_f32_16x16x32_bf16 v[60:63], v[88:91], a[220:223], v[60:63]
    v_xor_b32 v97, v102, v89
    v_mfma_f32_16x16x32_bf16 v[64:67], v[88:91], a[224:227], v[64:67]
    v_xor_b32 v98, v102, v90
    v_mfma_f32_16x16x32_bf16 v[68:71], v[88:91], a[228:231], v[68:71]
    v_xor_b32 v99, v102, v91
    s_nop 1
    v_mfma_f32_16x16x32_bf16 v[56:59], v[96:99], a[176:179], v[56:59]
    v_cvt_pk_bf16_f32 v92, v240, v241
    v_mfma_f32_16x16x32_bf16 v[60:63], v[96:99], a[180:183], v[60:63]
    v_cvt_pk_bf16_f32 v93, v242, v243
    v_alignbit_b32 v94, v92, v92, v100
    v_mfma_f32_16x16x32_bf16 v[64:67], v[96:99], a[184:187], v[64:67]
    v_alignbit_b32 v95, v93, v93, v100
    v_mfma_f32_16x16x32_bf16 v[68:71], v[96:99], a[188:191], v[68:71]
    v_xor_b32 v94, v101, v94
    v_xor_b32 v95, v101, v95
    s_nop 1
    v_mfma_f32_16x16x32_bf16 v[72:75], v[92:95], a[216:219], v[72:75]
    v_xor_b32 v96, v102, v92
    v_mfma_f32_16x16x32_bf16 v[76:79], v[92:95], a[220:223], v[76:79]
    v_xor_b32 v97, v102, v93
    v_mfma_f32_16x16x32_bf16 v[80:83], v[92:95], a[224:227], v[80:83]
    v_xor_b32 v98, v102, v94
    v_mfma_f32_16x16x32_bf16 v[84:87], v[92:95], a[228:231], v[84:87]
    v_xor_b32 v99, v102, v95
    s_nop 1
    v_mfma_f32_16x16x32_bf16 v[72:75], v[96:99], a[176:179], v[72:75]
SCB_e20:
PAD_200:
    s_cbranch_execz PAD_201
    s_mov_b32 s48, 0x2000
    buffer_load_dwordx4 v[224:227], v7, s[32:35], s48 offen offset:0 sc1
    buffer_load_dwordx4 v[228:231], v7, s[32:35], s48 offen offset:256 sc1
    v_mfma_f32_16x16x32_bf16 v[76:79], v[96:99], a[180:183], v[76:79]
    buffer_load_dwordx4 v[232:235], v7, s[32:35], s48 offen offset:512 sc1
    buffer_load_dwordx4 v[236:239], v7, s[32:35], s48 offen offset:768 sc1
    v_mfma_f32_16x16x32_bf16 v[80:83], v[96:99], a[184:187], v[80:83]
    s_mov_b32 s48, 0x3000
    buffer_load_dwordx4 v[240:243], v7, s[32:35], s48 offen offset:0 sc1
    buffer_load_dwordx4 v[244:247], v7, s[32:35], s48 offen offset:256 sc1
    v_mfma_f32_16x16x32_bf16 v[84:87], v[96:99], a[188:191], v[84:87]
    buffer_load_dwordx4 v[248:251], v7, s[32:35], s48 offen offset:512 sc1
    buffer_load_dwordx4 v[252:255], v7, s[32:35], s48 offen offset:768 sc1
    s_mov_b32 s48, 0x4000
    buffer_load_dwordx4 a[216:219], v7, s[32:35], s48 offen offset:0 sc1
    buffer_load_dwordx4 a[220:223], v7, s[32:35], s48 offen offset:256 sc1
    buffer_load_dwordx4 a[224:227], v7, s[32:35], s48 offen offset:512 sc1
    buffer_load_dwordx4 a[228:231], v7, s[32:35], s48 offen offset:768 sc1
G2_h:
    s_waitcnt vmcnt(17)
    v_bitop3_b32 v4, v192, v196, v200 bitop3:0x80
    s_waitcnt vmcnt(16)
    v_bitop3_b32 v4, v4, v204, 1 bitop3:0x80
    v_cmp_eq_u32 vcc, 0, v4
    s_nop 3
    s_cbranch_vccnz G2_retry_62
G2_retry_62_ok:
    v_mfma_f32_16x16x32_bf16 v[8:11], v[112:115], v[192:195], v[8:11]
    v_mfma_f32_16x16x32_bf16 v[24:27], v[116:119], v[192:195], v[24:27]
    v_mfma_f32_16x16x32_bf16 v[40:43], v[120:123], v[192:195], v[40:43]
    v_mfma_f32_16x16x32_bf16 v[56:59], v[124:127], v[192:195], v[56:59]
    v_mfma_f32_16x16x32_bf16 v[72:75], v[128:131], v[192:195], v[72:75]
    s_mov_b32 s48, 0x5000
    buffer_load_dwordx4 a[200:203], v7, s[32:35], s48 offen offset:0 sc1
    v_mfma_f32_16x16x32_bf16 v[12:15], v[112:115], v[196:199], v[12:15]
    v_mfma_f32_16x16x32_bf16 v[28:31], v[116:119], v[196:199], v[28:31]
PAD_201:
    s_cbranch_execz PAD_202
    v_mfma_f32_16x16x32_bf16 v[44:47], v[120:123], v[196:199], v[44:47]
    v_mfma_f32_16x16x32_bf16 v[60:63], v[124:127], v[196:199], v[60:63]
    v_mfma_f32_16x16x32_bf16 v[76:79], v[128:131], v[196:199], v[76:79]
    v_mfma_f32_16x16x32_bf16 v[16:19], v[112:115], v[200:203], v[16:19]
    buffer_load_dwordx4 a[204:207], v7, s[32:35], s48 offen offset:256 sc1
    v_mfma_f32_16x16x32_bf16 v[32:35], v[116:119], v[200:203], v[32:35]
    v_mfma_f32_16x16x32_bf16 v[48:51], v[120:123], v[200:203], v[48:51]
    v_mfma_f32_16x16x32_bf16 v[64:67], v[124:127], v[200:203], v[64:67]
    v_mfma_f32_16x16x32_bf16 v[80:83], v[128:131], v[200:203], v[80:83]
    v_mfma_f32_16x16x32_bf16 v[20:23], v[112:115], v[204:207], v[20:23]
    s_waitcnt vmcnt(15)
    v_bitop3_b32 v4, v208, v212, v216 bitop3:0x80
    buffer_load_dwordx4 a[208:211], v7, s[32:35], s48 offen offset:512 sc1
    v_mfma_f32_16x16x32_bf16 v[36:39], v[116:119], v[204:207], v[36:39]
    s_waitcnt vmcnt(15)
    v_bitop3_b32 v4, v4, v220, 1 bitop3:0x80
    v_mfma_f32_16x16x32_bf16 v[52:55], v[120:123], v[204:207], v[52:55]
    v_cmp_eq_u32 vcc, 0, v4
    v_mfma_f32_16x16x32_bf16 v[68:71], v[124:127], v[204:207], v[68:71]
    v_mfma_f32_16x16x32_bf16 v[84:87], v[128:131], v[204:207], v[84:87]
    s_nop 1
    s_cbranch_vccnz G2_retry_63
G2_retry_63_ok:
    v_mfma_f32_16x16x32_bf16 v[8:11], v[132:135], v[208:211], v[8:11]
    v_mfma_f32_16x16x32_bf16 v[24:27], v[136:139], v[208:211], v[24:27]
    s_mov_b32 s48, 0x5000
    buffer_load_dwordx4 a[212:215], v7, s[32:35], s48 offen offset:768 sc1
    v_mfma_f32_16x16x32_bf16 v[40:43], v[140:143], v[208:211], v[40:43]
    v_mfma_f32_16x16x32_bf16 v[56:59], v[144:147], v[208:211], v[56:59]
    v_mfma_f32_16x16x32_bf16 v[72:75], v[148:151], v[208:211], v[72:75]
    v_mfma_f32_16x16x32_bf16 v[12:15], v[132:135], v[212:215], v[12:15]
    v_mfma_f32_16x16x32_bf16 v[28:31], v[136:139], v[212:215], v[28:31]
    s_mov_b32 s48, 0x6000
    buffer_load_dwordx4 a[232:235], v7, s[32:35], s48 offen offset:0 sc1
    v_mfma_f32_16x16x32_bf16 v[44:47], v[140:143], v[212:215], v[44:47]
PAD_202:
    s_cbranch_execz PAD_203
    v_mfma_f32_16x16x32_bf16 v[60:63], v[144:147], v[212:215], v[60:63]
    v_mfma_f32_16x16x32_bf16 v[76:79], v[148:151], v[212:215], v[76:79]
    v_mfma_f32_16x16x32_bf16 v[16:19], v[132:135], v[216:219], v[16:19]
    v_mfma_f32_16x16x32_bf16 v[32:35], v[136:139], v[216:219], v[32:35]
    buffer_load_dwordx4 a[236:239], v7, s[32:35], s48 offen offset:256 sc1
    v_mfma_f32_16x16x32_bf16 v[48:51], v[140:143], v[216:219], v[48:51]
    v_mfma_f32_16x16x32_bf16 v[64:67], v[144:147], v[216:219], v[64:67]
    v_mfma_f32_16x16x32_bf16 v[80:83], v[148:151], v[216:219], v[80:83]
    v_mfma_f32_16x16x32_bf16 v[20:23], v[132:135], v[220:223], v[20:23]
    s_waitcnt vmcnt(15)
    v_bitop3_b32 v4, v224, v228, v232 bitop3:0x80
    v_mfma_f32_16x16x32_bf16 v[36:39], v[136:139], v[220:223], v[36:39]
    s_waitcnt vmcnt(14)
    v_bitop3_b32 v4, v4, v236, 1 bitop3:0x80
    v_mfma_f32_16x16x32_bf16 v[52:55], v[140:143], v[220:223], v[52:55]
    v_cmp_eq_u32 vcc, 0, v4
    buffer_load_dwordx4 a[240:243], v7, s[32:35], s48 offen offset:512 sc1
    v_mfma_f32_16x16x32_bf16 v[68:71], v[144:147], v[220:223], v[68:71]
    v_mfma_f32_16x16x32_bf16 v[84:87], v[148:151], v[220:223], v[84:87]
    s_nop 0
    s_cbranch_vccnz G2_retry_64
G2_retry_64_ok:
    v_mfma_f32_16x16x32_bf16 v[8:11], v[152:155], v[224:227], v[8:11]
    v_mfma_f32_16x16x32_bf16 v[24:27], v[156:159], v[224:227], v[24:27]
    v_mfma_f32_16x16x32_bf16 v[40:43], v[160:163], v[224:227], v[40:43]
    s_mov_b32 s48, 0x6000
    buffer_load_dwordx4 a[244:247], v7, s[32:35], s48 offen offset:768 sc1
    v_mfma_f32_16x16x32_bf16 v[56:59], v[164:167], v[224:227], v[56:59]
    v_mfma_f32_16x16x32_bf16 v[72:75], v[168:171], v[224:227], v[72:75]
    v_mfma_f32_16x16x32_bf16 v[12:15], v[152:155], v[228:231], v[12:15]
    v_mfma_f32_16x16x32_bf16 v[28:31], v[156:159], v[228:231], v[28:31]
    v_mfma_f32_16x16x32_bf16 v[44:47], v[160:163], v[228:231], v[44:47]
    v_mfma_f32_16x16x32_bf16 v[60:63], v[164:167], v[228:231], v[60:63]
    s_mov_b32 s48, 0x7000
    buffer_load_dwordx4 v[112:115], v7, s[32:35], s48 offen offset:0 sc1
PAD_203:
    s_cbranch_execz SCB_ret
    v_mfma_f32_16x16x32_bf16 v[76:79], v[168:171], v[228:231], v[76:79]
    v_mfma_f32_16x16x32_bf16 v[16:19], v[152:155], v[232:235], v[16:19]
    v_mfma_f32_16x16x32_bf16 v[32:35], v[156:159], v[232:235], v[32:35]
    v_mfma_f32_16x16x32_bf16 v[48:51], v[160:163], v[232:235], v[48:51]
    v_mfma_f32_16x16x32_bf16 v[64:67], v[164:167], v[232:235], v[64:67]
    buffer_load_dwordx4 v[116:119], v7, s[32:35], s48 offen offset:256 sc1
    v_mfma_f32_16x16x32_bf16 v[80:83], v[168:171], v[232:235], v[80:83]
    v_mfma_f32_16x16x32_bf16 v[20:23], v[152:155], v[236:239], v[20:23]
    s_waitcnt vmcnt(15)
    v_bitop3_b32 v4, v240, v244, v248 bitop3:0x80
    v_mfma_f32_16x16x32_bf16 v[36:39], v[156:159], v[236:239], v[36:39]
    s_waitcnt vmcnt(14)
    v_bitop3_b32 v4, v4, v252, 1 bitop3:0x80
    v_mfma_f32_16x16x32_bf16 v[52:55], v[160:163], v[236:239], v[52:55]
    v_cmp_eq_u32 vcc, 0, v4
    v_mfma_f32_16x16x32_bf16 v[68:71], v[164:167], v[236:239], v[68:71]
    v_mfma_f32_16x16x32_bf16 v[84:87], v[168:171], v[236:239], v[84:87]
    buffer_load_dwordx4 v[120:123], v7, s[32:35], s48 offen offset:512 sc1
    s_nop 0
    s_cbranch_vccnz G2_retry_65
G2_retry_65_ok:
    v_mfma_f32_16x16x32_bf16 v[8:11], v[172:175], v[240:243], v[8:11]
    v_mfma_f32_16x16x32_bf16 v[24:27], v[176:179], v[240:243], v[24:27]
    v_mfma_f32_16x16x32_bf16 v[40:43], v[180:183], v[240:243], v[40:43]
    v_mfma_f32_16x16x32_bf16 v[56:59], v[184:187], v[240:243], v[56:59]
    v_mfma_f32_16x16x32_bf16 v[72:75], v[188:191], v[240:243], v[72:75]
    s_mov_b32 s48, 0x7000
    buffer_load_dwordx4 v[124:127], v7, s[32:35], s48 offen offset:768 sc1
    v_mfma_f32_16x16x32_bf16 v[12:15], v[172:175], v[244:247], v[12:15]
    v_mfma_f32_16x16x32_bf16 v[28:31], v[176:179], v[244:247], v[28:31]
    v_mfma_f32_16x16x32_bf16 v[44:47], v[180:183], v[244:247], v[44:47]
    v_mfma_f32_16x16x32_bf16 v[60:63], v[184:187], v[244:247], v[60:63]
    v_mfma_f32_16x16x32_bf16 v[76:79], v[188:191], v[244:247], v[76:79]
    s_mov_b32 s48, 0x8000
    buffer_load_dwordx4 v[192:195], v7, s[32:35], s48 offen offset:0 sc1
SCB_e32:
PAD_204:
    s_cbranch_execz PAD_205
    v_mfma_f32_16x16x32_bf16 v[16:19], v[172:175], v[248:251], v[16:19]
    v_mfma_f32_16x16x32_bf16 v[32:35], v[176:179], v[248:251], v[32:35]
    s_waitcnt vmcnt(16)
    v_accvgpr_read_b32 v4, a216
    v_mfma_f32_16x16x32_bf16 v[48:51], v[180:183], v[248:251], v[48:51]
    s_waitcnt vmcnt(15)
    v_accvgpr_read_b32 v5, a220
    v_mfma_f32_16x16x32_bf16 v[64:67], v[184:187], v[248:251], v[64:67]
    s_waitcnt vmcnt(14)
    v_accvgpr_read_b32 v108, a224
    v_mfma_f32_16x16x32_bf16 v[80:83], v[188:191], v[248:251], v[80:83]
    v_bitop3_b32 v4, v4, v5, v108 bitop3:0x80
    v_mfma_f32_16x16x32_bf16 v[20:23], v[172:175], v[252:255], v[20:23]
    s_waitcnt vmcnt(13)
    v_accvgpr_read_b32 v5, a228
    buffer_load_dwordx4 v[196:199], v7, s[32:35], s48 offen offset:256 sc1
    v_mfma_f32_16x16x32_bf16 v[36:39], v[176:179], v[252:255], v[36:39]
    v_bitop3_b32 v4, v4, v5, 1 bitop3:0x80
    v_mfma_f32_16x16x32_bf16 v[52:55], v[180:183], v[252:255], v[52:55]
    v_cmp_eq_u32 vcc, 0, v4
    v_mfma_f32_16x16x32_bf16 v[68:71], v[184:187], v[252:255], v[68:71]
    v_mfma_f32_16x16x32_bf16 v[84:87], v[188:191], v[252:255], v[84:87]
    s_nop 1
    s_cbranch_vccnz G2_retry_66
G2_retry_66_ok:
    v_mfma_f32_16x16x32_bf16 v[8:11], a[0:3], a[216:219], v[8:11]
    s_mov_b32 s48, 0x8000
    buffer_load_dwordx4 v[200:203], v7, s[32:35], s48 offen offset:512 sc1
    v_mfma_f32_16x16x32_bf16 v[24:27], a[4:7], a[216:219], v[24:27]
    v_mfma_f32_16x16x32_bf16 v[40:43], a[8:11], a[216:219], v[40:43]
    v_mfma_f32_16x16x32_bf16 v[56:59], a[12:15], a[216:219], v[56:59]
    v_mfma_f32_16x16x32_bf16 v[72:75], a[16:19], a[216:219], v[72:75]
    v_mfma_f32_16x16x32_bf16 v[12:15], a[0:3], a[220:223], v[12:15]
    v_mfma_f32_16x16x32_bf16 v[28:31], a[4:7], a[220:223], v[28:31]
    buffer_load_dwordx4 v[204:207], v7, s[32:35], s48 offen offset:768 sc1
    v_mfma_f32_16x16x32_bf16 v[44:47], a[8:11], a[220:223], v[44:47]
PAD_205:
    s_cbranch_execz PAD_206
    v_mfma_f32_16x16x32_bf16 v[60:63], a[12:15], a[220:223], v[60:63]
    v_mfma_f32_16x16x32_bf16 v[76:79], a[16:19], a[220:223], v[76:79]
    v_mfma_f32_16x16x32_bf16 v[16:19], a[0:3], a[224:227], v[16:19]
    v_mfma_f32_16x16x32_bf16 v[32:35], a[4:7], a[224:227], v[32:35]
    s_waitcnt vmcnt(15)
    v_accvgpr_read_b32 v4, a200
    s_mov_b32 s48, 0x9000
    buffer_load_dwordx4 v[128:131], v7, s[32:35], s48 offen offset:0 sc1
    v_mfma_f32_16x16x32_bf16 v[48:51], a[8:11], a[224:227], v[48:51]
    s_waitcnt vmcnt(15)
    v_accvgpr_read_b32 v5, a204
    v_mfma_f32_16x16x32_bf16 v[64:67], a[12:15], a[224:227], v[64:67]
    s_waitcnt vmcnt(14)
    v_accvgpr_read_b32 v108, a208
    v_mfma_f32_16x16x32_bf16 v[80:83], a[16:19], a[224:227], v[80:83]
    v_bitop3_b32 v4, v4, v5, v108 bitop3:0x80
    v_mfma_f32_16x16x32_bf16 v[20:23], a[0:3], a[228:231], v[20:23]
    s_waitcnt vmcnt(13)
    v_accvgpr_read_b32 v5, a212
    v_mfma_f32_16x16x32_bf16 v[36:39], a[4:7], a[228:231], v[36:39]
    v_bitop3_b32 v4, v4, v5, 1 bitop3:0x80
    buffer_load_dwordx4 v[132:135], v7, s[32:35], s48 offen offset:256 sc1
    v_mfma_f32_16x16x32_bf16 v[52:55], a[8:11], a[228:231], v[52:55]
    v_cmp_eq_u32 vcc, 0, v4
    v_mfma_f32_16x16x32_bf16 v[68:71], a[12:15], a[228:231], v[68:71]
    v_mfma_f32_16x16x32_bf16 v[84:87], a[16:19], a[228:231], v[84:87]
    s_nop 1
    s_cbranch_vccnz G2_retry_67
G2_retry_67_ok:
    v_mfma_f32_16x16x32_bf16 v[8:11], a[20:23], a[200:203], v[8:11]
    v_mfma_f32_16x16x32_bf16 v[24:27], a[24:27], a[200:203], v[24:27]
    v_mfma_f32_16x16x32_bf16 v[40:43], a[28:31], a[200:203], v[40:43]
    s_mov_b32 s48, 0x9000
    buffer_load_dwordx4 v[136:139], v7, s[32:35], s48 offen offset:512 sc1
    v_mfma_f32_16x16x32_bf16 v[56:59], a[32:35], a[200:203], v[56:59]
    v_mfma_f32_16x16x32_bf16 v[72:75], a[36:39], a[200:203], v[72:75]
PAD_206:
    s_cbranch_execz SCB_ret
    v_mfma_f32_16x16x32_bf16 v[12:15], a[20:23], a[204:207], v[12:15]
    v_mfma_f32_16x16x32_bf16 v[28:31], a[24:27], a[204:207], v[28:31]
    v_mfma_f32_16x16x32_bf16 v[44:47], a[28:31], a[204:207], v[44:47]
    buffer_load_dwordx4 v[140:143], v7, s[32:35], s48 offen offset:768 sc1
    v_mfma_f32_16x16x32_bf16 v[60:63], a[32:35], a[204:207], v[60:63]
    v_mfma_f32_16x16x32_bf16 v[76:79], a[36:39], a[204:207], v[76:79]
    v_mfma_f32_16x16x32_bf16 v[16:19], a[20:23], a[208:211], v[16:19]
    v_mfma_f32_16x16x32_bf16 v[32:35], a[24:27], a[208:211], v[32:35]
    s_waitcnt vmcnt(15)
    v_accvgpr_read_b32 v4, a232
    v_mfma_f32_16x16x32_bf16 v[48:51], a[28:31], a[208:211], v[48:51]
    s_waitcnt vmcnt(14)
    v_accvgpr_read_b32 v5, a236
    v_mfma_f32_16x16x32_bf16 v[64:67], a[32:35], a[208:211], v[64:67]
    s_waitcnt vmcnt(13)
    v_accvgpr_read_b32 v108, a240
    s_mov_b32 s48, 0xa000
    buffer_load_dwordx4 v[208:211], v7, s[32:35], s48 offen offset:0 sc1
    v_mfma_f32_16x16x32_bf16 v[80:83], a[36:39], a[208:211], v[80:83]
    v_bitop3_b32 v4, v4, v5, v108 bitop3:0x80
    v_mfma_f32_16x16x32_bf16 v[20:23], a[20:23], a[212:215], v[20:23]
    s_waitcnt vmcnt(13)
    v_accvgpr_read_b32 v5, a244
    v_mfma_f32_16x16x32_bf16 v[36:39], a[24:27], a[212:215], v[36:39]
    v_bitop3_b32 v4, v4, v5, 1 bitop3:0x80
    v_mfma_f32_16x16x32_bf16 v[52:55], a[28:31], a[212:215], v[52:55]
    v_cmp_eq_u32 vcc, 0, v4
    v_mfma_f32_16x16x32_bf16 v[68:71], a[32:35], a[212:215], v[68:71]
    buffer_load_dwordx4 v[212:215], v7, s[32:35], s48 offen offset:256 sc1
    v_mfma_f32_16x16x32_bf16 v[84:87], a[36:39], a[212:215], v[84:87]
    s_nop 0
    s_cbranch_vccnz G2_retry_68
G2_retry_68_ok:
    v_mfma_f32_16x16x32_bf16 v[8:11], a[40:43], a[232:235], v[8:11]
    v_mfma_f32_16x16x32_bf16 v[24:27], a[44:47], a[232:235], v[24:27]
    v_mfma_f32_16x16x32_bf16 v[40:43], a[48:51], a[232:235], v[40:43]
SCB_e44:
PAD_207:
    s_cbranch_execz PAD_208
    v_mfma_f32_16x16x32_bf16 v[56:59], a[52:55], a[232:235], v[56:59]
    s_mov_b32 s48, 0xa000
    buffer_load_dwordx4 v[216:219], v7, s[32:35], s48 offen offset:512 sc1
    v_mfma_f32_16x16x32_bf16 v[72:75], a[56:59], a[232:235], v[72:75]
    v_mfma_f32_16x16x32_bf16 v[12:15], a[40:43], a[236:239], v[12:15]
    v_mfma_f32_16x16x32_bf16 v[28:31], a[44:47], a[236:239], v[28:31]
    v_mfma_f32_16x16x32_bf16 v[44:47], a[48:51], a[236:239], v[44:47]
    v_mfma_f32_16x16x32_bf16 v[60:63], a[52:55], a[236:239], v[60:63]
    v_mfma_f32_16x16x32_bf16 v[76:79], a[56:59], a[236:239], v[76:79]
    buffer_load_dwordx4 v[220:223], v7, s[32:35], s48 offen offset:768 sc1
    v_mfma_f32_16x16x32_bf16 v[16:19], a[40:43], a[240:243], v[16:19]
    v_mfma_f32_16x16x32_bf16 v[32:35], a[44:47], a[240:243], v[32:35]
    v_mfma_f32_16x16x32_bf16 v[48:51], a[48:51], a[240:243], v[48:51]
    v_mfma_f32_16x16x32_bf16 v[64:67], a[52:55], a[240:243], v[64:67]
    v_mfma_f32_16x16x32_bf16 v[80:83], a[56:59], a[240:243], v[80:83]
    s_mov_b32 s48, 0xb000
    buffer_load_dwordx4 v[144:147], v7, s[32:35], s48 offen offset:0 sc1
    v_mfma_f32_16x16x32_bf16 v[20:23], a[40:43], a[244:247], v[20:23]
    s_waitcnt vmcnt(14)
    v_bitop3_b32 v4, v112, v116, v120 bitop3:0x80
    v_mfma_f32_16x16x32_bf16 v[36:39], a[44:47], a[244:247], v[36:39]
    s_waitcnt vmcnt(13)
    v_bitop3_b32 v4, v4, v124, 1 bitop3:0x80
    v_mfma_f32_16x16x32_bf16 v[52:55], a[48:51], a[244:247], v[52:55]
    v_cmp_eq_u32 vcc, 0, v4
    v_mfma_f32_16x16x32_bf16 v[68:71], a[52:55], a[244:247], v[68:71]
    v_mfma_f32_16x16x32_bf16 v[84:87], a[56:59], a[244:247], v[84:87]
    s_nop 1
    s_cbranch_vccnz G2_retry_69
G2_retry_69_ok:
    v_mfma_f32_16x16x32_bf16 v[8:11], a[60:63], v[112:115], v[8:11]
    s_mov_b32 s48, 0xb000
    buffer_load_dwordx4 v[148:151], v7, s[32:35], s48 offen offset:256 sc1
    v_mfma_f32_16x16x32_bf16 v[24:27], a[64:67], v[112:115], v[24:27]
    v_mfma_f32_16x16x32_bf16 v[40:43], a[68:71], v[112:115], v[40:43]
PAD_208:
    s_cbranch_execz PAD_209
    v_mfma_f32_16x16x32_bf16 v[56:59], a[72:75], v[112:115], v[56:59]
    v_mfma_f32_16x16x32_bf16 v[72:75], a[76:79], v[112:115], v[72:75]
    v_mfma_f32_16x16x32_bf16 v[12:15], a[60:63], v[116:119], v[12:15]
    buffer_load_dwordx4 v[152:155], v7, s[32:35], s48 offen offset:512 sc1
    v_mfma_f32_16x16x32_bf16 v[28:31], a[64:67], v[116:119], v[28:31]
    v_mfma_f32_16x16x32_bf16 v[44:47], a[68:71], v[116:119], v[44:47]
    v_mfma_f32_16x16x32_bf16 v[60:63], a[72:75], v[116:119], v[60:63]
    v_mfma_f32_16x16x32_bf16 v[76:79], a[76:79], v[116:119], v[76:79]
    v_mfma_f32_16x16x32_bf16 v[16:19], a[60:63], v[120:123], v[16:19]
    v_mfma_f32_16x16x32_bf16 v[32:35], a[64:67], v[120:123], v[32:35]
    buffer_load_dwordx4 v[156:159], v7, s[32:35], s48 offen offset:768 sc1
    v_mfma_f32_16x16x32_bf16 v[48:51], a[68:71], v[120:123], v[48:51]
    v_mfma_f32_16x16x32_bf16 v[64:67], a[72:75], v[120:123], v[64:67]
    v_mfma_f32_16x16x32_bf16 v[80:83], a[76:79], v[120:123], v[80:83]
    v_mfma_f32_16x16x32_bf16 v[20:23], a[60:63], v[124:127], v[20:23]
    s_waitcnt vmcnt(13)
    v_bitop3_b32 v4, v192, v196, v200 bitop3:0x80
    v_mfma_f32_16x16x32_bf16 v[36:39], a[64:67], v[124:127], v[36:39]
    s_waitcnt vmcnt(12)
    v_bitop3_b32 v4, v4, v204, 1 bitop3:0x80
    s_mov_b32 s52, 0x10000
    buffer_load_dwordx4 a[176:179], v6, s[32:35], s52 offen offset:0 sc1
    v_mfma_f32_16x16x32_bf16 v[52:55], a[68:71], v[124:127], v[52:55]
    v_cmp_eq_u32 vcc, 0, v4
    v_mfma_f32_16x16x32_bf16 v[68:71], a[72:75], v[124:127], v[68:71]
    v_mfma_f32_16x16x32_bf16 v[84:87], a[76:79], v[124:127], v[84:87]
    s_nop 1
    s_cbranch_vccnz G2_retry_70
G2_retry_70_ok:
    v_mfma_f32_16x16x32_bf16 v[8:11], a[80:83], v[192:195], v[8:11]
    v_mfma_f32_16x16x32_bf16 v[24:27], a[84:87], v[192:195], v[24:27]
    s_mov_b32 s48, 0xc000
    buffer_load_dwordx4 v[224:227], v7, s[32:35], s48 offen offset:0 sc1
    v_mfma_f32_16x16x32_bf16 v[40:43], a[88:91], v[192:195], v[40:43]
    v_mfma_f32_16x16x32_bf16 v[56:59], a[92:95], v[192:195], v[56:59]
PAD_209:
    s_cbranch_execz PAD_210
    v_mfma_f32_16x16x32_bf16 v[72:75], a[96:99], v[192:195], v[72:75]
    v_mfma_f32_16x16x32_bf16 v[12:15], a[80:83], v[196:199], v[12:15]
    v_mfma_f32_16x16x32_bf16 v[28:31], a[84:87], v[196:199], v[28:31]
    v_mfma_f32_16x16x32_bf16 v[44:47], a[88:91], v[196:199], v[44:47]
    buffer_load_dwordx4 v[228:231], v7, s[32:35], s48 offen offset:256 sc1
    v_mfma_f32_16x16x32_bf16 v[60:63], a[92:95], v[196:199], v[60:63]
    v_mfma_f32_16x16x32_bf16 v[76:79], a[96:99], v[196:199], v[76:79]
    v_mfma_f32_16x16x32_bf16 v[16:19], a[80:83], v[200:203], v[16:19]
    v_mfma_f32_16x16x32_bf16 v[32:35], a[84:87], v[200:203], v[32:35]
    v_mfma_f32_16x16x32_bf16 v[48:51], a[88:91], v[200:203], v[48:51]
    buffer_load_dwordx4 v[232:235], v7, s[32:35], s48 offen offset:512 sc1
    v_mfma_f32_16x16x32_bf16 v[64:67], a[92:95], v[200:203], v[64:67]
    v_mfma_f32_16x16x32_bf16 v[80:83], a[96:99], v[200:203], v[80:83]
    v_mfma_f32_16x16x32_bf16 v[20:23], a[80:83], v[204:207], v[20:23]
    s_waitcnt vmcnt(13)
    v_bitop3_b32 v4, v128, v132, v136 bitop3:0x80
    v_mfma_f32_16x16x32_bf16 v[36:39], a[84:87], v[204:207], v[36:39]
    s_waitcnt vmcnt(12)
    v_bitop3_b32 v4, v4, v140, 1 bitop3:0x80
    v_mfma_f32_16x16x32_bf16 v[52:55], a[88:91], v[204:207], v[52:55]
    v_cmp_eq_u32 vcc, 0, v4
    v_mfma_f32_16x16x32_bf16 v[68:71], a[92:95], v[204:207], v[68:71]
    buffer_load_dwordx4 v[236:239], v7, s[32:35], s48 offen offset:768 sc1
    v_mfma_f32_16x16x32_bf16 v[84:87], a[96:99], v[204:207], v[84:87]
    s_nop 0
    s_cbranch_vccnz G2_retry_71
G2_retry_71_ok:
    v_mfma_f32_16x16x32_bf16 v[8:11], a[100:103], v[128:131], v[8:11]
    v_mfma_f32_16x16x32_bf16 v[24:27], a[104:107], v[128:131], v[24:27]
    v_mfma_f32_16x16x32_bf16 v[40:43], a[108:111], v[128:131], v[40:43]
    v_mfma_f32_16x16x32_bf16 v[56:59], a[112:115], v[128:131], v[56:59]
    s_mov_b32 s52, 0x10000
    buffer_load_dwordx4 a[180:183], v6, s[32:35], s52 offen offset:1024 sc1
    v_mfma_f32_16x16x32_bf16 v[72:75], a[116:119], v[128:131], v[72:75]
    v_mfma_f32_16x16x32_bf16 v[12:15], a[100:103], v[132:135], v[12:15]
PAD_210:
    s_cbranch_execz SCB_ret
    v_mfma_f32_16x16x32_bf16 v[28:31], a[104:107], v[132:135], v[28:31]
    v_mfma_f32_16x16x32_bf16 v[44:47], a[108:111], v[132:135], v[44:47]
    v_mfma_f32_16x16x32_bf16 v[60:63], a[112:115], v[132:135], v[60:63]
    buffer_load_dwordx4 a[184:187], v6, s[32:35], s52 offen offset:2048 sc1
    v_mfma_f32_16x16x32_bf16 v[76:79], a[116:119], v[132:135], v[76:79]
    v_mfma_f32_16x16x32_bf16 v[16:19], a[100:103], v[136:139], v[16:19]
    v_mfma_f32_16x16x32_bf16 v[32:35], a[104:107], v[136:139], v[32:35]
    v_mfma_f32_16x16x32_bf16 v[48:51], a[108:111], v[136:139], v[48:51]
    v_mfma_f32_16x16x32_bf16 v[64:67], a[112:115], v[136:139], v[64:67]
    v_mfma_f32_16x16x32_bf16 v[80:83], a[116:119], v[136:139], v[80:83]
    buffer_load_dwordx4 a[188:191], v6, s[32:35], s52 offen offset:3072 sc1
    v_mfma_f32_16x16x32_bf16 v[20:23], a[100:103], v[140:143], v[20:23]
    s_waitcnt vmcnt(13)
    v_bitop3_b32 v4, v208, v212, v216 bitop3:0x80
    v_mfma_f32_16x16x32_bf16 v[36:39], a[104:107], v[140:143], v[36:39]
    s_waitcnt vmcnt(12)
    v_bitop3_b32 v4, v4, v220, 1 bitop3:0x80
    v_mfma_f32_16x16x32_bf16 v[52:55], a[108:111], v[140:143], v[52:55]
    v_cmp_eq_u32 vcc, 0, v4
    v_mfma_f32_16x16x32_bf16 v[68:71], a[112:115], v[140:143], v[68:71]
    v_mfma_f32_16x16x32_bf16 v[84:87], a[116:119], v[140:143], v[84:87]
    s_mov_b32 s52, 0x11000
    buffer_load_dwordx4 a[192:195], v6, s[32:35], s52 offen offset:0 sc1
    s_cbranch_vccnz G2_retry_72
G2_retry_72_ok:
    v_mfma_f32_16x16x32_bf16 v[8:11], a[120:123], v[208:211], v[8:11]
    v_mfma_f32_16x16x32_bf16 v[24:27], a[124:127], v[208:211], v[24:27]
    v_mfma_f32_16x16x32_bf16 v[40:43], a[128:131], v[208:211], v[40:43]
    v_mfma_f32_16x16x32_bf16 v[56:59], a[132:135], v[208:211], v[56:59]
    v_mfma_f32_16x16x32_bf16 v[72:75], a[136:139], v[208:211], v[72:75]
    v_mfma_f32_16x16x32_bf16 v[12:15], a[120:123], v[212:215], v[12:15]
    s_mov_b32 s52, 0x11000
    buffer_load_dwordx4 a[196:199], v6, s[32:35], s52 offen offset:1024 sc1
    v_mfma_f32_16x16x32_bf16 v[28:31], a[124:127], v[212:215], v[28:31]
SCB_e9:
PAD_211:
    s_cbranch_execz PAD_212
    v_mfma_f32_16x16x32_bf16 v[44:47], a[128:131], v[212:215], v[44:47]
    v_mfma_f32_16x16x32_bf16 v[60:63], a[132:135], v[212:215], v[60:63]
    v_mfma_f32_16x16x32_bf16 v[76:79], a[136:139], v[212:215], v[76:79]
    v_mfma_f32_16x16x32_bf16 v[16:19], a[120:123], v[216:219], v[16:19]
    s_mov_b32 s48, 0xd000
    buffer_load_dwordx4 v[160:163], v7, s[32:35], s48 offen offset:0 sc1
    v_mfma_f32_16x16x32_bf16 v[32:35], a[124:127], v[216:219], v[32:35]
    v_mfma_f32_16x16x32_bf16 v[48:51], a[128:131], v[216:219], v[48:51]
    v_mfma_f32_16x16x32_bf16 v[64:67], a[132:135], v[216:219], v[64:67]
    v_mfma_f32_16x16x32_bf16 v[80:83], a[136:139], v[216:219], v[80:83]
    v_mfma_f32_16x16x32_bf16 v[20:23], a[120:123], v[220:223], v[20:23]
    s_waitcnt vmcnt(12)
    v_bitop3_b32 v4, v144, v148, v152 bitop3:0x80
    buffer_load_dwordx4 v[164:167], v7, s[32:35], s48 offen offset:256 sc1
    v_mfma_f32_16x16x32_bf16 v[36:39], a[124:127], v[220:223], v[36:39]
    s_waitcnt vmcnt(12)
    v_bitop3_b32 v4, v4, v156, 1 bitop3:0x80
    v_mfma_f32_16x16x32_bf16 v[52:55], a[128:131], v[220:223], v[52:55]
    v_cmp_eq_u32 vcc, 0, v4
    v_mfma_f32_16x16x32_bf16 v[68:71], a[132:135], v[220:223], v[68:71]
    v_mfma_f32_16x16x32_bf16 v[84:87], a[136:139], v[220:223], v[84:87]
    s_nop 1
    s_cbranch_vccnz G2_retry_73
G2_retry_73_ok:
    v_mfma_f32_16x16x32_bf16 v[8:11], a[140:143], v[144:147], v[8:11]
    v_mfma_f32_16x16x32_bf16 v[24:27], a[144:147], v[144:147], v[24:27]
    s_mov_b32 s48, 0xd000
    buffer_load_dwordx4 v[168:171], v7, s[32:35], s48 offen offset:512 sc1
    v_mfma_f32_16x16x32_bf16 v[40:43], a[148:151], v[144:147], v[40:43]
    v_mfma_f32_16x16x32_bf16 v[56:59], a[152:155], v[144:147], v[56:59]
    v_mfma_f32_16x16x32_bf16 v[72:75], a[156:159], v[144:147], v[72:75]
    v_mfma_f32_16x16x32_bf16 v[12:15], a[140:143], v[148:151], v[12:15]
    v_mfma_f32_16x16x32_bf16 v[28:31], a[144:147], v[148:151], v[28:31]
    buffer_load_dwordx4 v[172:175], v7, s[32:35], s48 offen offset:768 sc1
    v_mfma_f32_16x16x32_bf16 v[44:47], a[148:151], v[148:151], v[44:47]
PAD_212:
    s_cbranch_execz PAD_213
    v_mfma_f32_16x16x32_bf16 v[60:63], a[152:155], v[148:151], v[60:63]
    v_mfma_f32_16x16x32_bf16 v[76:79], a[156:159], v[148:151], v[76:79]
    v_mfma_f32_16x16x32_bf16 v[16:19], a[140:143], v[152:155], v[16:19]
    v_lshrrev_b32 v4, 4, v1
    v_lshlrev_b32 v5, 4, v4
    v_lshlrev_b32 v4, 3, v4
    s_mul_i32 s48, s28, 160
    buffer_load_dwordx4 v[88:91], v5, s[44:47], s48 offen offset:0
    buffer_load_dwordx4 v[92:95], v5, s[44:47], s48 offen offset:64
    buffer_load_dwordx2 v[96:97], v4, s[44:47], s48 offen offset:128
    v_mfma_f32_16x16x32_bf16 v[32:35], a[144:147], v[152:155], v[32:35]
    v_mfma_f32_16x16x32_bf16 v[48:51], a[148:151], v[152:155], v[48:51]
    v_mfma_f32_16x16x32_bf16 v[64:67], a[152:155], v[152:155], v[64:67]
    v_mfma_f32_16x16x32_bf16 v[80:83], a[156:159], v[152:155], v[80:83]
    v_mfma_f32_16x16x32_bf16 v[20:23], a[140:143], v[156:159], v[20:23]
    s_waitcnt vmcnt(13)
    v_bitop3_b32 v4, v224, v228, v232 bitop3:0x80
    v_mfma_f32_16x16x32_bf16 v[36:39], a[144:147], v[156:159], v[36:39]
    s_waitcnt vmcnt(12)
    v_bitop3_b32 v4, v4, v236, 1 bitop3:0x80
    v_mfma_f32_16x16x32_bf16 v[52:55], a[148:151], v[156:159], v[52:55]
    v_cmp_eq_u32 vcc, 0, v4
    v_mfma_f32_16x16x32_bf16 v[68:71], a[152:155], v[156:159], v[68:71]
    v_mfma_f32_16x16x32_bf16 v[84:87], a[156:159], v[156:159], v[84:87]
    s_cmp_eq_u32 s26, 3
    s_cbranch_scc1 G2_skip_61
    s_cbranch_vccnz G2_retry_74
G2_retry_74_ok:
    v_mfma_f32_16x16x32_bf16 v[8:11], a[160:163], v[224:227], v[8:11]
    v_mfma_f32_16x16x32_bf16 v[24:27], a[164:167], v[224:227], v[24:27]
    v_mfma_f32_16x16x32_bf16 v[40:43], a[168:171], v[224:227], v[40:43]
    v_mfma_f32_16x16x32_bf16 v[56:59], a[172:175], v[224:227], v[56:59]
    v_mfma_f32_16x16x32_bf16 v[72:75], a[176:179], v[224:227], v[72:75]
    v_mfma_f32_16x16x32_bf16 v[12:15], a[160:163], v[228:231], v[12:15]
    v_mfma_f32_16x16x32_bf16 v[28:31], a[164:167], v[228:231], v[28:31]
    v_mfma_f32_16x16x32_bf16 v[44:47], a[168:171], v[228:231], v[44:47]
    v_mfma_f32_16x16x32_bf16 v[60:63], a[172:175], v[228:231], v[60:63]
PAD_213:
    s_cbranch_execz PAD_214
    v_mfma_f32_16x16x32_bf16 v[76:79], a[176:179], v[228:231], v[76:79]
    v_mfma_f32_16x16x32_bf16 v[16:19], a[160:163], v[232:235], v[16:19]
    v_mfma_f32_16x16x32_bf16 v[32:35], a[164:167], v[232:235], v[32:35]
    v_mfma_f32_16x16x32_bf16 v[48:51], a[168:171], v[232:235], v[48:51]
    v_mfma_f32_16x16x32_bf16 v[64:67], a[172:175], v[232:235], v[64:67]
    v_mfma_f32_16x16x32_bf16 v[80:83], a[176:179], v[232:235], v[80:83]
    v_mfma_f32_16x16x32_bf16 v[20:23], a[160:163], v[236:239], v[20:23]
    s_waitcnt vmcnt(4)
    v_bitop3_b32 v4, v160, v164, v168 bitop3:0x80
    v_mfma_f32_16x16x32_bf16 v[36:39], a[164:167], v[236:239], v[36:39]
    s_waitcnt vmcnt(3)
    v_bitop3_b32 v4, v4, v172, 1 bitop3:0x80
    v_mfma_f32_16x16x32_bf16 v[52:55], a[168:171], v[236:239], v[52:55]
    v_cmp_eq_u32 vcc, 0, v4
    v_mfma_f32_16x16x32_bf16 v[68:71], a[172:175], v[236:239], v[68:71]
    v_mfma_f32_16x16x32_bf16 v[84:87], a[176:179], v[236:239], v[84:87]
    s_nop 1
    s_cbranch_vccnz G2_retry_75
G2_retry_75_ok:
G2_skip_61:
    v_add_u32 v108, 81920, v2
    s_cmp_eq_u32 s26, 1
    s_cbranch_scc1 G2_red_77
    s_cmp_eq_u32 s26, 2
    s_cbranch_scc1 G2_red_78
    s_cmp_eq_u32 s26, 3
    s_cbranch_scc1 G2_red_79
G2_red_76:
    v_mfma_f32_16x16x32_bf16 v[12:15], a[180:183], v[164:167], v[12:15]
    v_mfma_f32_16x16x32_bf16 v[28:31], a[184:187], v[164:167], v[28:31]
    v_mfma_f32_16x16x32_bf16 v[44:47], a[188:191], v[164:167], v[44:47]
    v_mfma_f32_16x16x32_bf16 v[60:63], a[192:195], v[164:167], v[60:63]
    v_mfma_f32_16x16x32_bf16 v[76:79], a[196:199], v[164:167], v[76:79]
    s_nop 3
    ds_write_b128 v108, v[12:15] offset:0
    v_mfma_f32_16x16x32_bf16 v[16:19], a[180:183], v[168:171], v[16:19]
    ds_write_b128 v108, v[28:31] offset:3072
    v_mfma_f32_16x16x32_bf16 v[32:35], a[184:187], v[168:171], v[32:35]
    ds_write_b128 v108, v[44:47] offset:6144
    v_mfma_f32_16x16x32_bf16 v[48:51], a[188:191], v[168:171], v[48:51]
    ds_write_b128 v108, v[60:63] offset:9216
PAD_214:
    s_cbranch_execz SCB_ret
    v_mfma_f32_16x16x32_bf16 v[64:67], a[192:195], v[168:171], v[64:67]
    ds_write_b128 v108, v[76:79] offset:12288
    v_mfma_f32_16x16x32_bf16 v[80:83], a[196:199], v[168:171], v[80:83]
    ds_write_b128 v108, v[16:19] offset:1024
    v_mfma_f32_16x16x32_bf16 v[20:23], a[180:183], v[172:175], v[20:23]
    ds_write_b128 v108, v[32:35] offset:4096
    v_mfma_f32_16x16x32_bf16 v[36:39], a[184:187], v[172:175], v[36:39]
    ds_write_b128 v108, v[48:51] offset:7168
    v_mfma_f32_16x16x32_bf16 v[52:55], a[188:191], v[172:175], v[52:55]
    ds_write_b128 v108, v[64:67] offset:10240
    v_mfma_f32_16x16x32_bf16 v[68:71], a[192:195], v[172:175], v[68:71]
    ds_write_b128 v108, v[80:83] offset:13312
    v_mfma_f32_16x16x32_bf16 v[84:87], a[196:199], v[172:175], v[84:87]
    ds_write_b128 v108, v[20:23] offset:2048
    v_mfma_f32_16x16x32_bf16 v[8:11], a[180:183], v[160:163], v[8:11]
    ds_write_b128 v108, v[36:39] offset:5120
    v_mfma_f32_16x16x32_bf16 v[24:27], a[184:187], v[160:163], v[24:27]
    ds_write_b128 v108, v[52:55] offset:8192
    v_mfma_f32_16x16x32_bf16 v[40:43], a[188:191], v[160:163], v[40:43]
    ds_write_b128 v108, v[68:71] offset:11264
    v_mfma_f32_16x16x32_bf16 v[56:59], a[192:195], v[160:163], v[56:59]
    ds_write_b128 v108, v[84:87] offset:14336
    v_mfma_f32_16x16x32_bf16 v[72:75], a[196:199], v[160:163], v[72:75]
    v_lshrrev_b32 v192, 4, v1
    v_and_b32 v193, 15, v1
    v_mul_u32_u24 v110, 81920, v193
    v_lshl_add_u32 v111, v192, 3, v110
    v_lshl_add_u32 v110, v192, 4, v110
    s_and_b32 s48, s26, 1
    s_lshl_b32 s48, s48, 5
    s_lshr_b32 s49, s26, 1
    s_add_u32 s48, s48, s49
    s_lshl_b32 s48, s48, 5
    s_add_u32 s48, s48, s27
    s_mul_i32 s48, s48, 1280
SCB_e21:
PAD_215:
    s_cbranch_execz PAD_216
    s_mul_i32 s49, s28, 160
    s_add_u32 s48, s48, s49
    s_waitcnt vmcnt(2)
    v_lshlrev_b32 v208, 16, v88
    v_and_b32 v209, 0xffff0000, v88
    v_pk_add_f32 v[8:9], v[8:9], v[208:209]
    v_lshlrev_b32 v208, 16, v89
    v_and_b32 v209, 0xffff0000, v89
    v_pk_add_f32 v[10:11], v[10:11], v[208:209]
    v_lshlrev_b32 v208, 16, v90
    v_and_b32 v209, 0xffff0000, v90
    v_pk_add_f32 v[24:25], v[24:25], v[208:209]
    v_lshlrev_b32 v208, 16, v91
    v_and_b32 v209, 0xffff0000, v91
    v_pk_add_f32 v[26:27], v[26:27], v[208:209]
    s_waitcnt vmcnt(1)
    v_lshlrev_b32 v208, 16, v92
    v_and_b32 v209, 0xffff0000, v92
    v_pk_add_f32 v[40:41], v[40:41], v[208:209]
    v_lshlrev_b32 v208, 16, v93
    v_and_b32 v209, 0xffff0000, v93
    v_pk_add_f32 v[42:43], v[42:43], v[208:209]
    v_lshlrev_b32 v208, 16, v94
    v_and_b32 v209, 0xffff0000, v94
    v_pk_add_f32 v[56:57], v[56:57], v[208:209]
    v_lshlrev_b32 v208, 16, v95
    v_and_b32 v209, 0xffff0000, v95
    v_pk_add_f32 v[58:59], v[58:59], v[208:209]
    s_waitcnt vmcnt(0)
    v_lshlrev_b32 v208, 16, v96
    v_and_b32 v209, 0xffff0000, v96
    v_pk_add_f32 v[72:73], v[72:73], v[208:209]
    v_lshlrev_b32 v208, 16, v97
    v_and_b32 v209, 0xffff0000, v97
    v_pk_add_f32 v[74:75], v[74:75], v[208:209]
    s_waitcnt lgkmcnt(0)
    s_barrier
    ds_read_b128 v[12:15], v108 offset:17408
    ds_read_b128 v[16:19], v108 offset:31744
    ds_read_b128 v[20:23], v108 offset:46080
PAD_216:
    s_cbranch_execz PAD_217
    ds_read_b128 v[28:31], v108 offset:20480
    ds_read_b128 v[32:35], v108 offset:34816
    ds_read_b128 v[36:39], v108 offset:49152
    ds_read_b128 v[44:47], v108 offset:23552
    ds_read_b128 v[48:51], v108 offset:37888
    ds_read_b128 v[52:55], v108 offset:52224
    ds_read_b128 v[60:63], v108 offset:26624
    ds_read_b128 v[64:67], v108 offset:40960
    ds_read_b128 v[68:71], v108 offset:55296
    ds_read_b128 v[76:79], v108 offset:29696
    ds_read_b128 v[80:83], v108 offset:44032
    ds_read_b128 v[84:87], v108 offset:58368
    s_waitcnt lgkmcnt(14)
    v_pk_add_f32 v[8:9], v[8:9], v[12:13]
    s_waitcnt lgkmcnt(12)
    v_pk_add_f32 v[16:17], v[16:17], v[20:21]
    v_pk_add_f32 v[10:11], v[10:11], v[14:15]
    v_pk_add_f32 v[18:19], v[18:19], v[22:23]
    v_pk_add_f32 v[8:9], v[8:9], v[16:17]
    v_pk_add_f32 v[10:11], v[10:11], v[18:19]
    v_cvt_pk_bf16_f32 v88, v8, v9
    v_cvt_pk_bf16_f32 v89, v10, v11
    s_waitcnt lgkmcnt(11)
    v_pk_add_f32 v[24:25], v[24:25], v[28:29]
    s_waitcnt lgkmcnt(9)
    v_pk_add_f32 v[32:33], v[32:33], v[36:37]
    v_pk_add_f32 v[26:27], v[26:27], v[30:31]
    v_pk_add_f32 v[34:35], v[34:35], v[38:39]
    v_pk_add_f32 v[24:25], v[24:25], v[32:33]
    v_pk_add_f32 v[26:27], v[26:27], v[34:35]
    v_cvt_pk_bf16_f32 v90, v24, v25
    v_cvt_pk_bf16_f32 v91, v26, v27
    buffer_store_dwordx4 v[88:91], v110, s[40:43], s48 offen offset:0
PAD_217:
    s_cbranch_execz SCB_ret
    s_waitcnt lgkmcnt(8)
    v_pk_add_f32 v[40:41], v[40:41], v[44:45]
    s_waitcnt lgkmcnt(6)
    v_pk_add_f32 v[48:49], v[48:49], v[52:53]
    v_pk_add_f32 v[42:43], v[42:43], v[46:47]
    v_pk_add_f32 v[50:51], v[50:51], v[54:55]
    v_pk_add_f32 v[40:41], v[40:41], v[48:49]
    v_pk_add_f32 v[42:43], v[42:43], v[50:51]
    v_cvt_pk_bf16_f32 v92, v40, v41
    v_cvt_pk_bf16_f32 v93, v42, v43
    s_waitcnt lgkmcnt(5)
    v_pk_add_f32 v[56:57], v[56:57], v[60:61]
    s_waitcnt lgkmcnt(3)
    v_pk_add_f32 v[64:65], v[64:65], v[68:69]
    v_pk_add_f32 v[58:59], v[58:59], v[62:63]
    v_pk_add_f32 v[66:67], v[66:67], v[70:71]
    v_pk_add_f32 v[56:57], v[56:57], v[64:65]
    v_pk_add_f32 v[58:59], v[58:59], v[66:67]
    v_cvt_pk_bf16_f32 v94, v56, v57
    v_cvt_pk_bf16_f32 v95, v58, v59
    buffer_store_dwordx4 v[92:95], v110, s[40:43], s48 offen offset:64
    s_waitcnt lgkmcnt(2)
    v_pk_add_f32 v[72:73], v[72:73], v[76:77]
    s_waitcnt lgkmcnt(0)
    v_pk_add_f32 v[80:81], v[80:81], v[84:85]
    v_pk_add_f32 v[74:75], v[74:75], v[78:79]
    v_pk_add_f32 v[82:83], v[82:83], v[86:87]
    v_pk_add_f32 v[72:73], v[72:73], v[80:81]
    v_pk_add_f32 v[74:75], v[74:75], v[82:83]
    v_cvt_pk_bf16_f32 v96, v72, v73
    v_cvt_pk_bf16_f32 v97, v74, v75
    buffer_store_dwordx2 v[96:97], v111, s[40:43], s48 offen offset:128
    s_branch G2_done_80
G2_red_77:
    v_mfma_f32_16x16x32_bf16 v[8:11], a[180:183], v[160:163], v[8:11]
    v_mfma_f32_16x16x32_bf16 v[24:27], a[184:187], v[160:163], v[24:27]
SCB_e33:
PAD_218:
    s_cbranch_execz PAD_219
    v_mfma_f32_16x16x32_bf16 v[40:43], a[188:191], v[160:163], v[40:43]
    v_mfma_f32_16x16x32_bf16 v[56:59], a[192:195], v[160:163], v[56:59]
    v_mfma_f32_16x16x32_bf16 v[72:75], a[196:199], v[160:163], v[72:75]
    s_nop 3
    ds_write_b128 v108, v[8:11] offset:17408
    v_mfma_f32_16x16x32_bf16 v[16:19], a[180:183], v[168:171], v[16:19]
    ds_write_b128 v108, v[24:27] offset:20480
    v_mfma_f32_16x16x32_bf16 v[32:35], a[184:187], v[168:171], v[32:35]
    ds_write_b128 v108, v[40:43] offset:23552
    v_mfma_f32_16x16x32_bf16 v[48:51], a[188:191], v[168:171], v[48:51]
    ds_write_b128 v108, v[56:59] offset:26624
    v_mfma_f32_16x16x32_bf16 v[64:67], a[192:195], v[168:171], v[64:67]
    ds_write_b128 v108, v[72:75] offset:29696
    v_mfma_f32_16x16x32_bf16 v[80:83], a[196:199], v[168:171], v[80:83]
    ds_write_b128 v108, v[16:19] offset:15360
    v_mfma_f32_16x16x32_bf16 v[20:23], a[180:183], v[172:175], v[20:23]
    ds_write_b128 v108, v[32:35] offset:18432
    v_mfma_f32_16x16x32_bf16 v[36:39], a[184:187], v[172:175], v[36:39]
    ds_write_b128 v108, v[48:51] offset:21504
    v_mfma_f32_16x16x32_bf16 v[52:55], a[188:191], v[172:175], v[52:55]
    ds_write_b128 v108, v[64:67] offset:24576
    v_mfma_f32_16x16x32_bf16 v[68:71], a[192:195], v[172:175], v[68:71]
    ds_write_b128 v108, v[80:83] offset:27648
    v_mfma_f32_16x16x32_bf16 v[84:87], a[196:199], v[172:175], v[84:87]
    ds_write_b128 v108, v[20:23] offset:16384
    v_mfma_f32_16x16x32_bf16 v[12:15], a[180:183], v[164:167], v[12:15]
    ds_write_b128 v108, v[36:39] offset:19456
    v_mfma_f32_16x16x32_bf16 v[28:31], a[184:187], v[164:167], v[28:31]
    ds_write_b128 v108, v[52:55] offset:22528
    v_mfma_f32_16x16x32_bf16 v[44:47], a[188:191], v[164:167], v[44:47]
    ds_write_b128 v108, v[68:71] offset:25600
    v_mfma_f32_16x16x32_bf16 v[60:63], a[192:195], v[164:167], v[60:63]
PAD_219:
    s_cbranch_execz PAD_220
    ds_write_b128 v108, v[84:87] offset:28672
    v_mfma_f32_16x16x32_bf16 v[76:79], a[196:199], v[164:167], v[76:79]
    v_lshrrev_b32 v192, 4, v1
    v_and_b32 v193, 15, v1
    v_mul_u32_u24 v110, 81920, v193
    v_lshl_add_u32 v111, v192, 3, v110
    v_lshl_add_u32 v110, v192, 4, v110
    s_and_b32 s48, s26, 1
    s_lshl_b32 s48, s48, 5
    s_lshr_b32 s49, s26, 1
    s_add_u32 s48, s48, s49
    s_lshl_b32 s48, s48, 5
    s_add_u32 s48, s48, s27
    s_mul_i32 s48, s48, 1280
    s_mul_i32 s49, s28, 160
    s_add_u32 s48, s48, s49
    s_waitcnt vmcnt(2)
    v_lshlrev_b32 v208, 16, v88
    v_and_b32 v209, 0xffff0000, v88
    v_pk_add_f32 v[12:13], v[12:13], v[208:209]
    v_lshlrev_b32 v208, 16, v89
    v_and_b32 v209, 0xffff0000, v89
    v_pk_add_f32 v[14:15], v[14:15], v[208:209]
    v_lshlrev_b32 v208, 16, v90
    v_and_b32 v209, 0xffff0000, v90
    v_pk_add_f32 v[28:29], v[28:29], v[208:209]
    v_lshlrev_b32 v208, 16, v91
    v_and_b32 v209, 0xffff0000, v91
    v_pk_add_f32 v[30:31], v[30:31], v[208:209]
    s_waitcnt vmcnt(1)
    v_lshlrev_b32 v208, 16, v92
    v_and_b32 v209, 0xffff0000, v92
    v_pk_add_f32 v[44:45], v[44:45], v[208:209]
    v_lshlrev_b32 v208, 16, v93
    v_and_b32 v209, 0xffff0000, v93
    v_pk_add_f32 v[46:47], v[46:47], v[208:209]
    v_lshlrev_b32 v208, 16, v94
    v_and_b32 v209, 0xffff0000, v94
    v_pk_add_f32 v[60:61], v[60:61], v[208:209]
    v_lshlrev_b32 v208, 16, v95
    v_and_b32 v209, 0xffff0000, v95
PAD_220:
    s_cbranch_execz PAD_221
    v_pk_add_f32 v[62:63], v[62:63], v[208:209]
    s_waitcnt vmcnt(0)
    v_lshlrev_b32 v208, 16, v96
    v_and_b32 v209, 0xffff0000, v96
    v_pk_add_f32 v[76:77], v[76:77], v[208:209]
    v_lshlrev_b32 v208, 16, v97
    v_and_b32 v209, 0xffff0000, v97
    v_pk_add_f32 v[78:79], v[78:79], v[208:209]
    s_waitcnt lgkmcnt(0)
    s_barrier
    ds_read_b128 v[8:11], v108 offset:32768
    ds_read_b128 v[16:19], v108 offset:47104
    ds_read_b128 v[20:23], v108 offset:0
    ds_read_b128 v[24:27], v108 offset:35840
    ds_read_b128 v[32:35], v108 offset:50176
    ds_read_b128 v[36:39], v108 offset:3072
    ds_read_b128 v[40:43], v108 offset:38912
    ds_read_b128 v[48:51], v108 offset:53248
    ds_read_b128 v[52:55], v108 offset:6144
    ds_read_b128 v[56:59], v108 offset:41984
    ds_read_b128 v[64:67], v108 offset:56320
    ds_read_b128 v[68:71], v108 offset:9216
    ds_read_b128 v[72:75], v108 offset:45056
    ds_read_b128 v[80:83], v108 offset:59392
    ds_read_b128 v[84:87], v108 offset:12288
    s_waitcnt lgkmcnt(14)
    v_pk_add_f32 v[12:13], v[12:13], v[8:9]
    s_waitcnt lgkmcnt(12)
    v_pk_add_f32 v[16:17], v[16:17], v[20:21]
    v_pk_add_f32 v[14:15], v[14:15], v[10:11]
    v_pk_add_f32 v[18:19], v[18:19], v[22:23]
    v_pk_add_f32 v[12:13], v[12:13], v[16:17]
    v_pk_add_f32 v[14:15], v[14:15], v[18:19]
    v_cvt_pk_bf16_f32 v88, v12, v13
    v_cvt_pk_bf16_f32 v89, v14, v15
PAD_221:
    s_cbranch_execz SCB_ret
    s_waitcnt lgkmcnt(11)
    v_pk_add_f32 v[28:29], v[28:29], v[24:25]
    s_waitcnt lgkmcnt(9)
    v_pk_add_f32 v[32:33], v[32:33], v[36:37]
    v_pk_add_f32 v[30:31], v[30:31], v[26:27]
    v_pk_add_f32 v[34:35], v[34:35], v[38:39]
    v_pk_add_f32 v[28:29], v[28:29], v[32:33]
    v_pk_add_f32 v[30:31], v[30:31], v[34:35]
    v_cvt_pk_bf16_f32 v90, v28, v29
    v_cvt_pk_bf16_f32 v91, v30, v31
    buffer_store_dwordx4 v[88:91], v110, s[40:43], s48 offen offset:0
    s_waitcnt lgkmcnt(8)
    v_pk_add_f32 v[44:45], v[44:45], v[40:41]
    s_waitcnt lgkmcnt(6)
    v_pk_add_f32 v[48:49], v[48:49], v[52:53]
    v_pk_add_f32 v[46:47], v[46:47], v[42:43]
    v_pk_add_f32 v[50:51], v[50:51], v[54:55]
    v_pk_add_f32 v[44:45], v[44:45], v[48:49]
    v_pk_add_f32 v[46:47], v[46:47], v[50:51]
    v_cvt_pk_bf16_f32 v92, v44, v45
    v_cvt_pk_bf16_f32 v93, v46, v47
    s_waitcnt lgkmcnt(5)
    v_pk_add_f32 v[60:61], v[60:61], v[56:57]
    s_waitcnt lgkmcnt(3)
    v_pk_add_f32 v[64:65], v[64:65], v[68:69]
    v_pk_add_f32 v[62:63], v[62:63], v[58:59]
    v_pk_add_f32 v[66:67], v[66:67], v[70:71]
    v_pk_add_f32 v[60:61], v[60:61], v[64:65]
    v_pk_add_f32 v[62:63], v[62:63], v[66:67]
    v_cvt_pk_bf16_f32 v94, v60, v61
    v_cvt_pk_bf16_f32 v95, v62, v63
    buffer_store_dwordx4 v[92:95], v110, s[40:43], s48 offen offset:64
    s_waitcnt lgkmcnt(2)
    v_pk_add_f32 v[76:77], v[76:77], v[72:73]
    s_waitcnt lgkmcnt(0)
    v_pk_add_f32 v[80:81], v[80:81], v[84:85]
SCB_e45:
PAD_222:
    s_cbranch_execz PAD_223
    v_pk_add_f32 v[78:79], v[78:79], v[74:75]
    v_pk_add_f32 v[82:83], v[82:83], v[86:87]
    v_pk_add_f32 v[76:77], v[76:77], v[80:81]
    v_pk_add_f32 v[78:79], v[78:79], v[82:83]
    v_cvt_pk_bf16_f32 v96, v76, v77
    v_cvt_pk_bf16_f32 v97, v78, v79
    buffer_store_dwordx2 v[96:97], v111, s[40:43], s48 offen offset:128
    s_branch G2_done_80
G2_red_78:
    v_mfma_f32_16x16x32_bf16 v[8:11], a[180:183], v[160:163], v[8:11]
    v_mfma_f32_16x16x32_bf16 v[24:27], a[184:187], v[160:163], v[24:27]
    v_mfma_f32_16x16x32_bf16 v[40:43], a[188:191], v[160:163], v[40:43]
    v_mfma_f32_16x16x32_bf16 v[56:59], a[192:195], v[160:163], v[56:59]
    v_mfma_f32_16x16x32_bf16 v[72:75], a[196:199], v[160:163], v[72:75]
    s_nop 3
    ds_write_b128 v108, v[8:11] offset:31744
    v_mfma_f32_16x16x32_bf16 v[12:15], a[180:183], v[164:167], v[12:15]
    ds_write_b128 v108, v[24:27] offset:34816
    v_mfma_f32_16x16x32_bf16 v[28:31], a[184:187], v[164:167], v[28:31]
    ds_write_b128 v108, v[40:43] offset:37888
    v_mfma_f32_16x16x32_bf16 v[44:47], a[188:191], v[164:167], v[44:47]
    ds_write_b128 v108, v[56:59] offset:40960
    v_mfma_f32_16x16x32_bf16 v[60:63], a[192:195], v[164:167], v[60:63]
    ds_write_b128 v108, v[72:75] offset:44032
    v_mfma_f32_16x16x32_bf16 v[76:79], a[196:199], v[164:167], v[76:79]
    ds_write_b128 v108, v[12:15] offset:32768
    v_mfma_f32_16x16x32_bf16 v[20:23], a[180:183], v[172:175], v[20:23]
    ds_write_b128 v108, v[28:31] offset:35840
    v_mfma_f32_16x16x32_bf16 v[36:39], a[184:187], v[172:175], v[36:39]
    ds_write_b128 v108, v[44:47] offset:38912
    v_mfma_f32_16x16x32_bf16 v[52:55], a[188:191], v[172:175], v[52:55]
    ds_write_b128 v108, v[60:63] offset:41984
    v_mfma_f32_16x16x32_bf16 v[68:71], a[192:195], v[172:175], v[68:71]
PAD_223:
    s_cbranch_execz PAD_224
    ds_write_b128 v108, v[76:79] offset:45056
    v_mfma_f32_16x16x32_bf16 v[84:87], a[196:199], v[172:175], v[84:87]
    ds_write_b128 v108, v[20:23] offset:30720
    v_mfma_f32_16x16x32_bf16 v[16:19], a[180:183], v[168:171], v[16:19]
    ds_write_b128 v108, v[36:39] offset:33792
    v_mfma_f32_16x16x32_bf16 v[32:35], a[184:187], v[168:171], v[32:35]
    ds_write_b128 v108, v[52:55] offset:36864
    v_mfma_f32_16x16x32_bf16 v[48:51], a[188:191], v[168:171], v[48:51]
    ds_write_b128 v108, v[68:71] offset:39936
    v_mfma_f32_16x16x32_bf16 v[64:67], a[192:195], v[168:171], v[64:67]
    ds_write_b128 v108, v[84:87] offset:43008
    v_mfma_f32_16x16x32_bf16 v[80:83], a[196:199], v[168:171], v[80:83]
    v_lshrrev_b32 v192, 4, v1
    v_and_b32 v193, 15, v1
    v_mul_u32_u24 v110, 81920, v193
    v_lshl_add_u32 v111, v192, 3, v110
    v_lshl_add_u32 v110, v192, 4, v110
    s_and_b32 s48, s26, 1
    s_lshl_b32 s48, s48, 5
    s_lshr_b32 s49, s26, 1
    s_add_u32 s48, s48, s49
    s_lshl_b32 s48, s48, 5
    s_add_u32 s48, s48, s27
    s_mul_i32 s48, s48, 1280
    s_mul_i32 s49, s28, 160
    s_add_u32 s48, s48, s49
    s_waitcnt vmcnt(2)
    v_lshlrev_b32 v208, 16, v88
    v_and_b32 v209, 0xffff0000, v88
    v_pk_add_f32 v[16:17], v[16:17], v[208:209]
    v_lshlrev_b32 v208, 16, v89
    v_and_b32 v209, 0xffff0000, v89
    v_pk_add_f32 v[18:19], v[18:19], v[208:209]
    v_lshlrev_b32 v208, 16, v90
    v_and_b32 v209, 0xffff0000, v90
    v_pk_add_f32 v[32:33], v[32:33], v[208:209]
    v_lshlrev_b32 v208, 16, v91
    v_and_b32 v209, 0xffff0000, v91
    v_pk_add_f32 v[34:35], v[34:35], v[208:209]
PAD_224:
    s_cbranch_execz PAD_225
    s_waitcnt vmcnt(1)
    v_lshlrev_b32 v208, 16, v92
    v_and_b32 v209, 0xffff0000, v92
    v_pk_add_f32 v[48:49], v[48:49], v[208:209]
    v_lshlrev_b32 v208, 16, v93
    v_and_b32 v209, 0xffff0000, v93
    v_pk_add_f32 v[50:51], v[50:51], v[208:209]
    v_lshlrev_b32 v208, 16, v94
    v_and_b32 v209, 0xffff0000, v94
    v_pk_add_f32 v[64:65], v[64:65], v[208:209]
    v_lshlrev_b32 v208, 16, v95
    v_and_b32 v209, 0xffff0000, v95
    v_pk_add_f32 v[66:67], v[66:67], v[208:209]
    s_waitcnt vmcnt(0)
    v_lshlrev_b32 v208, 16, v96
    v_and_b32 v209, 0xffff0000, v96
    v_pk_add_f32 v[80:81], v[80:81], v[208:209]
    v_lshlrev_b32 v208, 16, v97
    v_and_b32 v209, 0xffff0000, v97
    v_pk_add_f32 v[82:83], v[82:83], v[208:209]
    s_waitcnt lgkmcnt(0)
    s_barrier
    ds_read_b128 v[8:11], v108 offset:48128
    ds_read_b128 v[12:15], v108 offset:1024
    ds_read_b128 v[20:23], v108 offset:15360
    ds_read_b128 v[24:27], v108 offset:51200
    ds_read_b128 v[28:31], v108 offset:4096
    ds_read_b128 v[36:39], v108 offset:18432
    ds_read_b128 v[40:43], v108 offset:54272
    ds_read_b128 v[44:47], v108 offset:7168
    ds_read_b128 v[52:55], v108 offset:21504
    ds_read_b128 v[56:59], v108 offset:57344
    ds_read_b128 v[60:63], v108 offset:10240
    ds_read_b128 v[68:71], v108 offset:24576
    ds_read_b128 v[72:75], v108 offset:60416
    ds_read_b128 v[76:79], v108 offset:13312
PAD_225:
    s_cbranch_execz SCB_ret
    ds_read_b128 v[84:87], v108 offset:27648
    s_waitcnt lgkmcnt(14)
    v_pk_add_f32 v[16:17], v[16:17], v[8:9]
    s_waitcnt lgkmcnt(12)
    v_pk_add_f32 v[12:13], v[12:13], v[20:21]
    v_pk_add_f32 v[18:19], v[18:19], v[10:11]
    v_pk_add_f32 v[14:15], v[14:15], v[22:23]
    v_pk_add_f32 v[16:17], v[16:17], v[12:13]
    v_pk_add_f32 v[18:19], v[18:19], v[14:15]
    v_cvt_pk_bf16_f32 v88, v16, v17
    v_cvt_pk_bf16_f32 v89, v18, v19
    s_waitcnt lgkmcnt(11)
    v_pk_add_f32 v[32:33], v[32:33], v[24:25]
    s_waitcnt lgkmcnt(9)
    v_pk_add_f32 v[28:29], v[28:29], v[36:37]
    v_pk_add_f32 v[34:35], v[34:35], v[26:27]
    v_pk_add_f32 v[30:31], v[30:31], v[38:39]
    v_pk_add_f32 v[32:33], v[32:33], v[28:29]
    v_pk_add_f32 v[34:35], v[34:35], v[30:31]
    v_cvt_pk_bf16_f32 v90, v32, v33
    v_cvt_pk_bf16_f32 v91, v34, v35
    buffer_store_dwordx4 v[88:91], v110, s[40:43], s48 offen offset:0
    s_waitcnt lgkmcnt(8)
    v_pk_add_f32 v[48:49], v[48:49], v[40:41]
    s_waitcnt lgkmcnt(6)
    v_pk_add_f32 v[44:45], v[44:45], v[52:53]
    v_pk_add_f32 v[50:51], v[50:51], v[42:43]
    v_pk_add_f32 v[46:47], v[46:47], v[54:55]
    v_pk_add_f32 v[48:49], v[48:49], v[44:45]
    v_pk_add_f32 v[50:51], v[50:51], v[46:47]
    v_cvt_pk_bf16_f32 v92, v48, v49
    v_cvt_pk_bf16_f32 v93, v50, v51
    s_waitcnt lgkmcnt(5)
    v_pk_add_f32 v[64:65], v[64:65], v[56:57]
    s_waitcnt lgkmcnt(3)
    v_pk_add_f32 v[60:61], v[60:61], v[68:69]
SCB_e10:
PAD_226:
    s_cbranch_execz PAD_227
    v_pk_add_f32 v[66:67], v[66:67], v[58:59]
    v_pk_add_f32 v[62:63], v[62:63], v[70:71]
    v_pk_add_f32 v[64:65], v[64:65], v[60:61]
    v_pk_add_f32 v[66:67], v[66:67], v[62:63]
    v_cvt_pk_bf16_f32 v94, v64, v65
    v_cvt_pk_bf16_f32 v95, v66, v67
    buffer_store_dwordx4 v[92:95], v110, s[40:43], s48 offen offset:64
    s_waitcnt lgkmcnt(2)
    v_pk_add_f32 v[80:81], v[80:81], v[72:73]
    s_waitcnt lgkmcnt(0)
    v_pk_add_f32 v[76:77], v[76:77], v[84:85]
    v_pk_add_f32 v[82:83], v[82:83], v[74:75]
    v_pk_add_f32 v[78:79], v[78:79], v[86:87]
    v_pk_add_f32 v[80:81], v[80:81], v[76:77]
    v_pk_add_f32 v[82:83], v[82:83], v[78:79]
    v_cvt_pk_bf16_f32 v96, v80, v81
    v_cvt_pk_bf16_f32 v97, v82, v83
    buffer_store_dwordx2 v[96:97], v111, s[40:43], s48 offen offset:128
    s_branch G2_done_80
G2_red_79:
    ds_write_b128 v108, v[8:11] offset:46080
    ds_write_b128 v108, v[24:27] offset:49152
    ds_write_b128 v108, v[40:43] offset:52224
    ds_write_b128 v108, v[56:59] offset:55296
    ds_write_b128 v108, v[72:75] offset:58368
    ds_write_b128 v108, v[12:15] offset:47104
    ds_write_b128 v108, v[28:31] offset:50176
    ds_write_b128 v108, v[44:47] offset:53248
    ds_write_b128 v108, v[60:63] offset:56320
    ds_write_b128 v108, v[76:79] offset:59392
    ds_write_b128 v108, v[16:19] offset:48128
    ds_write_b128 v108, v[32:35] offset:51200
    ds_write_b128 v108, v[48:51] offset:54272
    ds_write_b128 v108, v[64:67] offset:57344
PAD_227:
    s_cbranch_execz PAD_228
    ds_write_b128 v108, v[80:83] offset:60416
    v_lshrrev_b32 v192, 4, v1
    v_and_b32 v193, 15, v1
    v_mul_u32_u24 v110, 81920, v193
    v_lshl_add_u32 v111, v192, 3, v110
    v_lshl_add_u32 v110, v192, 4, v110
    s_and_b32 s48, s26, 1
    s_lshl_b32 s48, s48, 5
    s_lshr_b32 s49, s26, 1
    s_add_u32 s48, s48, s49
    s_lshl_b32 s48, s48, 5
    s_add_u32 s48, s48, s27
    s_mul_i32 s48, s48, 1280
    s_mul_i32 s49, s28, 160
    s_add_u32 s48, s48, s49
    s_waitcnt vmcnt(2)
    v_lshlrev_b32 v208, 16, v88
    v_and_b32 v209, 0xffff0000, v88
    v_pk_add_f32 v[20:21], v[20:21], v[208:209]
    v_lshlrev_b32 v208, 16, v89
    v_and_b32 v209, 0xffff0000, v89
    v_pk_add_f32 v[22:23], v[22:23], v[208:209]
    v_lshlrev_b32 v208, 16, v90
    v_and_b32 v209, 0xffff0000, v90
    v_pk_add_f32 v[36:37], v[36:37], v[208:209]
    v_lshlrev_b32 v208, 16, v91
    v_and_b32 v209, 0xffff0000, v91
    v_pk_add_f32 v[38:39], v[38:39], v[208:209]
    s_waitcnt vmcnt(1)
    v_lshlrev_b32 v208, 16, v92
    v_and_b32 v209, 0xffff0000, v92
    v_pk_add_f32 v[52:53], v[52:53], v[208:209]
    v_lshlrev_b32 v208, 16, v93
    v_and_b32 v209, 0xffff0000, v93
    v_pk_add_f32 v[54:55], v[54:55], v[208:209]
    v_lshlrev_b32 v208, 16, v94
    v_and_b32 v209, 0xffff0000, v94
    v_pk_add_f32 v[68:69], v[68:69], v[208:209]
    v_lshlrev_b32 v208, 16, v95
    v_and_b32 v209, 0xffff0000, v95
    v_pk_add_f32 v[70:71], v[70:71], v[208:209]
PAD_228:
    s_cbranch_execz PAD_229
    s_waitcnt vmcnt(0)
    v_lshlrev_b32 v208, 16, v96
    v_and_b32 v209, 0xffff0000, v96
    v_pk_add_f32 v[84:85], v[84:85], v[208:209]
    v_lshlrev_b32 v208, 16, v97
    v_and_b32 v209, 0xffff0000, v97
    v_pk_add_f32 v[86:87], v[86:87], v[208:209]
    s_waitcnt lgkmcnt(0)
    s_barrier
    ds_read_b128 v[8:11], v108 offset:2048
    ds_read_b128 v[12:15], v108 offset:16384
    ds_read_b128 v[16:19], v108 offset:30720
    ds_read_b128 v[24:27], v108 offset:5120
    ds_read_b128 v[28:31], v108 offset:19456
    ds_read_b128 v[32:35], v108 offset:33792
    ds_read_b128 v[40:43], v108 offset:8192
    ds_read_b128 v[44:47], v108 offset:22528
    ds_read_b128 v[48:51], v108 offset:36864
    ds_read_b128 v[56:59], v108 offset:11264
    ds_read_b128 v[60:63], v108 offset:25600
    ds_read_b128 v[64:67], v108 offset:39936
    ds_read_b128 v[72:75], v108 offset:14336
    ds_read_b128 v[76:79], v108 offset:28672
    ds_read_b128 v[80:83], v108 offset:43008
    s_waitcnt lgkmcnt(14)
    v_pk_add_f32 v[20:21], v[20:21], v[8:9]
    s_waitcnt lgkmcnt(12)
    v_pk_add_f32 v[12:13], v[12:13], v[16:17]
    v_pk_add_f32 v[22:23], v[22:23], v[10:11]
    v_pk_add_f32 v[14:15], v[14:15], v[18:19]
    v_pk_add_f32 v[20:21], v[20:21], v[12:13]
    v_pk_add_f32 v[22:23], v[22:23], v[14:15]
    v_cvt_pk_bf16_f32 v88, v20, v21
    v_cvt_pk_bf16_f32 v89, v22, v23
    s_waitcnt lgkmcnt(11)
PAD_229:
    s_cbranch_execz SCB_ret
    v_pk_add_f32 v[36:37], v[36:37], v[24:25]
    s_waitcnt lgkmcnt(9)
    v_pk_add_f32 v[28:29], v[28:29], v[32:33]
    v_pk_add_f32 v[38:39], v[38:39], v[26:27]
    v_pk_add_f32 v[30:31], v[30:31], v[34:35]
    v_pk_add_f32 v[36:37], v[36:37], v[28:29]
    v_pk_add_f32 v[38:39], v[38:39], v[30:31]
    v_cvt_pk_bf16_f32 v90, v36, v37
    v_cvt_pk_bf16_f32 v91, v38, v39
    buffer_store_dwordx4 v[88:91], v110, s[40:43], s48 offen offset:0
    s_waitcnt lgkmcnt(8)
    v_pk_add_f32 v[52:53], v[52:53], v[40:41]
    s_waitcnt lgkmcnt(6)
    v_pk_add_f32 v[44:45], v[44:45], v[48:49]
    v_pk_add_f32 v[54:55], v[54:55], v[42:43]
    v_pk_add_f32 v[46:47], v[46:47], v[50:51]
    v_pk_add_f32 v[52:53], v[52:53], v[44:45]
    v_pk_add_f32 v[54:55], v[54:55], v[46:47]
    v_cvt_pk_bf16_f32 v92, v52, v53
    v_cvt_pk_bf16_f32 v93, v54, v55
    s_waitcnt lgkmcnt(5)
    v_pk_add_f32 v[68:69], v[68:69], v[56:57]
    s_waitcnt lgkmcnt(3)
    v_pk_add_f32 v[60:61], v[60:61], v[64:65]
    v_pk_add_f32 v[70:71], v[70:71], v[58:59]
    v_pk_add_f32 v[62:63], v[62:63], v[66:67]
    v_pk_add_f32 v[68:69], v[68:69], v[60:61]
    v_pk_add_f32 v[70:71], v[70:71], v[62:63]
    v_cvt_pk_bf16_f32 v94, v68, v69
    v_cvt_pk_bf16_f32 v95, v70, v71
    buffer_store_dwordx4 v[92:95], v110, s[40:43], s48 offen offset:64
    s_waitcnt lgkmcnt(2)
    v_pk_add_f32 v[84:85], v[84:85], v[72:73]
    s_waitcnt lgkmcnt(0)
    v_pk_add_f32 v[76:77], v[76:77], v[80:81]
SCB_e22:
PAD_230:
    s_cbranch_execz PAD_231
    v_pk_add_f32 v[86:87], v[86:87], v[74:75]
    v_pk_add_f32 v[78:79], v[78:79], v[82:83]
    v_pk_add_f32 v[84:85], v[84:85], v[76:77]
    v_pk_add_f32 v[86:87], v[86:87], v[78:79]
    v_cvt_pk_bf16_f32 v96, v84, v85
    v_cvt_pk_bf16_f32 v97, v86, v87
    buffer_store_dwordx2 v[96:97], v111, s[40:43], s48 offen offset:128
G2_done_80:
main_kernel_exit:
    s_endpgm
flg_retry_5:
    s_sub_u32 s55, s55, 1
    s_cbranch_scc1 flg_retry_5_out
    s_sleep 1
    buffer_load_dword v248, v249, s[60:63], 0 offen sc1
    s_waitcnt vmcnt(0)
    v_readfirstlane_b32 s57, v248
    s_nop 3
    s_or_b32 s57, s57, s26
    s_cmp_eq_u32 s57, 0
    s_cbranch_scc1 flg_retry_5
    s_branch flg_4
flg_retry_5_out:
    s_mov_b32 s55, 0
    s_branch flg_4
flg_retry_7:
    s_sub_u32 s55, s55, 1
    s_cbranch_scc1 flg_retry_7_out
    s_sleep 1
    buffer_load_dword v248, v249, s[60:63], 0 offen sc1
    s_waitcnt vmcnt(0)
    v_readfirstlane_b32 s57, v248
    s_nop 3
    s_or_b32 s57, s57, s26
    s_cmp_eq_u32 s57, 0
    s_cbranch_scc1 flg_retry_7
    s_branch flg_6
flg_retry_7_out:
    s_mov_b32 s55, 0
    s_branch flg_6
K1_st3:
    buffer_store_dwordx4 v[184:187], v87, s[32:35], s40 offen offset:0 sc1
    buffer_store_dwordx4 v[188:191], v87, s[32:35], s40 offen offset:16 sc1
    v_xor_b32 v193, 0x80000000, v193
    v_xor_b32 v195, 0x80000000, v195
    buffer_store_dwordx4 v[192:195], v88, s[32:35], s40 offen offset:0 sc1
    v_xor_b32 v197, 0x80000000, v197
    v_xor_b32 v199, 0x80000000, v199
    buffer_store_dwordx4 v[196:199], v88, s[32:35], s40 offen offset:16 sc1
    s_waitcnt vmcnt(0)
    s_branch K1_out
flg_retry_10:
    s_sub_u32 s55, s55, 1
    s_cbranch_scc1 flg_retry_10_out
PAD_231:
    s_cbranch_execz PAD_232
    s_sleep 1
    buffer_load_dword v248, v249, s[60:63], 0 offen sc1
    s_waitcnt vmcnt(0)
    v_readfirstlane_b32 s57, v248
    s_nop 3
    s_or_b32 s57, s57, s26
    s_cmp_eq_u32 s57, 0
    s_cbranch_scc1 flg_retry_10
    s_branch flg_9
flg_retry_10_out:
    s_mov_b32 s55, 0
    s_branch flg_9
flg_retry_14:
    s_sub_u32 s55, s55, 1
    s_cbranch_scc1 flg_retry_14_out
    s_sleep 1
    buffer_load_dwordx4 v[252:255], v251, s[32:35], s101 offen sc1
    s_waitcnt vmcnt(0)
    v_or3_b32 v184, v252, v253, v254
    v_bitop3_b32 v184, v184, v255, 2 bitop3:0xa8
    v_cmp_ne_u32 vcc, 0, v184
    s_nop 3
    s_cmp_lg_u64 vcc, 0
    s_cbranch_scc1 flg_retry_14
    s_branch flg_13
flg_retry_14_out:
    s_mov_b32 s55, 0
    s_branch flg_13
col_retry_12:
    s_sub_u32 s55, s55, 1
    s_cbranch_scc1 col_retry_12_out
    s_sleep 1
    s_cmp_eq_u64 s[48:49], 0
    s_cbranch_scc1 col_retry_12_q
    buffer_load_dwordx4 v[88:91], v80, s[32:35], 0 offen offset:0 sc1
    buffer_load_dwordx4 v[92:95], v80, s[32:35], 0 offen offset:128 sc1
    buffer_load_dwordx4 v[96:99], v80, s[32:35], 0 offen offset:256 sc1
    buffer_load_dwordx4 v[100:103], v80, s[32:35], 0 offen offset:384 sc1
col_retry_12_q:
    s_cbranch_vccz col_retry_12_w
    s_mov_b32 s50, 0xc83000
    buffer_load_dwordx4 v[152:155], v85, s[32:35], s50 offen sc1
    s_mov_b32 s50, 0xc84000
    buffer_load_dwordx4 v[156:159], v85, s[32:35], s50 offen sc1
    s_mov_b32 s50, 0xc85000
    buffer_load_dwordx4 v[160:163], v85, s[32:35], s50 offen sc1
    s_mov_b32 s50, 0xc86000
    buffer_load_dwordx4 v[164:167], v85, s[32:35], s50 offen sc1
    s_mov_b32 s50, 0xc87000
    buffer_load_dwordx4 v[168:171], v85, s[32:35], s50 offen sc1
PAD_232:
    s_cbranch_execz PAD_233
    s_mov_b32 s50, 0xc88000
    buffer_load_dwordx4 v[172:175], v85, s[32:35], s50 offen sc1
    s_mov_b32 s50, 0xc89000
    buffer_load_dwordx4 v[176:179], v85, s[32:35], s50 offen sc1
    s_mov_b32 s50, 0xc8a000
    buffer_load_dwordx4 v[180:183], v85, s[32:35], s50 offen sc1
col_retry_12_w:
    s_waitcnt vmcnt(0)
    s_branch col_chk_11
col_retry_12_out:
    s_mov_b32 s55, 0
    s_branch col_chk_11_ok
col_retry_120:
    s_sub_u32 s55, s55, 1
    s_cbranch_scc1 col_retry_120_out
    s_sleep 1
    s_cmp_eq_u64 s[48:49], 0
    s_cbranch_scc1 col_retry_120_q
    buffer_load_dwordx4 v[88:91], v80, s[32:35], 0 offen offset:0 sc1
    buffer_load_dwordx4 v[92:95], v80, s[32:35], 0 offen offset:128 sc1
    buffer_load_dwordx4 v[96:99], v80, s[32:35], 0 offen offset:256 sc1
    buffer_load_dwordx4 v[100:103], v80, s[32:35], 0 offen offset:384 sc1
col_retry_120_q:
    s_cbranch_vccz col_retry_120_w
    s_mov_b32 s50, 0xb7c000
    buffer_load_dwordx2 v[152:153], v85, s[32:35], s50 offen offset:0 sc1
    buffer_load_dwordx2 v[154:155], v85, s[32:35], s50 offen offset:64 sc1
    buffer_load_dwordx2 v[156:157], v85, s[32:35], s50 offen offset:128 sc1
    buffer_load_dwordx2 v[158:159], v85, s[32:35], s50 offen offset:192 sc1
col_retry_120_w:
    s_waitcnt vmcnt(0)
    s_branch col_chk_110
col_retry_120_out:
    s_mov_b32 s55, 0
    s_branch col_chk_110_ok
flg_retry_17:
    s_sub_u32 s55, s55, 1
    s_cbranch_scc1 flg_retry_17_out
    s_sleep 2
    buffer_load_dwordx4 v[252:255], v251, s[32:35], s101 offen sc1
    s_waitcnt vmcnt(0)
    v_or3_b32 v184, v252, v253, v254
    v_bitop3_b32 v184, v184, v255, 2 bitop3:0xa8
    v_cmp_ne_u32 vcc, 0, v184
    s_nop 3
    s_cmp_lg_u64 vcc, 0
    s_cbranch_scc1 flg_retry_17
    s_branch flg_16
flg_retry_17_out:
    s_mov_b32 s55, 0
    s_branch flg_16
flg_retry_24:
    s_sub_u32 s55, s55, 1
    s_cbranch_scc1 flg_retry_24_out
PAD_233:
    s_cbranch_execz SCB_ret
    s_sleep 2
    buffer_load_dwordx4 v[252:255], v251, s[32:35], s101 offen sc1
    s_waitcnt vmcnt(0)
    v_or3_b32 v14, v252, v253, v254
    v_bitop3_b32 v14, v14, v255, 2 bitop3:0xa8
    v_cmp_ne_u32 vcc, 0, v14
    s_nop 3
    s_cmp_lg_u64 vcc, 0
    s_cbranch_scc1 flg_retry_24
    s_branch flg_23
flg_retry_24_out:
    s_mov_b32 s55, 0
    s_branch flg_23
flg_retry_26:
    s_sub_u32 s55, s55, 1
    s_cbranch_scc1 flg_retry_26_out
    s_sleep 2
    buffer_load_dwordx4 v[12:15], v8, s[32:35], s101 offen sc1
    s_waitcnt vmcnt(0)
    v_or3_b32 v9, v12, v13, v14
    v_bitop3_b32 v9, v9, v15, 2 bitop3:0xa8
    v_cmp_ne_u32 vcc, 0, v9
    s_nop 3
    s_cmp_lg_u64 vcc, 0
    s_cbranch_scc1 flg_retry_26
    s_branch flg_25
flg_retry_26_out:
    s_mov_b32 s55, 0
    s_branch flg_25
flg_retry_33:
    s_sub_u32 s55, s55, 1
    s_cbranch_scc1 flg_retry_33_out
    s_sleep 1
    buffer_load_dwordx2 v[4:5], off, s[32:35], s50 sc1
    s_waitcnt vmcnt(0)
    v_or_b32 v4, v4, v5
    s_nop 0
    v_readfirstlane_b32 s49, v4
    s_nop 3
    s_cmp_lg_u32 s49, 0
    s_cbranch_scc1 flg_retry_33
    s_branch flg_32
flg_retry_33_out:
    s_mov_b32 s55, 0
    s_branch flg_32
flg_retry_39:
    s_sub_u32 s55, s55, 1
    s_cbranch_scc1 flg_retry_39_out
    s_sleep 1
    buffer_load_dwordx2 v[4:5], off, s[32:35], s50 sc1
    s_waitcnt vmcnt(0)
    v_or_b32 v4, v4, v5
    s_nop 0
    v_readfirstlane_b32 s49, v4
    s_nop 3
    s_cmp_lg_u32 s49, 0
    s_cbranch_scc1 flg_retry_39
    s_branch flg_38
flg_retry_39_out:
    s_mov_b32 s55, 0
    s_branch flg_38
G2_retry_42:
    s_sub_u32 s55, s55, 1
SCB_e34:
PAD_234:
    s_cbranch_execz PAD_235
    s_cbranch_scc1 G2_retry_42_out
    s_mov_b32 s48, 0x0
    buffer_load_dwordx4 v[192:195], v7, s[32:35], s48 offen offset:0 sc1
    buffer_load_dwordx4 v[196:199], v7, s[32:35], s48 offen offset:256 sc1
    buffer_load_dwordx4 v[200:203], v7, s[32:35], s48 offen offset:512 sc1
    buffer_load_dwordx4 v[204:207], v7, s[32:35], s48 offen offset:768 sc1
    s_mov_b32 s48, 0x1000
    buffer_load_dwordx4 v[208:211], v7, s[32:35], s48 offen offset:0 sc1
    buffer_load_dwordx4 v[212:215], v7, s[32:35], s48 offen offset:256 sc1
    buffer_load_dwordx4 v[216:219], v7, s[32:35], s48 offen offset:512 sc1
    buffer_load_dwordx4 v[220:223], v7, s[32:35], s48 offen offset:768 sc1
    s_mov_b32 s48, 0x2000
    buffer_load_dwordx4 v[224:227], v7, s[32:35], s48 offen offset:0 sc1
    buffer_load_dwordx4 v[228:231], v7, s[32:35], s48 offen offset:256 sc1
    buffer_load_dwordx4 v[232:235], v7, s[32:35], s48 offen offset:512 sc1
    buffer_load_dwordx4 v[236:239], v7, s[32:35], s48 offen offset:768 sc1
    s_mov_b32 s48, 0x3000
    buffer_load_dwordx4 v[240:243], v7, s[32:35], s48 offen offset:0 sc1
    buffer_load_dwordx4 v[244:247], v7, s[32:35], s48 offen offset:256 sc1
    buffer_load_dwordx4 v[248:251], v7, s[32:35], s48 offen offset:512 sc1
    buffer_load_dwordx4 v[252:255], v7, s[32:35], s48 offen offset:768 sc1
    s_waitcnt vmcnt(0)
    v_bitop3_b32 v4, v192, v196, v200 bitop3:0xfe
    v_bitop3_b32 v4, v4, v204, 1 bitop3:0xa8
    v_cmp_ne_u32 vcc, 0, v4
    s_nop 3
    s_cbranch_vccnz G2_retry_42
    s_branch G2_retry_42_ok
G2_retry_42_out:
    s_mov_b32 s55, 0
    s_branch G2_retry_42_ok
G2_retry_43:
    s_sub_u32 s55, s55, 1
    s_cbranch_scc1 G2_retry_43_out
    s_mov_b32 s48, 0x1000
    buffer_load_dwordx4 v[208:211], v7, s[32:35], s48 offen offset:0 sc1
    buffer_load_dwordx4 v[212:215], v7, s[32:35], s48 offen offset:256 sc1
    buffer_load_dwordx4 v[216:219], v7, s[32:35], s48 offen offset:512 sc1
    buffer_load_dwordx4 v[220:223], v7, s[32:35], s48 offen offset:768 sc1
PAD_235:
    s_cbranch_execz PAD_236
    s_mov_b32 s48, 0x2000
    buffer_load_dwordx4 v[224:227], v7, s[32:35], s48 offen offset:0 sc1
    buffer_load_dwordx4 v[228:231], v7, s[32:35], s48 offen offset:256 sc1
    buffer_load_dwordx4 v[232:235], v7, s[32:35], s48 offen offset:512 sc1
    buffer_load_dwordx4 v[236:239], v7, s[32:35], s48 offen offset:768 sc1
    s_mov_b32 s48, 0x3000
    buffer_load_dwordx4 v[240:243], v7, s[32:35], s48 offen offset:0 sc1
    buffer_load_dwordx4 v[244:247], v7, s[32:35], s48 offen offset:256 sc1
    buffer_load_dwordx4 v[248:251], v7, s[32:35], s48 offen offset:512 sc1
    buffer_load_dwordx4 v[252:255], v7, s[32:35], s48 offen offset:768 sc1
    s_mov_b32 s48, 0x4000
    buffer_load_dwordx4 v[112:115], v7, s[32:35], s48 offen offset:0 sc1
    buffer_load_dwordx4 v[116:119], v7, s[32:35], s48 offen offset:256 sc1
    buffer_load_dwordx4 v[120:123], v7, s[32:35], s48 offen offset:512 sc1
    buffer_load_dwordx4 v[124:127], v7, s[32:35], s48 offen offset:768 sc1
    s_waitcnt vmcnt(0)
    v_bitop3_b32 v4, v208, v212, v216 bitop3:0xfe
    v_bitop3_b32 v4, v4, v220, 1 bitop3:0xa8
    v_cmp_ne_u32 vcc, 0, v4
    s_nop 3
    s_cbranch_vccnz G2_retry_43
    s_branch G2_retry_43_ok
G2_retry_43_out:
    s_mov_b32 s55, 0
    s_branch G2_retry_43_ok
G2_retry_44:
    s_sub_u32 s55, s55, 1
    s_cbranch_scc1 G2_retry_44_out
    s_mov_b32 s48, 0x2000
    buffer_load_dwordx4 v[224:227], v7, s[32:35], s48 offen offset:0 sc1
    buffer_load_dwordx4 v[228:231], v7, s[32:35], s48 offen offset:256 sc1
    buffer_load_dwordx4 v[232:235], v7, s[32:35], s48 offen offset:512 sc1
    buffer_load_dwordx4 v[236:239], v7, s[32:35], s48 offen offset:768 sc1
    s_mov_b32 s48, 0x3000
    buffer_load_dwordx4 v[240:243], v7, s[32:35], s48 offen offset:0 sc1
    buffer_load_dwordx4 v[244:247], v7, s[32:35], s48 offen offset:256 sc1
    buffer_load_dwordx4 v[248:251], v7, s[32:35], s48 offen offset:512 sc1
    buffer_load_dwordx4 v[252:255], v7, s[32:35], s48 offen offset:768 sc1
PAD_236:
    s_cbranch_execz SCB_ret
    s_mov_b32 s48, 0x4000
    buffer_load_dwordx4 v[112:115], v7, s[32:35], s48 offen offset:0 sc1
    buffer_load_dwordx4 v[116:119], v7, s[32:35], s48 offen offset:256 sc1
    buffer_load_dwordx4 v[120:123], v7, s[32:35], s48 offen offset:512 sc1
    buffer_load_dwordx4 v[124:127], v7, s[32:35], s48 offen offset:768 sc1
    s_mov_b32 s48, 0x5000
    buffer_load_dwordx4 v[192:195], v7, s[32:35], s48 offen offset:0 sc1
    buffer_load_dwordx4 v[196:199], v7, s[32:35], s48 offen offset:256 sc1
    buffer_load_dwordx4 v[200:203], v7, s[32:35], s48 offen offset:512 sc1
    buffer_load_dwordx4 v[204:207], v7, s[32:35], s48 offen offset:768 sc1
    s_waitcnt vmcnt(0)
    v_bitop3_b32 v4, v224, v228, v232 bitop3:0xfe
    v_bitop3_b32 v4, v4, v236, 1 bitop3:0xa8
    v_cmp_ne_u32 vcc, 0, v4
    s_nop 3
    s_cbranch_vccnz G2_retry_44
    s_branch G2_retry_44_ok
G2_retry_44_out:
    s_mov_b32 s55, 0
    s_branch G2_retry_44_ok
G2_retry_45:
    s_sub_u32 s55, s55, 1
    s_cbranch_scc1 G2_retry_45_out
    s_mov_b32 s48, 0x3000
    buffer_load_dwordx4 v[240:243], v7, s[32:35], s48 offen offset:0 sc1
    buffer_load_dwordx4 v[244:247], v7, s[32:35], s48 offen offset:256 sc1
    buffer_load_dwordx4 v[248:251], v7, s[32:35], s48 offen offset:512 sc1
    buffer_load_dwordx4 v[252:255], v7, s[32:35], s48 offen offset:768 sc1
    s_mov_b32 s48, 0x4000
    buffer_load_dwordx4 v[112:115], v7, s[32:35], s48 offen offset:0 sc1
    buffer_load_dwordx4 v[116:119], v7, s[32:35], s48 offen offset:256 sc1
    buffer_load_dwordx4 v[120:123], v7, s[32:35], s48 offen offset:512 sc1
    buffer_load_dwordx4 v[124:127], v7, s[32:35], s48 offen offset:768 sc1
    s_mov_b32 s48, 0x5000
    buffer_load_dwordx4 v[192:195], v7, s[32:35], s48 offen offset:0 sc1
    buffer_load_dwordx4 v[196:199], v7, s[32:35], s48 offen offset:256 sc1
    buffer_load_dwordx4 v[200:203], v7, s[32:35], s48 offen offset:512 sc1
    buffer_load_dwordx4 v[204:207], v7, s[32:35], s48 offen offset:768 sc1
SCB_e46:
PAD_237:
    s_cbranch_execz PAD_238
    s_mov_b32 s48, 0x6000
    buffer_load_dwordx4 v[128:131], v7, s[32:35], s48 offen offset:0 sc1
    buffer_load_dwordx4 v[132:135], v7, s[32:35], s48 offen offset:256 sc1
    buffer_load_dwordx4 v[136:139], v7, s[32:35], s48 offen offset:512 sc1
    buffer_load_dwordx4 v[140:143], v7, s[32:35], s48 offen offset:768 sc1
    s_waitcnt vmcnt(0)
    v_bitop3_b32 v4, v240, v244, v248 bitop3:0xfe
    v_bitop3_b32 v4, v4, v252, 1 bitop3:0xa8
    v_cmp_ne_u32 vcc, 0, v4
    s_nop 3
    s_cbranch_vccnz G2_retry_45
    s_branch G2_retry_45_ok
G2_retry_45_out:
    s_mov_b32 s55, 0
    s_branch G2_retry_45_ok
G2_retry_46:
    s_sub_u32 s55, s55, 1
    s_cbranch_scc1 G2_retry_46_out
    s_mov_b32 s48, 0x4000
    buffer_load_dwordx4 v[112:115], v7, s[32:35], s48 offen offset:0 sc1
    buffer_load_dwordx4 v[116:119], v7, s[32:35], s48 offen offset:256 sc1
    buffer_load_dwordx4 v[120:123], v7, s[32:35], s48 offen offset:512 sc1
    buffer_load_dwordx4 v[124:127], v7, s[32:35], s48 offen offset:768 sc1
    s_mov_b32 s48, 0x5000
    buffer_load_dwordx4 v[192:195], v7, s[32:35], s48 offen offset:0 sc1
    buffer_load_dwordx4 v[196:199], v7, s[32:35], s48 offen offset:256 sc1
    buffer_load_dwordx4 v[200:203], v7, s[32:35], s48 offen offset:512 sc1
    buffer_load_dwordx4 v[204:207], v7, s[32:35], s48 offen offset:768 sc1
    s_mov_b32 s48, 0x6000
    buffer_load_dwordx4 v[128:131], v7, s[32:35], s48 offen offset:0 sc1
    buffer_load_dwordx4 v[132:135], v7, s[32:35], s48 offen offset:256 sc1
    buffer_load_dwordx4 v[136:139], v7, s[32:35], s48 offen offset:512 sc1
    buffer_load_dwordx4 v[140:143], v7, s[32:35], s48 offen offset:768 sc1
    s_mov_b32 s48, 0x7000
    buffer_load_dwordx4 v[208:211], v7, s[32:35], s48 offen offset:0 sc1
    buffer_load_dwordx4 v[212:215], v7, s[32:35], s48 offen offset:256 sc1
    buffer_load_dwordx4 v[216:219], v7, s[32:35], s48 offen offset:512 sc1
    buffer_load_dwordx4 v[220:223], v7, s[32:35], s48 offen offset:768 sc1
PAD_238:
    s_cbranch_execz PAD_239
    s_waitcnt vmcnt(0)
    v_bitop3_b32 v4, v112, v116, v120 bitop3:0xfe
    v_bitop3_b32 v4, v4, v124, 1 bitop3:0xa8
    v_cmp_ne_u32 vcc, 0, v4
    s_nop 3
    s_cbranch_vccnz G2_retry_46
    s_branch G2_retry_46_ok
G2_retry_46_out:
    s_mov_b32 s55, 0
    s_branch G2_retry_46_ok
G2_retry_47:
    s_sub_u32 s55, s55, 1
    s_cbranch_scc1 G2_retry_47_out
    s_mov_b32 s48, 0x5000
    buffer_load_dwordx4 v[192:195], v7, s[32:35], s48 offen offset:0 sc1
    buffer_load_dwordx4 v[196:199], v7, s[32:35], s48 offen offset:256 sc1
    buffer_load_dwordx4 v[200:203], v7, s[32:35], s48 offen offset:512 sc1
    buffer_load_dwordx4 v[204:207], v7, s[32:35], s48 offen offset:768 sc1
    s_mov_b32 s48, 0x6000
    buffer_load_dwordx4 v[128:131], v7, s[32:35], s48 offen offset:0 sc1
    buffer_load_dwordx4 v[132:135], v7, s[32:35], s48 offen offset:256 sc1
    buffer_load_dwordx4 v[136:139], v7, s[32:35], s48 offen offset:512 sc1
    buffer_load_dwordx4 v[140:143], v7, s[32:35], s48 offen offset:768 sc1
    s_mov_b32 s48, 0x7000
    buffer_load_dwordx4 v[208:211], v7, s[32:35], s48 offen offset:0 sc1
    buffer_load_dwordx4 v[212:215], v7, s[32:35], s48 offen offset:256 sc1
    buffer_load_dwordx4 v[216:219], v7, s[32:35], s48 offen offset:512 sc1
    buffer_load_dwordx4 v[220:223], v7, s[32:35], s48 offen offset:768 sc1
    s_waitcnt vmcnt(0)
    v_bitop3_b32 v4, v192, v196, v200 bitop3:0xfe
    v_bitop3_b32 v4, v4, v204, 1 bitop3:0xa8
    v_cmp_ne_u32 vcc, 0, v4
    s_nop 3
    s_cbranch_vccnz G2_retry_47
    s_branch G2_retry_47_ok
G2_retry_47_out:
    s_mov_b32 s55, 0
    s_branch G2_retry_47_ok
G2_retry_48:
    s_sub_u32 s55, s55, 1
    s_cbranch_scc1 G2_retry_48_out
    s_mov_b32 s48, 0x6000
    buffer_load_dwordx4 v[128:131], v7, s[32:35], s48 offen offset:0 sc1
    buffer_load_dwordx4 v[132:135], v7, s[32:35], s48 offen offset:256 sc1
    buffer_load_dwordx4 v[136:139], v7, s[32:35], s48 offen offset:512 sc1
PAD_239:
    s_cbranch_execz PAD_240
    buffer_load_dwordx4 v[140:143], v7, s[32:35], s48 offen offset:768 sc1
    s_mov_b32 s48, 0x7000
    buffer_load_dwordx4 v[208:211], v7, s[32:35], s48 offen offset:0 sc1
    buffer_load_dwordx4 v[212:215], v7, s[32:35], s48 offen offset:256 sc1
    buffer_load_dwordx4 v[216:219], v7, s[32:35], s48 offen offset:512 sc1
    buffer_load_dwordx4 v[220:223], v7, s[32:35], s48 offen offset:768 sc1
    s_mov_b32 s48, 0x8000
    buffer_load_dwordx4 v[144:147], v7, s[32:35], s48 offen offset:0 sc1
    buffer_load_dwordx4 v[148:151], v7, s[32:35], s48 offen offset:256 sc1
    buffer_load_dwordx4 v[152:155], v7, s[32:35], s48 offen offset:512 sc1
    buffer_load_dwordx4 v[156:159], v7, s[32:35], s48 offen offset:768 sc1
    s_waitcnt vmcnt(0)
    v_bitop3_b32 v4, v128, v132, v136 bitop3:0xfe
    v_bitop3_b32 v4, v4, v140, 1 bitop3:0xa8
    v_cmp_ne_u32 vcc, 0, v4
    s_nop 3
    s_cbranch_vccnz G2_retry_48
    s_branch G2_retry_48_ok
G2_retry_48_out:
    s_mov_b32 s55, 0
    s_branch G2_retry_48_ok
G2_retry_49:
    s_sub_u32 s55, s55, 1
    s_cbranch_scc1 G2_retry_49_out
    s_mov_b32 s48, 0x7000
    buffer_load_dwordx4 v[208:211], v7, s[32:35], s48 offen offset:0 sc1
    buffer_load_dwordx4 v[212:215], v7, s[32:35], s48 offen offset:256 sc1
    buffer_load_dwordx4 v[216:219], v7, s[32:35], s48 offen offset:512 sc1
    buffer_load_dwordx4 v[220:223], v7, s[32:35], s48 offen offset:768 sc1
    s_mov_b32 s48, 0x8000
    buffer_load_dwordx4 v[144:147], v7, s[32:35], s48 offen offset:0 sc1
    buffer_load_dwordx4 v[148:151], v7, s[32:35], s48 offen offset:256 sc1
    buffer_load_dwordx4 v[152:155], v7, s[32:35], s48 offen offset:512 sc1
    buffer_load_dwordx4 v[156:159], v7, s[32:35], s48 offen offset:768 sc1
    s_mov_b32 s48, 0x9000
    buffer_load_dwordx4 v[224:227], v7, s[32:35], s48 offen offset:0 sc1
    buffer_load_dwordx4 v[228:231], v7, s[32:35], s48 offen offset:256 sc1
    buffer_load_dwordx4 v[232:235], v7, s[32:35], s48 offen offset:512 sc1
PAD_240:
    s_cbranch_execz SCB_ret
    buffer_load_dwordx4 v[236:239], v7, s[32:35], s48 offen offset:768 sc1
    s_waitcnt vmcnt(0)
    v_bitop3_b32 v4, v208, v212, v216 bitop3:0xfe
    v_bitop3_b32 v4, v4, v220, 1 bitop3:0xa8
    v_cmp_ne_u32 vcc, 0, v4
    s_nop 3
    s_cbranch_vccnz G2_retry_49
    s_branch G2_retry_49_ok
G2_retry_49_out:
    s_mov_b32 s55, 0
    s_branch G2_retry_49_ok
G2_retry_50:
    s_sub_u32 s55, s55, 1
    s_cbranch_scc1 G2_retry_50_out
    s_mov_b32 s48, 0x8000
    buffer_load_dwordx4 v[144:147], v7, s[32:35], s48 offen offset:0 sc1
    buffer_load_dwordx4 v[148:151], v7, s[32:35], s48 offen offset:256 sc1
    buffer_load_dwordx4 v[152:155], v7, s[32:35], s48 offen offset:512 sc1
    buffer_load_dwordx4 v[156:159], v7, s[32:35], s48 offen offset:768 sc1
    s_mov_b32 s48, 0x9000
    buffer_load_dwordx4 v[224:227], v7, s[32:35], s48 offen offset:0 sc1
    buffer_load_dwordx4 v[228:231], v7, s[32:35], s48 offen offset:256 sc1
    buffer_load_dwordx4 v[232:235], v7, s[32:35], s48 offen offset:512 sc1
    buffer_load_dwordx4 v[236:239], v7, s[32:35], s48 offen offset:768 sc1
    s_mov_b32 s48, 0xa000
    buffer_load_dwordx4 v[160:163], v7, s[32:35], s48 offen offset:0 sc1
    buffer_load_dwordx4 v[164:167], v7, s[32:35], s48 offen offset:256 sc1
    buffer_load_dwordx4 v[168:171], v7, s[32:35], s48 offen offset:512 sc1
    buffer_load_dwordx4 v[172:175], v7, s[32:35], s48 offen offset:768 sc1
    s_waitcnt vmcnt(0)
    v_bitop3_b32 v4, v144, v148, v152 bitop3:0xfe
    v_bitop3_b32 v4, v4, v156, 1 bitop3:0xa8
    v_cmp_ne_u32 vcc, 0, v4
    s_nop 3
    s_cbranch_vccnz G2_retry_50
    s_branch G2_retry_50_ok
G2_retry_50_out:
    s_mov_b32 s55, 0
    s_branch G2_retry_50_ok
G2_retry_51:
    s_sub_u32 s55, s55, 1
    s_cbranch_scc1 G2_retry_51_out
    s_mov_b32 s48, 0x9000
    buffer_load_dwordx4 v[224:227], v7, s[32:35], s48 offen offset:0 sc1
SCB_e11:
PAD_241:
    s_cbranch_execz PAD_242
    buffer_load_dwordx4 v[228:231], v7, s[32:35], s48 offen offset:256 sc1
    buffer_load_dwordx4 v[232:235], v7, s[32:35], s48 offen offset:512 sc1
    buffer_load_dwordx4 v[236:239], v7, s[32:35], s48 offen offset:768 sc1
    s_mov_b32 s48, 0xa000
    buffer_load_dwordx4 v[160:163], v7, s[32:35], s48 offen offset:0 sc1
    buffer_load_dwordx4 v[164:167], v7, s[32:35], s48 offen offset:256 sc1
    buffer_load_dwordx4 v[168:171], v7, s[32:35], s48 offen offset:512 sc1
    buffer_load_dwordx4 v[172:175], v7, s[32:35], s48 offen offset:768 sc1
    s_waitcnt vmcnt(0)
    v_bitop3_b32 v4, v224, v228, v232 bitop3:0xfe
    v_bitop3_b32 v4, v4, v236, 1 bitop3:0xa8
    v_cmp_ne_u32 vcc, 0, v4
    s_nop 3
    s_cbranch_vccnz G2_retry_51
    s_branch G2_retry_51_ok
G2_retry_51_out:
    s_mov_b32 s55, 0
    s_branch G2_retry_51_ok
G2_retry_52:
    s_sub_u32 s55, s55, 1
    s_cbranch_scc1 G2_retry_52_out
    s_mov_b32 s48, 0xa000
    buffer_load_dwordx4 v[160:163], v7, s[32:35], s48 offen offset:0 sc1
    buffer_load_dwordx4 v[164:167], v7, s[32:35], s48 offen offset:256 sc1
    buffer_load_dwordx4 v[168:171], v7, s[32:35], s48 offen offset:512 sc1
    buffer_load_dwordx4 v[172:175], v7, s[32:35], s48 offen offset:768 sc1
    s_mov_b32 s48, 0xb000
    buffer_load_dwordx4 v[176:179], v7, s[32:35], s48 offen offset:0 sc1
    buffer_load_dwordx4 v[180:183], v7, s[32:35], s48 offen offset:256 sc1
    buffer_load_dwordx4 v[184:187], v7, s[32:35], s48 offen offset:512 sc1
    buffer_load_dwordx4 v[188:191], v7, s[32:35], s48 offen offset:768 sc1
    s_waitcnt vmcnt(0)
    v_bitop3_b32 v4, v160, v164, v168 bitop3:0xfe
    v_bitop3_b32 v4, v4, v172, 1 bitop3:0xa8
    v_cmp_ne_u32 vcc, 0, v4
    s_nop 3
    s_cbranch_vccnz G2_retry_52
    s_branch G2_retry_52_ok
G2_retry_52_out:
    s_mov_b32 s55, 0
    s_branch G2_retry_52_ok
G2_retry_53:
    s_sub_u32 s55, s55, 1
    s_cbranch_scc1 G2_retry_53_out
    s_mov_b32 s48, 0xb000
PAD_242:
    s_cbranch_execz PAD_243
    buffer_load_dwordx4 v[176:179], v7, s[32:35], s48 offen offset:0 sc1
    buffer_load_dwordx4 v[180:183], v7, s[32:35], s48 offen offset:256 sc1
    buffer_load_dwordx4 v[184:187], v7, s[32:35], s48 offen offset:512 sc1
    buffer_load_dwordx4 v[188:191], v7, s[32:35], s48 offen offset:768 sc1
    s_mov_b32 s48, 0xc000
    buffer_load_dwordx4 v[240:243], v7, s[32:35], s48 offen offset:0 sc1
    buffer_load_dwordx4 v[244:247], v7, s[32:35], s48 offen offset:256 sc1
    buffer_load_dwordx4 v[248:251], v7, s[32:35], s48 offen offset:512 sc1
    buffer_load_dwordx4 v[252:255], v7, s[32:35], s48 offen offset:768 sc1
    s_waitcnt vmcnt(0)
    v_bitop3_b32 v4, v176, v180, v184 bitop3:0xfe
    v_bitop3_b32 v4, v4, v188, 1 bitop3:0xa8
    v_cmp_ne_u32 vcc, 0, v4
    s_nop 3
    s_cbranch_vccnz G2_retry_53
    s_branch G2_retry_53_ok
G2_retry_53_out:
    s_mov_b32 s55, 0
    s_branch G2_retry_53_ok
G2_retry_54:
    s_sub_u32 s55, s55, 1
    s_cbranch_scc1 G2_retry_54_out
    s_mov_b32 s48, 0xc000
    buffer_load_dwordx4 v[240:243], v7, s[32:35], s48 offen offset:0 sc1
    buffer_load_dwordx4 v[244:247], v7, s[32:35], s48 offen offset:256 sc1
    buffer_load_dwordx4 v[248:251], v7, s[32:35], s48 offen offset:512 sc1
    buffer_load_dwordx4 v[252:255], v7, s[32:35], s48 offen offset:768 sc1
    s_mov_b32 s48, 0xd000
    buffer_load_dwordx4 v[112:115], v7, s[32:35], s48 offen offset:0 sc1
    buffer_load_dwordx4 v[116:119], v7, s[32:35], s48 offen offset:256 sc1
    buffer_load_dwordx4 v[120:123], v7, s[32:35], s48 offen offset:512 sc1
    buffer_load_dwordx4 v[124:127], v7, s[32:35], s48 offen offset:768 sc1
    s_waitcnt vmcnt(0)
    v_bitop3_b32 v4, v240, v244, v248 bitop3:0xfe
    v_bitop3_b32 v4, v4, v252, 1 bitop3:0xa8
    v_cmp_ne_u32 vcc, 0, v4
    s_nop 3
    s_cbranch_vccnz G2_retry_54
    s_branch G2_retry_54_ok
G2_retry_54_out:
    s_mov_b32 s55, 0
    s_branch G2_retry_54_ok
G2_retry_55:
PAD_243:
    s_cbranch_execz PAD_244
    s_sub_u32 s55, s55, 1
    s_cbranch_scc1 G2_retry_55_out
    s_mov_b32 s48, 0xd000
    buffer_load_dwordx4 v[112:115], v7, s[32:35], s48 offen offset:0 sc1
    buffer_load_dwordx4 v[116:119], v7, s[32:35], s48 offen offset:256 sc1
    buffer_load_dwordx4 v[120:123], v7, s[32:35], s48 offen offset:512 sc1
    buffer_load_dwordx4 v[124:127], v7, s[32:35], s48 offen offset:768 sc1
    s_waitcnt vmcnt(0)
    v_bitop3_b32 v4, v112, v116, v120 bitop3:0xfe
    v_bitop3_b32 v4, v4, v124, 1 bitop3:0xa8
    v_cmp_ne_u32 vcc, 0, v4
    s_nop 3
    s_cbranch_vccnz G2_retry_55
    s_branch G2_retry_55_ok
G2_retry_55_out:
    s_mov_b32 s55, 0
    s_branch G2_retry_55_ok
G2_retry_62:
    s_sub_u32 s55, s55, 1
    s_cbranch_scc1 G2_retry_62_out
    s_mov_b32 s48, 0x0
    buffer_load_dwordx4 v[192:195], v7, s[32:35], s48 offen offset:0 sc1
    buffer_load_dwordx4 v[196:199], v7, s[32:35], s48 offen offset:256 sc1
    buffer_load_dwordx4 v[200:203], v7, s[32:35], s48 offen offset:512 sc1
    buffer_load_dwordx4 v[204:207], v7, s[32:35], s48 offen offset:768 sc1
    s_mov_b32 s48, 0x1000
    buffer_load_dwordx4 v[208:211], v7, s[32:35], s48 offen offset:0 sc1
    buffer_load_dwordx4 v[212:215], v7, s[32:35], s48 offen offset:256 sc1
    buffer_load_dwordx4 v[216:219], v7, s[32:35], s48 offen offset:512 sc1
    buffer_load_dwordx4 v[220:223], v7, s[32:35], s48 offen offset:768 sc1
    s_mov_b32 s48, 0x2000
    buffer_load_dwordx4 v[224:227], v7, s[32:35], s48 offen offset:0 sc1
    buffer_load_dwordx4 v[228:231], v7, s[32:35], s48 offen offset:256 sc1
    buffer_load_dwordx4 v[232:235], v7, s[32:35], s48 offen offset:512 sc1
    buffer_load_dwordx4 v[236:239], v7, s[32:35], s48 offen offset:768 sc1
    s_mov_b32 s48, 0x3000
    buffer_load_dwordx4 v[240:243], v7, s[32:35], s48 offen offset:0 sc1
    buffer_load_dwordx4 v[244:247], v7, s[32:35], s48 offen offset:256 sc1
    buffer_load_dwordx4 v[248:251], v7, s[32:35], s48 offen offset:512 sc1
    buffer_load_dwordx4 v[252:255], v7, s[32:35], s48 offen offset:768 sc1
PAD_244:
    s_cbranch_execz SCB_ret
    s_mov_b32 s48, 0x4000
    buffer_load_dwordx4 a[216:219], v7, s[32:35], s48 offen offset:0 sc1
    buffer_load_dwordx4 a[220:223], v7, s[32:35], s48 offen offset:256 sc1
    buffer_load_dwordx4 a[224:227], v7, s[32:35], s48 offen offset:512 sc1
    buffer_load_dwordx4 a[228:231], v7, s[32:35], s48 offen offset:768 sc1
    s_waitcnt vmcnt(0)
    v_bitop3_b32 v4, v192, v196, v200 bitop3:0x80
    v_bitop3_b32 v4, v4, v204, 1 bitop3:0x80
    v_cmp_eq_u32 vcc, 0, v4
    s_nop 3
    s_cbranch_vccnz G2_retry_62
    s_branch G2_retry_62_ok
G2_retry_62_out:
    s_mov_b32 s55, 0
    s_branch G2_retry_62_ok
G2_retry_63:
    s_sub_u32 s55, s55, 1
    s_cbranch_scc1 G2_retry_63_out
    s_mov_b32 s48, 0x1000
    buffer_load_dwordx4 v[208:211], v7, s[32:35], s48 offen offset:0 sc1
    buffer_load_dwordx4 v[212:215], v7, s[32:35], s48 offen offset:256 sc1
    buffer_load_dwordx4 v[216:219], v7, s[32:35], s48 offen offset:512 sc1
    buffer_load_dwordx4 v[220:223], v7, s[32:35], s48 offen offset:768 sc1
    s_mov_b32 s48, 0x2000
    buffer_load_dwordx4 v[224:227], v7, s[32:35], s48 offen offset:0 sc1
    buffer_load_dwordx4 v[228:231], v7, s[32:35], s48 offen offset:256 sc1
    buffer_load_dwordx4 v[232:235], v7, s[32:35], s48 offen offset:512 sc1
    buffer_load_dwordx4 v[236:239], v7, s[32:35], s48 offen offset:768 sc1
    s_mov_b32 s48, 0x3000
    buffer_load_dwordx4 v[240:243], v7, s[32:35], s48 offen offset:0 sc1
    buffer_load_dwordx4 v[244:247], v7, s[32:35], s48 offen offset:256 sc1
    buffer_load_dwordx4 v[248:251], v7, s[32:35], s48 offen offset:512 sc1
    buffer_load_dwordx4 v[252:255], v7, s[32:35], s48 offen offset:768 sc1
    s_mov_b32 s48, 0x4000
    buffer_load_dwordx4 a[216:219], v7, s[32:35], s48 offen offset:0 sc1
    buffer_load_dwordx4 a[220:223], v7, s[32:35], s48 offen offset:256 sc1
    buffer_load_dwordx4 a[224:227], v7, s[32:35], s48 offen offset:512 sc1
    buffer_load_dwordx4 a[228:231], v7, s[32:35], s48 offen offset:768 sc1
SCB_e23:
PAD_245:
    s_cbranch_execz PAD_246
    s_mov_b32 s48, 0x5000
    buffer_load_dwordx4 a[200:203], v7, s[32:35], s48 offen offset:0 sc1
    buffer_load_dwordx4 a[204:207], v7, s[32:35], s48 offen offset:256 sc1
    buffer_load_dwordx4 a[208:211], v7, s[32:35], s48 offen offset:512 sc1
    buffer_load_dwordx4 a[212:215], v7, s[32:35], s48 offen offset:768 sc1
    s_waitcnt vmcnt(0)
    v_bitop3_b32 v4, v208, v212, v216 bitop3:0x80
    v_bitop3_b32 v4, v4, v220, 1 bitop3:0x80
    v_cmp_eq_u32 vcc, 0, v4
    s_nop 3
    s_cbranch_vccnz G2_retry_63
    s_branch G2_retry_63_ok
G2_retry_63_out:
    s_mov_b32 s55, 0
    s_branch G2_retry_63_ok
G2_retry_64:
    s_sub_u32 s55, s55, 1
    s_cbranch_scc1 G2_retry_64_out
    s_mov_b32 s48, 0x2000
    buffer_load_dwordx4 v[224:227], v7, s[32:35], s48 offen offset:0 sc1
    buffer_load_dwordx4 v[228:231], v7, s[32:35], s48 offen offset:256 sc1
    buffer_load_dwordx4 v[232:235], v7, s[32:35], s48 offen offset:512 sc1
    buffer_load_dwordx4 v[236:239], v7, s[32:35], s48 offen offset:768 sc1
    s_mov_b32 s48, 0x3000
    buffer_load_dwordx4 v[240:243], v7, s[32:35], s48 offen offset:0 sc1
    buffer_load_dwordx4 v[244:247], v7, s[32:35], s48 offen offset:256 sc1
    buffer_load_dwordx4 v[248:251], v7, s[32:35], s48 offen offset:512 sc1
    buffer_load_dwordx4 v[252:255], v7, s[32:35], s48 offen offset:768 sc1
    s_mov_b32 s48, 0x4000
    buffer_load_dwordx4 a[216:219], v7, s[32:35], s48 offen offset:0 sc1
    buffer_load_dwordx4 a[220:223], v7, s[32:35], s48 offen offset:256 sc1
    buffer_load_dwordx4 a[224:227], v7, s[32:35], s48 offen offset:512 sc1
    buffer_load_dwordx4 a[228:231], v7, s[32:35], s48 offen offset:768 sc1
    s_mov_b32 s48, 0x5000
    buffer_load_dwordx4 a[200:203], v7, s[32:35], s48 offen offset:0 sc1
    buffer_load_dwordx4 a[204:207], v7, s[32:35], s48 offen offset:256 sc1
    buffer_load_dwordx4 a[208:211], v7, s[32:35], s48 offen offset:512 sc1
    buffer_load_dwordx4 a[212:215], v7, s[32:35], s48 offen offset:768 sc1
PAD_246:
    s_cbranch_execz PAD_247
    s_mov_b32 s48, 0x6000
    buffer_load_dwordx4 a[232:235], v7, s[32:35], s48 offen offset:0 sc1
    buffer_load_dwordx4 a[236:239], v7, s[32:35], s48 offen offset:256 sc1
    buffer_load_dwordx4 a[240:243], v7, s[32:35], s48 offen offset:512 sc1
    buffer_load_dwordx4 a[244:247], v7, s[32:35], s48 offen offset:768 sc1
    s_waitcnt vmcnt(0)
    v_bitop3_b32 v4, v224, v228, v232 bitop3:0x80
    v_bitop3_b32 v4, v4, v236, 1 bitop3:0x80
    v_cmp_eq_u32 vcc, 0, v4
    s_nop 3
    s_cbranch_vccnz G2_retry_64
    s_branch G2_retry_64_ok
G2_retry_64_out:
    s_mov_b32 s55, 0
    s_branch G2_retry_64_ok
G2_retry_65:
    s_sub_u32 s55, s55, 1
    s_cbranch_scc1 G2_retry_65_out
    s_mov_b32 s48, 0x3000
    buffer_load_dwordx4 v[240:243], v7, s[32:35], s48 offen offset:0 sc1
    buffer_load_dwordx4 v[244:247], v7, s[32:35], s48 offen offset:256 sc1
    buffer_load_dwordx4 v[248:251], v7, s[32:35], s48 offen offset:512 sc1
    buffer_load_dwordx4 v[252:255], v7, s[32:35], s48 offen offset:768 sc1
    s_mov_b32 s48, 0x4000
    buffer_load_dwordx4 a[216:219], v7, s[32:35], s48 offen offset:0 sc1
    buffer_load_dwordx4 a[220:223], v7, s[32:35], s48 offen offset:256 sc1
    buffer_load_dwordx4 a[224:227], v7, s[32:35], s48 offen offset:512 sc1
    buffer_load_dwordx4 a[228:231], v7, s[32:35], s48 offen offset:768 sc1
    s_mov_b32 s48, 0x5000
    buffer_load_dwordx4 a[200:203], v7, s[32:35], s48 offen offset:0 sc1
    buffer_load_dwordx4 a[204:207], v7, s[32:35], s48 offen offset:256 sc1
    buffer_load_dwordx4 a[208:211], v7, s[32:35], s48 offen offset:512 sc1
    buffer_load_dwordx4 a[212:215], v7, s[32:35], s48 offen offset:768 sc1
    s_mov_b32 s48, 0x6000
    buffer_load_dwordx4 a[232:235], v7, s[32:35], s48 offen offset:0 sc1
    buffer_load_dwordx4 a[236:239], v7, s[32:35], s48 offen offset:256 sc1
    buffer_load_dwordx4 a[240:243], v7, s[32:35], s48 offen offset:512 sc1
    buffer_load_dwordx4 a[244:247], v7, s[32:35], s48 offen offset:768 sc1
PAD_247:
    s_cbranch_execz SCB_ret
    s_mov_b32 s48, 0x7000
    buffer_load_dwordx4 v[112:115], v7, s[32:35], s48 offen offset:0 sc1
    buffer_load_dwordx4 v[116:119], v7, s[32:35], s48 offen offset:256 sc1
    buffer_load_dwordx4 v[120:123], v7, s[32:35], s48 offen offset:512 sc1
    buffer_load_dwordx4 v[124:127], v7, s[32:35], s48 offen offset:768 sc1
    s_waitcnt vmcnt(0)
    v_bitop3_b32 v4, v240, v244, v248 bitop3:0x80
    v_bitop3_b32 v4, v4, v252, 1 bitop3:0x80
    v_cmp_eq_u32 vcc, 0, v4
    s_nop 3
    s_cbranch_vccnz G2_retry_65
    s_branch G2_retry_65_ok
G2_retry_65_out:
    s_mov_b32 s55, 0
    s_branch G2_retry_65_ok
G2_retry_66:
    s_sub_u32 s55, s55, 1
    s_cbranch_scc1 G2_retry_66_out
    s_mov_b32 s48, 0x4000
    buffer_load_dwordx4 a[216:219], v7, s[32:35], s48 offen offset:0 sc1
    buffer_load_dwordx4 a[220:223], v7, s[32:35], s48 offen offset:256 sc1
    buffer_load_dwordx4 a[224:227], v7, s[32:35], s48 offen offset:512 sc1
    buffer_load_dwordx4 a[228:231], v7, s[32:35], s48 offen offset:768 sc1
    s_mov_b32 s48, 0x5000
    buffer_load_dwordx4 a[200:203], v7, s[32:35], s48 offen offset:0 sc1
    buffer_load_dwordx4 a[204:207], v7, s[32:35], s48 offen offset:256 sc1
    buffer_load_dwordx4 a[208:211], v7, s[32:35], s48 offen offset:512 sc1
    buffer_load_dwordx4 a[212:215], v7, s[32:35], s48 offen offset:768 sc1
    s_mov_b32 s48, 0x6000
    buffer_load_dwordx4 a[232:235], v7, s[32:35], s48 offen offset:0 sc1
    buffer_load_dwordx4 a[236:239], v7, s[32:35], s48 offen offset:256 sc1
    buffer_load_dwordx4 a[240:243], v7, s[32:35], s48 offen offset:512 sc1
    buffer_load_dwordx4 a[244:247], v7, s[32:35], s48 offen offset:768 sc1
    s_mov_b32 s48, 0x7000
    buffer_load_dwordx4 v[112:115], v7, s[32:35], s48 offen offset:0 sc1
    buffer_load_dwordx4 v[116:119], v7, s[32:35], s48 offen offset:256 sc1
    buffer_load_dwordx4 v[120:123], v7, s[32:35], s48 offen offset:512 sc1
    buffer_load_dwordx4 v[124:127], v7, s[32:35], s48 offen offset:768 sc1
SCB_e35:
PAD_248:
    s_cbranch_execz PAD_249
    s_mov_b32 s48, 0x8000
    buffer_load_dwordx4 v[192:195], v7, s[32:35], s48 offen offset:0 sc1
    buffer_load_dwordx4 v[196:199], v7, s[32:35], s48 offen offset:256 sc1
    buffer_load_dwordx4 v[200:203], v7, s[32:35], s48 offen offset:512 sc1
    buffer_load_dwordx4 v[204:207], v7, s[32:35], s48 offen offset:768 sc1
    s_waitcnt vmcnt(0)
    v_accvgpr_read_b32 v4, a216
    v_accvgpr_read_b32 v5, a220
    v_accvgpr_read_b32 v108, a224
    v_bitop3_b32 v4, v4, v5, v108 bitop3:0x80
    v_accvgpr_read_b32 v5, a228
    v_bitop3_b32 v4, v4, v5, 1 bitop3:0x80
    v_cmp_eq_u32 vcc, 0, v4
    s_nop 3
    s_cbranch_vccnz G2_retry_66
    s_branch G2_retry_66_ok
G2_retry_66_out:
    s_mov_b32 s55, 0
    s_branch G2_retry_66_ok
G2_retry_67:
    s_sub_u32 s55, s55, 1
    s_cbranch_scc1 G2_retry_67_out
    s_mov_b32 s48, 0x5000
    buffer_load_dwordx4 a[200:203], v7, s[32:35], s48 offen offset:0 sc1
    buffer_load_dwordx4 a[204:207], v7, s[32:35], s48 offen offset:256 sc1
    buffer_load_dwordx4 a[208:211], v7, s[32:35], s48 offen offset:512 sc1
    buffer_load_dwordx4 a[212:215], v7, s[32:35], s48 offen offset:768 sc1
    s_mov_b32 s48, 0x6000
    buffer_load_dwordx4 a[232:235], v7, s[32:35], s48 offen offset:0 sc1
    buffer_load_dwordx4 a[236:239], v7, s[32:35], s48 offen offset:256 sc1
    buffer_load_dwordx4 a[240:243], v7, s[32:35], s48 offen offset:512 sc1
    buffer_load_dwordx4 a[244:247], v7, s[32:35], s48 offen offset:768 sc1
    s_mov_b32 s48, 0x7000
    buffer_load_dwordx4 v[112:115], v7, s[32:35], s48 offen offset:0 sc1
    buffer_load_dwordx4 v[116:119], v7, s[32:35], s48 offen offset:256 sc1
    buffer_load_dwordx4 v[120:123], v7, s[32:35], s48 offen offset:512 sc1
    buffer_load_dwordx4 v[124:127], v7, s[32:35], s48 offen offset:768 sc1
    s_mov_b32 s48, 0x8000
PAD_249:
    s_cbranch_execz PAD_250
    buffer_load_dwordx4 v[192:195], v7, s[32:35], s48 offen offset:0 sc1
    buffer_load_dwordx4 v[196:199], v7, s[32:35], s48 offen offset:256 sc1
    buffer_load_dwordx4 v[200:203], v7, s[32:35], s48 offen offset:512 sc1
    buffer_load_dwordx4 v[204:207], v7, s[32:35], s48 offen offset:768 sc1
    s_mov_b32 s48, 0x9000
    buffer_load_dwordx4 v[128:131], v7, s[32:35], s48 offen offset:0 sc1
    buffer_load_dwordx4 v[132:135], v7, s[32:35], s48 offen offset:256 sc1
    buffer_load_dwordx4 v[136:139], v7, s[32:35], s48 offen offset:512 sc1
    buffer_load_dwordx4 v[140:143], v7, s[32:35], s48 offen offset:768 sc1
    s_waitcnt vmcnt(0)
    v_accvgpr_read_b32 v4, a200
    v_accvgpr_read_b32 v5, a204
    v_accvgpr_read_b32 v108, a208
    v_bitop3_b32 v4, v4, v5, v108 bitop3:0x80
    v_accvgpr_read_b32 v5, a212
    v_bitop3_b32 v4, v4, v5, 1 bitop3:0x80
    v_cmp_eq_u32 vcc, 0, v4
    s_nop 3
    s_cbranch_vccnz G2_retry_67
    s_branch G2_retry_67_ok
G2_retry_67_out:
    s_mov_b32 s55, 0
    s_branch G2_retry_67_ok
G2_retry_68:
    s_sub_u32 s55, s55, 1
    s_cbranch_scc1 G2_retry_68_out
    s_mov_b32 s48, 0x6000
    buffer_load_dwordx4 a[232:235], v7, s[32:35], s48 offen offset:0 sc1
    buffer_load_dwordx4 a[236:239], v7, s[32:35], s48 offen offset:256 sc1
    buffer_load_dwordx4 a[240:243], v7, s[32:35], s48 offen offset:512 sc1
    buffer_load_dwordx4 a[244:247], v7, s[32:35], s48 offen offset:768 sc1
    s_mov_b32 s48, 0x7000
    buffer_load_dwordx4 v[112:115], v7, s[32:35], s48 offen offset:0 sc1
    buffer_load_dwordx4 v[116:119], v7, s[32:35], s48 offen offset:256 sc1
    buffer_load_dwordx4 v[120:123], v7, s[32:35], s48 offen offset:512 sc1
    buffer_load_dwordx4 v[124:127], v7, s[32:35], s48 offen offset:768 sc1
    s_mov_b32 s48, 0x8000
    buffer_load_dwordx4 v[192:195], v7, s[32:35], s48 offen offset:0 sc1
PAD_250:
    s_cbranch_execz PAD_251
    buffer_load_dwordx4 v[196:199], v7, s[32:35], s48 offen offset:256 sc1
    buffer_load_dwordx4 v[200:203], v7, s[32:35], s48 offen offset:512 sc1
    buffer_load_dwordx4 v[204:207], v7, s[32:35], s48 offen offset:768 sc1
    s_mov_b32 s48, 0x9000
    buffer_load_dwordx4 v[128:131], v7, s[32:35], s48 offen offset:0 sc1
    buffer_load_dwordx4 v[132:135], v7, s[32:35], s48 offen offset:256 sc1
    buffer_load_dwordx4 v[136:139], v7, s[32:35], s48 offen offset:512 sc1
    buffer_load_dwordx4 v[140:143], v7, s[32:35], s48 offen offset:768 sc1
    s_mov_b32 s48, 0xa000
    buffer_load_dwordx4 v[208:211], v7, s[32:35], s48 offen offset:0 sc1
    buffer_load_dwordx4 v[212:215], v7, s[32:35], s48 offen offset:256 sc1
    buffer_load_dwordx4 v[216:219], v7, s[32:35], s48 offen offset:512 sc1
    buffer_load_dwordx4 v[220:223], v7, s[32:35], s48 offen offset:768 sc1
    s_waitcnt vmcnt(0)
    v_accvgpr_read_b32 v4, a232
    v_accvgpr_read_b32 v5, a236
    v_accvgpr_read_b32 v108, a240
    v_bitop3_b32 v4, v4, v5, v108 bitop3:0x80
    v_accvgpr_read_b32 v5, a244
    v_bitop3_b32 v4, v4, v5, 1 bitop3:0x80
    v_cmp_eq_u32 vcc, 0, v4
    s_nop 3
    s_cbranch_vccnz G2_retry_68
    s_branch G2_retry_68_ok
G2_retry_68_out:
    s_mov_b32 s55, 0
    s_branch G2_retry_68_ok
G2_retry_69:
    s_sub_u32 s55, s55, 1
    s_cbranch_scc1 G2_retry_69_out
    s_mov_b32 s48, 0x7000
    buffer_load_dwordx4 v[112:115], v7, s[32:35], s48 offen offset:0 sc1
    buffer_load_dwordx4 v[116:119], v7, s[32:35], s48 offen offset:256 sc1
    buffer_load_dwordx4 v[120:123], v7, s[32:35], s48 offen offset:512 sc1
    buffer_load_dwordx4 v[124:127], v7, s[32:35], s48 offen offset:768 sc1
    s_mov_b32 s48, 0x8000
    buffer_load_dwordx4 v[192:195], v7, s[32:35], s48 offen offset:0 sc1
    buffer_load_dwordx4 v[196:199], v7, s[32:35], s48 offen offset:256 sc1
PAD_251:
    s_cbranch_execz SCB_ret
    buffer_load_dwordx4 v[200:203], v7, s[32:35], s48 offen offset:512 sc1
    buffer_load_dwordx4 v[204:207], v7, s[32:35], s48 offen offset:768 sc1
    s_mov_b32 s48, 0x9000
    buffer_load_dwordx4 v[128:131], v7, s[32:35], s48 offen offset:0 sc1
    buffer_load_dwordx4 v[132:135], v7, s[32:35], s48 offen offset:256 sc1
    buffer_load_dwordx4 v[136:139], v7, s[32:35], s48 offen offset:512 sc1
    buffer_load_dwordx4 v[140:143], v7, s[32:35], s48 offen offset:768 sc1
    s_mov_b32 s48, 0xa000
    buffer_load_dwordx4 v[208:211], v7, s[32:35], s48 offen offset:0 sc1
    buffer_load_dwordx4 v[212:215], v7, s[32:35], s48 offen offset:256 sc1
    buffer_load_dwordx4 v[216:219], v7, s[32:35], s48 offen offset:512 sc1
    buffer_load_dwordx4 v[220:223], v7, s[32:35], s48 offen offset:768 sc1
    s_mov_b32 s48, 0xb000
    buffer_load_dwordx4 v[144:147], v7, s[32:35], s48 offen offset:0 sc1
    buffer_load_dwordx4 v[148:151], v7, s[32:35], s48 offen offset:256 sc1
    buffer_load_dwordx4 v[152:155], v7, s[32:35], s48 offen offset:512 sc1
    buffer_load_dwordx4 v[156:159], v7, s[32:35], s48 offen offset:768 sc1
    s_waitcnt vmcnt(0)
    v_bitop3_b32 v4, v112, v116, v120 bitop3:0x80
    v_bitop3_b32 v4, v4, v124, 1 bitop3:0x80
    v_cmp_eq_u32 vcc, 0, v4
    s_nop 3
    s_cbranch_vccnz G2_retry_69
    s_branch G2_retry_69_ok
G2_retry_69_out:
    s_mov_b32 s55, 0
    s_branch G2_retry_69_ok
G2_retry_70:
    s_sub_u32 s55, s55, 1
    s_cbranch_scc1 G2_retry_70_out
    s_mov_b32 s48, 0x8000
    buffer_load_dwordx4 v[192:195], v7, s[32:35], s48 offen offset:0 sc1
    buffer_load_dwordx4 v[196:199], v7, s[32:35], s48 offen offset:256 sc1
    buffer_load_dwordx4 v[200:203], v7, s[32:35], s48 offen offset:512 sc1
    buffer_load_dwordx4 v[204:207], v7, s[32:35], s48 offen offset:768 sc1
    s_mov_b32 s48, 0x9000
    buffer_load_dwordx4 v[128:131], v7, s[32:35], s48 offen offset:0 sc1
    buffer_load_dwordx4 v[132:135], v7, s[32:35], s48 offen offset:256 sc1
SCB_e47:
PAD_252:
    s_cbranch_execz PAD_253
    buffer_load_dwordx4 v[136:139], v7, s[32:35], s48 offen offset:512 sc1
    buffer_load_dwordx4 v[140:143], v7, s[32:35], s48 offen offset:768 sc1
    s_mov_b32 s48, 0xa000
    buffer_load_dwordx4 v[208:211], v7, s[32:35], s48 offen offset:0 sc1
    buffer_load_dwordx4 v[212:215], v7, s[32:35], s48 offen offset:256 sc1
    buffer_load_dwordx4 v[216:219], v7, s[32:35], s48 offen offset:512 sc1
    buffer_load_dwordx4 v[220:223], v7, s[32:35], s48 offen offset:768 sc1
    s_mov_b32 s48, 0xb000
    buffer_load_dwordx4 v[144:147], v7, s[32:35], s48 offen offset:0 sc1
    buffer_load_dwordx4 v[148:151], v7, s[32:35], s48 offen offset:256 sc1
    buffer_load_dwordx4 v[152:155], v7, s[32:35], s48 offen offset:512 sc1
    buffer_load_dwordx4 v[156:159], v7, s[32:35], s48 offen offset:768 sc1
    s_waitcnt vmcnt(0)
    v_bitop3_b32 v4, v192, v196, v200 bitop3:0x80
    v_bitop3_b32 v4, v4, v204, 1 bitop3:0x80
    v_cmp_eq_u32 vcc, 0, v4
    s_nop 3
    s_cbranch_vccnz G2_retry_70
    s_branch G2_retry_70_ok
G2_retry_70_out:
    s_mov_b32 s55, 0
    s_branch G2_retry_70_ok
G2_retry_71:
    s_sub_u32 s55, s55, 1
    s_cbranch_scc1 G2_retry_71_out
    s_mov_b32 s48, 0x9000
    buffer_load_dwordx4 v[128:131], v7, s[32:35], s48 offen offset:0 sc1
    buffer_load_dwordx4 v[132:135], v7, s[32:35], s48 offen offset:256 sc1
    buffer_load_dwordx4 v[136:139], v7, s[32:35], s48 offen offset:512 sc1
    buffer_load_dwordx4 v[140:143], v7, s[32:35], s48 offen offset:768 sc1
    s_mov_b32 s48, 0xa000
    buffer_load_dwordx4 v[208:211], v7, s[32:35], s48 offen offset:0 sc1
    buffer_load_dwordx4 v[212:215], v7, s[32:35], s48 offen offset:256 sc1
    buffer_load_dwordx4 v[216:219], v7, s[32:35], s48 offen offset:512 sc1
    buffer_load_dwordx4 v[220:223], v7, s[32:35], s48 offen offset:768 sc1
    s_mov_b32 s48, 0xb000
    buffer_load_dwordx4 v[144:147], v7, s[32:35], s48 offen offset:0 sc1
    buffer_load_dwordx4 v[148:151], v7, s[32:35], s48 offen offset:256 sc1
PAD_253:
    s_cbranch_execz PAD_254
    buffer_load_dwordx4 v[152:155], v7, s[32:35], s48 offen offset:512 sc1
    buffer_load_dwordx4 v[156:159], v7, s[32:35], s48 offen offset:768 sc1
    s_mov_b32 s48, 0xc000
    buffer_load_dwordx4 v[224:227], v7, s[32:35], s48 offen offset:0 sc1
    buffer_load_dwordx4 v[228:231], v7, s[32:35], s48 offen offset:256 sc1
    buffer_load_dwordx4 v[232:235], v7, s[32:35], s48 offen offset:512 sc1
    buffer_load_dwordx4 v[236:239], v7, s[32:35], s48 offen offset:768 sc1
    s_waitcnt vmcnt(0)
    v_bitop3_b32 v4, v128, v132, v136 bitop3:0x80
    v_bitop3_b32 v4, v4, v140, 1 bitop3:0x80
    v_cmp_eq_u32 vcc, 0, v4
    s_nop 3
    s_cbranch_vccnz G2_retry_71
    s_branch G2_retry_71_ok
G2_retry_71_out:
    s_mov_b32 s55, 0
    s_branch G2_retry_71_ok
G2_retry_72:
    s_sub_u32 s55, s55, 1
    s_cbranch_scc1 G2_retry_72_out
    s_mov_b32 s48, 0xa000
    buffer_load_dwordx4 v[208:211], v7, s[32:35], s48 offen offset:0 sc1
    buffer_load_dwordx4 v[212:215], v7, s[32:35], s48 offen offset:256 sc1
    buffer_load_dwordx4 v[216:219], v7, s[32:35], s48 offen offset:512 sc1
    buffer_load_dwordx4 v[220:223], v7, s[32:35], s48 offen offset:768 sc1
    s_mov_b32 s48, 0xb000
    buffer_load_dwordx4 v[144:147], v7, s[32:35], s48 offen offset:0 sc1
    buffer_load_dwordx4 v[148:151], v7, s[32:35], s48 offen offset:256 sc1
    buffer_load_dwordx4 v[152:155], v7, s[32:35], s48 offen offset:512 sc1
    buffer_load_dwordx4 v[156:159], v7, s[32:35], s48 offen offset:768 sc1
    s_mov_b32 s48, 0xc000
    buffer_load_dwordx4 v[224:227], v7, s[32:35], s48 offen offset:0 sc1
    buffer_load_dwordx4 v[228:231], v7, s[32:35], s48 offen offset:256 sc1
    buffer_load_dwordx4 v[232:235], v7, s[32:35], s48 offen offset:512 sc1
    buffer_load_dwordx4 v[236:239], v7, s[32:35], s48 offen offset:768 sc1
    s_waitcnt vmcnt(0)
    v_bitop3_b32 v4, v208, v212, v216 bitop3:0x80
    v_bitop3_b32 v4, v4, v220, 1 bitop3:0x80
PAD_254:
    s_cbranch_execz PAD_255
    v_cmp_eq_u32 vcc, 0, v4
    s_nop 3
    s_cbranch_vccnz G2_retry_72
    s_branch G2_retry_72_ok
G2_retry_72_out:
    s_mov_b32 s55, 0
    s_branch G2_retry_72_ok
G2_retry_73:
    s_sub_u32 s55, s55, 1
    s_cbranch_scc1 G2_retry_73_out
    s_mov_b32 s48, 0xb000
    buffer_load_dwordx4 v[144:147], v7, s[32:35], s48 offen offset:0 sc1
    buffer_load_dwordx4 v[148:151], v7, s[32:35], s48 offen offset:256 sc1
    buffer_load_dwordx4 v[152:155], v7, s[32:35], s48 offen offset:512 sc1
    buffer_load_dwordx4 v[156:159], v7, s[32:35], s48 offen offset:768 sc1
    s_mov_b32 s48, 0xc000
    buffer_load_dwordx4 v[224:227], v7, s[32:35], s48 offen offset:0 sc1
    buffer_load_dwordx4 v[228:231], v7, s[32:35], s48 offen offset:256 sc1
    buffer_load_dwordx4 v[232:235], v7, s[32:35], s48 offen offset:512 sc1
    buffer_load_dwordx4 v[236:239], v7, s[32:35], s48 offen offset:768 sc1
    s_mov_b32 s48, 0xd000
    buffer_load_dwordx4 v[160:163], v7, s[32:35], s48 offen offset:0 sc1
    buffer_load_dwordx4 v[164:167], v7, s[32:35], s48 offen offset:256 sc1
    buffer_load_dwordx4 v[168:171], v7, s[32:35], s48 offen offset:512 sc1
    buffer_load_dwordx4 v[172:175], v7, s[32:35], s48 offen offset:768 sc1
    s_waitcnt vmcnt(0)
    v_bitop3_b32 v4, v144, v148, v152 bitop3:0x80
    v_bitop3_b32 v4, v4, v156, 1 bitop3:0x80
    v_cmp_eq_u32 vcc, 0, v4
    s_nop 3
    s_cbranch_vccnz G2_retry_73
    s_branch G2_retry_73_ok
G2_retry_73_out:
    s_mov_b32 s55, 0
    s_branch G2_retry_73_ok
G2_retry_74:
    s_sub_u32 s55, s55, 1
    s_cbranch_scc1 G2_retry_74_out
    s_mov_b32 s48, 0xc000
    buffer_load_dwordx4 v[224:227], v7, s[32:35], s48 offen offset:0 sc1
    buffer_load_dwordx4 v[228:231], v7, s[32:35], s48 offen offset:256 sc1
    buffer_load_dwordx4 v[232:235], v7, s[32:35], s48 offen offset:512 sc1
    buffer_load_dwordx4 v[236:239], v7, s[32:35], s48 offen offset:768 sc1
    s_mov_b32 s48, 0xd000
PAD_255:
    s_cbranch_execz SCB_ret
    buffer_load_dwordx4 v[160:163], v7, s[32:35], s48 offen offset:0 sc1
    buffer_load_dwordx4 v[164:167], v7, s[32:35], s48 offen offset:256 sc1
    buffer_load_dwordx4 v[168:171], v7, s[32:35], s48 offen offset:512 sc1
    buffer_load_dwordx4 v[172:175], v7, s[32:35], s48 offen offset:768 sc1
    s_waitcnt vmcnt(0)
    v_bitop3_b32 v4, v224, v228, v232 bitop3:0x80
    v_bitop3_b32 v4, v4, v236, 1 bitop3:0x80
    v_cmp_eq_u32 vcc, 0, v4
    s_nop 3
    s_cbranch_vccnz G2_retry_74
    s_branch G2_retry_74_ok
G2_retry_74_out:
    s_mov_b32 s55, 0
    s_branch G2_retry_74_ok
G2_retry_75:
    s_sub_u32 s55, s55, 1
    s_cbranch_scc1 G2_retry_75_out
    s_mov_b32 s48, 0xd000
    buffer_load_dwordx4 v[160:163], v7, s[32:35], s48 offen offset:0 sc1
    buffer_load_dwordx4 v[164:167], v7, s[32:35], s48 offen offset:256 sc1
    buffer_load_dwordx4 v[168:171], v7, s[32:35], s48 offen offset:512 sc1
    buffer_load_dwordx4 v[172:175], v7, s[32:35], s48 offen offset:768 sc1
    s_waitcnt vmcnt(0)
    v_bitop3_b32 v4, v160, v164, v168 bitop3:0x80
    v_bitop3_b32 v4, v4, v172, 1 bitop3:0x80
    v_cmp_eq_u32 vcc, 0, v4
    s_nop 3
    s_cbranch_vccnz G2_retry_75
    s_branch G2_retry_75_ok
G2_retry_75_out:
    s_mov_b32 s55, 0
    s_branch G2_retry_75_ok
.section .rodata,"a"
.p2align 6
.amdhsa_kernel main_kernel
  .amdhsa_next_free_vgpr 512
  .amdhsa_next_free_sgpr 102
  .amdhsa_accum_offset 256
  .amdhsa_group_segment_fixed_size 0
  .amdhsa_kernarg_size 88
  .amdhsa_user_sgpr_count 2
  .amdhsa_user_sgpr_kernarg_segment_ptr 1
  .amdhsa_system_sgpr_workgroup_id_x 1
.end_amdhsa_kernel
```
